```python
import torch

def _softmax(x, axis=-1):
    return torch.softmax(x, dim=axis)
def _gelu(x):
    return torch.nn.functional.gelu(x, approximate="tanh")
def _silu(x):
    return torch.nn.functional.silu(x)
def _sigmoid(x):
    return torch.sigmoid(x)
def _layernorm(x, axis=-1, eps=1e-5):
    m = x.mean(dim=axis, keepdim=True)
    v = x.var(dim=axis, keepdim=True, unbiased=False)
    return (x - m) / torch.sqrt(v + eps)
def _scatter_add(tgt, idx, src, axis=0):
    return tgt.clone().index_add_(axis, idx, src)
def _segment_sum(src, seg, n):
    out = torch.zeros((n,) + src.shape[1:], dtype=src.dtype)
    return out.index_add_(0, seg, src)
def _pad(x, pw):
    flat = tuple(v for pair in reversed(pw) for v in pair)
    return torch.nn.functional.pad(x, flat)

kernel_name = 'interleave_layers__mha_block__glu_gated_geglu__prompt'

def setup_inputs():

    _w = (lambda a: (lambda t: t.to(torch.bfloat16) if t.is_floating_point() else t)(torch.as_tensor(a)))
    def _A_setup():
        B, S, D, H = 1, 2048, 640, 32
        return {
            "x": _w((lambda *s: torch.randn(*s, dtype=torch.bfloat16) * 0.05)(B, S, D)),
            "wqkv": _w((lambda *s: torch.randn(*s, dtype=torch.bfloat16) * 0.05)(D, 3 * D)),
            "wo": _w((lambda *s: torch.randn(*s, dtype=torch.bfloat16) * 0.05)(D, D)),
        }
    _A_in = _A_setup()

    def _B_setup():
        B, S, Dm, Df = 1, 2048, 640, 1728
        return {
            "x": _w((lambda *s: torch.randn(*s, dtype=torch.bfloat16) * 0.05)(B, S, Dm)),
            "w_gate": _w((lambda *s: torch.randn(*s, dtype=torch.bfloat16) * 0.8)(Dm, Df) * (Dm ** -0.5)),
            "w_up": _w((lambda *s: torch.randn(*s, dtype=torch.bfloat16) * 0.8)(Dm, Df) * (Dm ** -0.5)),
            "w_down": _w((lambda *s: torch.randn(*s, dtype=torch.bfloat16) * 0.8)(Df, Dm) * (Df ** -0.5)),
        }
    _B_in = _B_setup()

    return {
        "A_x": _A_in["x"],
        "A_wqkv": _A_in["wqkv"],
        "A_wo": _A_in["wo"],
        "B_x": _B_in["x"],
        "B_w_gate": _B_in["w_gate"],
        "B_w_up": _B_in["w_up"],
        "B_w_down": _B_in["w_down"],
    }

def reference(A_x, A_wqkv, A_wo, B_x, B_w_gate, B_w_up, B_w_down):
    def _A_ref(x, wqkv, wo):
        B, S, D = x.shape
        H = 32
        Dh = D // H
        qkv = (lambda x, *d: x.permute(*d))((x @ wqkv).reshape(B, S, 3, H, Dh), 2, 0, 3, 1, 4)
        q, k, v = qkv[0], qkv[1], qkv[2]
        scores = torch.einsum("bhqd,bhkd->bhqk", q, k) * (Dh ** -0.5)
        p = _softmax(scores, axis=-1)
        o = torch.einsum("bhqk,bhkd->bhqd", p, v)
        return (lambda x, *d: x.permute(*d))(o, 0, 2, 1, 3).reshape(B, S, D) @ wo

    def _B_ref(x, w_gate, w_up, w_down):
        g = torch.einsum("bsd,df->bsf", x, w_gate)
        u = torch.einsum("bsd,df->bsf", x, w_up)
        h = _gelu(g) * u
        return torch.einsum("bsf,fd->bsd", h, w_down)

    x = A_x
    x = x + _A_ref(_layernorm(x, axis=-1), A_wqkv, A_wo)
    x = x + _B_ref(_layernorm(x, axis=-1), B_w_gate, B_w_up, B_w_down)
    x = x + _A_ref(_layernorm(x, axis=-1), A_wqkv, A_wo)
    x = x + _B_ref(_layernorm(x, axis=-1), B_w_gate, B_w_up, B_w_down)
    return x
```

```asm
; @launch kernel=prep_kernel grid=(1424,1,1) block=(256,1,1) lds=8192
; @launch kernel=qkv0_kernel grid=(240,1,1) block=(512,1,1) lds=133120
; @launch kernel=attn_kernel grid=(256,1,1) block=(512,1,1) lds=98304
; @launch kernel=oproj0_kernel grid=(256,1,1) block=(256,1,1) lds=147456
; @launch kernel=geglu_kernel grid=(256,1,1) block=(512,1,1) lds=149504
; @launch kernel=down0_kernel grid=(256,1,1) block=(256,1,1) lds=147456
; @launch kernel=qkv1_kernel grid=(240,1,1) block=(512,1,1) lds=133120
; @launch kernel=attn_kernel grid=(256,1,1) block=(512,1,1) lds=98304
; @launch kernel=oproj1_kernel grid=(256,1,1) block=(256,1,1) lds=147456
; @launch kernel=geglu_kernel grid=(256,1,1) block=(512,1,1) lds=149504
; @launch kernel=down1_kernel grid=(256,1,1) block=(256,1,1) lds=147456
.amdgcn_target "amdgcn-amd-amdhsa--gfx950"
.text
.globl prep_kernel
.p2align 8
.type prep_kernel,@function
prep_kernel:
    s_cmp_ge_u32 s2, 1424
    s_cbranch_scc1 end_prep_kernel_1
    s_load_dwordx2 s[20:21], s[0:1], 72
    s_cmp_ge_u32 s2, 172
    s_cbranch_scc1 roleb_prep_kernel_2
    s_and_b32 s31, s2, 3
    s_lshr_b32 s26, s2, 2
    s_cmp_ge_u32 s26, 15
    s_cbranch_scc1 ag_prep_kernel_5
    s_load_dwordx2 s[4:5], s[0:1], 8
    s_mov_b32 s24, 3840
    s_mov_b32 s25, 2457600
    s_mov_b32 s27, 0
    s_branch ago_prep_kernel_7
ag_prep_kernel_5:
    s_cmp_ge_u32 s26, 29
    s_cbranch_scc1 au_prep_kernel_6
    s_load_dwordx2 s[4:5], s[0:1], 32
    s_mov_b32 s24, 3456
    s_mov_b32 s25, 2211840
    s_sub_u32 s26, s26, 15
    s_mov_b32 s27, 1920
    s_branch ago_prep_kernel_7
au_prep_kernel_6:
    s_load_dwordx2 s[4:5], s[0:1], 40
    s_mov_b32 s24, 3456
    s_mov_b32 s25, 2211840
    s_sub_u32 s26, s26, 29
    s_mov_b32 s27, 3648
ago_prep_kernel_7:
    s_waitcnt lgkmcnt(0)
    s_mov_b32 s8, s4
    s_and_b32 s9, s5, 0xffff
    s_mov_b32 s10, s25
    s_mov_b32 s11, 0x20000
    s_add_u32 s12, s20, 0x40000
    s_addc_u32 s13, s21, 0
    s_and_b32 s13, s13, 0xffff
    s_mov_b32 s14, 0x15000
    s_mov_b32 s15, 0x20000
    v_and_b32 v1, 15, v0
    v_lshrrev_b32 v2, 4, v0
    s_mul_i32 s28, s24, 10
    v_mul_lo_u32 v3, v2, s28
    v_lshl_add_u32 v3, v1, 4, v3
    s_lshl_b32 s29, s26, 8
    s_mul_i32 s30, s31, 160
    s_mul_i32 s30, s30, s24
    s_add_u32 s30, s30, s29
    buffer_load_dwordx4 v[16:19], v3, s[8:11], s30 offen
    s_add_u32 s30, s30, s24
    buffer_load_dwordx4 v[20:23], v3, s[8:11], s30 offen
    s_add_u32 s30, s30, s24
    buffer_load_dwordx4 v[24:27], v3, s[8:11], s30 offen
    s_add_u32 s30, s30, s24
    buffer_load_dwordx4 v[28:31], v3, s[8:11], s30 offen
    s_add_u32 s30, s30, s24
    buffer_load_dwordx4 v[32:35], v3, s[8:11], s30 offen
    s_add_u32 s30, s30, s24
    buffer_load_dwordx4 v[36:39], v3, s[8:11], s30 offen
    s_add_u32 s30, s30, s24
    buffer_load_dwordx4 v[40:43], v3, s[8:11], s30 offen
    s_add_u32 s30, s30, s24
    buffer_load_dwordx4 v[44:47], v3, s[8:11], s30 offen
    s_add_u32 s30, s30, s24
    buffer_load_dwordx4 v[48:51], v3, s[8:11], s30 offen
    s_add_u32 s30, s30, s24
    buffer_load_dwordx4 v[52:55], v3, s[8:11], s30 offen
    s_add_u32 s30, s30, s24
    v_mov_b32 v8, 0
    v_mov_b32 v9, 0
    v_mov_b32 v10, 0
    v_mov_b32 v11, 0
    v_mov_b32 v12, 0
    v_mov_b32 v13, 0
    v_mov_b32 v14, 0
    v_mov_b32 v15, 0
    s_waitcnt vmcnt(9)
    v_lshlrev_b32 v4, 16, v16
    v_and_b32 v5, 0xffff0000, v16
    v_add_f32 v8, v8, v4
    v_add_f32 v9, v9, v5
    v_lshlrev_b32 v4, 16, v17
    v_and_b32 v5, 0xffff0000, v17
    v_add_f32 v10, v10, v4
    v_add_f32 v11, v11, v5
    v_lshlrev_b32 v4, 16, v18
    v_and_b32 v5, 0xffff0000, v18
    v_add_f32 v12, v12, v4
    v_add_f32 v13, v13, v5
    v_lshlrev_b32 v4, 16, v19
    v_and_b32 v5, 0xffff0000, v19
    v_add_f32 v14, v14, v4
    v_add_f32 v15, v15, v5
    s_waitcnt vmcnt(8)
    v_lshlrev_b32 v4, 16, v20
    v_and_b32 v5, 0xffff0000, v20
    v_add_f32 v8, v8, v4
    v_add_f32 v9, v9, v5
    v_lshlrev_b32 v4, 16, v21
    v_and_b32 v5, 0xffff0000, v21
    v_add_f32 v10, v10, v4
    v_add_f32 v11, v11, v5
    v_lshlrev_b32 v4, 16, v22
    v_and_b32 v5, 0xffff0000, v22
    v_add_f32 v12, v12, v4
    v_add_f32 v13, v13, v5
    v_lshlrev_b32 v4, 16, v23
    v_and_b32 v5, 0xffff0000, v23
    v_add_f32 v14, v14, v4
    v_add_f32 v15, v15, v5
    s_waitcnt vmcnt(7)
    v_lshlrev_b32 v4, 16, v24
    v_and_b32 v5, 0xffff0000, v24
    v_add_f32 v8, v8, v4
    v_add_f32 v9, v9, v5
    v_lshlrev_b32 v4, 16, v25
    v_and_b32 v5, 0xffff0000, v25
    v_add_f32 v10, v10, v4
    v_add_f32 v11, v11, v5
    v_lshlrev_b32 v4, 16, v26
    v_and_b32 v5, 0xffff0000, v26
    v_add_f32 v12, v12, v4
    v_add_f32 v13, v13, v5
    v_lshlrev_b32 v4, 16, v27
    v_and_b32 v5, 0xffff0000, v27
    v_add_f32 v14, v14, v4
    v_add_f32 v15, v15, v5
    s_waitcnt vmcnt(6)
    v_lshlrev_b32 v4, 16, v28
    v_and_b32 v5, 0xffff0000, v28
    v_add_f32 v8, v8, v4
    v_add_f32 v9, v9, v5
    v_lshlrev_b32 v4, 16, v29
    v_and_b32 v5, 0xffff0000, v29
    v_add_f32 v10, v10, v4
    v_add_f32 v11, v11, v5
    v_lshlrev_b32 v4, 16, v30
    v_and_b32 v5, 0xffff0000, v30
    v_add_f32 v12, v12, v4
    v_add_f32 v13, v13, v5
    v_lshlrev_b32 v4, 16, v31
    v_and_b32 v5, 0xffff0000, v31
    v_add_f32 v14, v14, v4
    v_add_f32 v15, v15, v5
    s_waitcnt vmcnt(5)
    v_lshlrev_b32 v4, 16, v32
    v_and_b32 v5, 0xffff0000, v32
    v_add_f32 v8, v8, v4
    v_add_f32 v9, v9, v5
    v_lshlrev_b32 v4, 16, v33
    v_and_b32 v5, 0xffff0000, v33
    v_add_f32 v10, v10, v4
    v_add_f32 v11, v11, v5
    v_lshlrev_b32 v4, 16, v34
    v_and_b32 v5, 0xffff0000, v34
    v_add_f32 v12, v12, v4
    v_add_f32 v13, v13, v5
    v_lshlrev_b32 v4, 16, v35
    v_and_b32 v5, 0xffff0000, v35
    v_add_f32 v14, v14, v4
    v_add_f32 v15, v15, v5
    s_waitcnt vmcnt(4)
    v_lshlrev_b32 v4, 16, v36
    v_and_b32 v5, 0xffff0000, v36
    v_add_f32 v8, v8, v4
    v_add_f32 v9, v9, v5
    v_lshlrev_b32 v4, 16, v37
    v_and_b32 v5, 0xffff0000, v37
    v_add_f32 v10, v10, v4
    v_add_f32 v11, v11, v5
    v_lshlrev_b32 v4, 16, v38
    v_and_b32 v5, 0xffff0000, v38
    v_add_f32 v12, v12, v4
    v_add_f32 v13, v13, v5
    v_lshlrev_b32 v4, 16, v39
    v_and_b32 v5, 0xffff0000, v39
    v_add_f32 v14, v14, v4
    v_add_f32 v15, v15, v5
    s_waitcnt vmcnt(3)
    v_lshlrev_b32 v4, 16, v40
    v_and_b32 v5, 0xffff0000, v40
    v_add_f32 v8, v8, v4
    v_add_f32 v9, v9, v5
    v_lshlrev_b32 v4, 16, v41
    v_and_b32 v5, 0xffff0000, v41
    v_add_f32 v10, v10, v4
    v_add_f32 v11, v11, v5
    v_lshlrev_b32 v4, 16, v42
    v_and_b32 v5, 0xffff0000, v42
    v_add_f32 v12, v12, v4
    v_add_f32 v13, v13, v5
    v_lshlrev_b32 v4, 16, v43
    v_and_b32 v5, 0xffff0000, v43
    v_add_f32 v14, v14, v4
    v_add_f32 v15, v15, v5
    s_waitcnt vmcnt(2)
    v_lshlrev_b32 v4, 16, v44
    v_and_b32 v5, 0xffff0000, v44
    v_add_f32 v8, v8, v4
    v_add_f32 v9, v9, v5
    v_lshlrev_b32 v4, 16, v45
    v_and_b32 v5, 0xffff0000, v45
    v_add_f32 v10, v10, v4
    v_add_f32 v11, v11, v5
    v_lshlrev_b32 v4, 16, v46
    v_and_b32 v5, 0xffff0000, v46
    v_add_f32 v12, v12, v4
    v_add_f32 v13, v13, v5
    v_lshlrev_b32 v4, 16, v47
    v_and_b32 v5, 0xffff0000, v47
    v_add_f32 v14, v14, v4
    v_add_f32 v15, v15, v5
    s_waitcnt vmcnt(1)
    v_lshlrev_b32 v4, 16, v48
    v_and_b32 v5, 0xffff0000, v48
    v_add_f32 v8, v8, v4
    v_add_f32 v9, v9, v5
    v_lshlrev_b32 v4, 16, v49
    v_and_b32 v5, 0xffff0000, v49
    v_add_f32 v10, v10, v4
    v_add_f32 v11, v11, v5
    v_lshlrev_b32 v4, 16, v50
    v_and_b32 v5, 0xffff0000, v50
    v_add_f32 v12, v12, v4
    v_add_f32 v13, v13, v5
    v_lshlrev_b32 v4, 16, v51
    v_and_b32 v5, 0xffff0000, v51
    v_add_f32 v14, v14, v4
    v_add_f32 v15, v15, v5
    s_waitcnt vmcnt(0)
    v_lshlrev_b32 v4, 16, v52
    v_and_b32 v5, 0xffff0000, v52
    v_add_f32 v8, v8, v4
    v_add_f32 v9, v9, v5
    v_lshlrev_b32 v4, 16, v53
    v_and_b32 v5, 0xffff0000, v53
    v_add_f32 v10, v10, v4
    v_add_f32 v11, v11, v5
    v_lshlrev_b32 v4, 16, v54
    v_and_b32 v5, 0xffff0000, v54
    v_add_f32 v12, v12, v4
    v_add_f32 v13, v13, v5
    v_lshlrev_b32 v4, 16, v55
    v_and_b32 v5, 0xffff0000, v55
    v_add_f32 v14, v14, v4
    v_add_f32 v15, v15, v5
    v_lshlrev_b32 v6, 5, v0
    ds_write_b128 v6, v[8:11]
    ds_write_b128 v6, v[12:15] offset:16
    s_waitcnt lgkmcnt(0)
    s_barrier
    s_lshl_b32 s29, s26, 7
    v_add_u32 v7, s29, v0
    s_lshr_b32 s28, s24, 1
    v_cmp_gt_u32 s[34:35], s28, v7
    v_cmp_gt_u32 vcc, 128, v0
    s_and_b64 vcc, vcc, s[34:35]
    s_and_saveexec_b64 s[32:33], vcc
    s_cbranch_execz adone_prep_kernel_8
    v_lshlrev_b32 v6, 2, v0
    ds_read_b32 v16, v6 offset:0
    ds_read_b32 v17, v6 offset:512
    ds_read_b32 v18, v6 offset:1024
    ds_read_b32 v19, v6 offset:1536
    ds_read_b32 v20, v6 offset:2048
    ds_read_b32 v21, v6 offset:2560
    ds_read_b32 v22, v6 offset:3072
    ds_read_b32 v23, v6 offset:3584
    ds_read_b32 v24, v6 offset:4096
    ds_read_b32 v25, v6 offset:4608
    ds_read_b32 v26, v6 offset:5120
    ds_read_b32 v27, v6 offset:5632
    ds_read_b32 v28, v6 offset:6144
    ds_read_b32 v29, v6 offset:6656
    ds_read_b32 v30, v6 offset:7168
    ds_read_b32 v31, v6 offset:7680
    s_waitcnt lgkmcnt(0)
    v_add_f32 v16, v16, v17
    v_add_f32 v16, v16, v18
    v_add_f32 v16, v16, v19
    v_add_f32 v16, v16, v20
    v_add_f32 v16, v16, v21
    v_add_f32 v16, v16, v22
    v_add_f32 v16, v16, v23
    v_add_f32 v16, v16, v24
    v_add_f32 v16, v16, v25
    v_add_f32 v16, v16, v26
    v_add_f32 v16, v16, v27
    v_add_f32 v16, v16, v28
    v_add_f32 v16, v16, v29
    v_add_f32 v16, v16, v30
    v_add_f32 v16, v16, v31
    s_mul_i32 s29, s31, 5376
    s_add_u32 s29, s29, s27
    v_add_u32 v7, s29, v7
    v_lshlrev_b32 v7, 2, v7
    buffer_store_dword v16, v7, s[12:15], 0 offen
adone_prep_kernel_8:
    s_mov_b64 exec, s[32:33]
    s_branch end_prep_kernel_1
roleb_prep_kernel_2:
    s_cmp_ge_u32 s2, 684
    s_cbranch_scc1 rolec_prep_kernel_3
    s_load_dwordx2 s[4:5], s[0:1], 0
    s_waitcnt lgkmcnt(0)
    s_mov_b32 s8, s4
    s_and_b32 s9, s5, 0xffff
    s_mov_b32 s10, 0x280000
    s_mov_b32 s11, 0x20000
    s_add_u32 s12, s20, 0x8000
    s_addc_u32 s13, s21, 0
    s_and_b32 s13, s13, 0xffff
    s_mov_b32 s14, 0x20000
    s_mov_b32 s15, 0x20000
    s_sub_u32 s24, s2, 172
    s_lshl_b32 s24, s24, 2
    v_lshrrev_b32 v1, 6, v0
    v_and_b32 v2, 63, v0
    v_add_u32 v1, s24, v1
    v_mul_u32_u24 v3, 1280, v1
    v_lshl_add_u32 v4, v2, 3, v3
    v_lshl_add_u32 v5, v2, 2, v3
    buffer_load_dwordx2 v[8:9], v4, s[8:11], 0 offen
    buffer_load_dwordx2 v[10:11], v4, s[8:11], 0 offen offset:512
    buffer_load_dword v12, v5, s[8:11], 0 offen offset:1024
    v_mov_b32 v14, 0
    v_mov_b32 v15, 0
    s_waitcnt vmcnt(0)
    v_lshlrev_b32 v6, 16, v8
    v_and_b32 v7, 0xffff0000, v8
    v_add_f32 v14, v14, v6
    v_fmac_f32 v15, v6, v6
    v_add_f32 v14, v14, v7
    v_fmac_f32 v15, v7, v7
    v_lshlrev_b32 v6, 16, v9
    v_and_b32 v7, 0xffff0000, v9
    v_add_f32 v14, v14, v6
    v_fmac_f32 v15, v6, v6
    v_add_f32 v14, v14, v7
    v_fmac_f32 v15, v7, v7
    v_lshlrev_b32 v6, 16, v10
    v_and_b32 v7, 0xffff0000, v10
    v_add_f32 v14, v14, v6
    v_fmac_f32 v15, v6, v6
    v_add_f32 v14, v14, v7
    v_fmac_f32 v15, v7, v7
    v_lshlrev_b32 v6, 16, v11
    v_and_b32 v7, 0xffff0000, v11
    v_add_f32 v14, v14, v6
    v_fmac_f32 v15, v6, v6
    v_add_f32 v14, v14, v7
    v_fmac_f32 v15, v7, v7
    v_lshlrev_b32 v6, 16, v12
    v_and_b32 v7, 0xffff0000, v12
    v_add_f32 v14, v14, v6
    v_fmac_f32 v15, v6, v6
    v_add_f32 v14, v14, v7
    v_fmac_f32 v15, v7, v7
    v_xor_b32 v6, 1, v2
    v_lshlrev_b32 v6, 2, v6
    ds_bpermute_b32 v16, v6, v14
    ds_bpermute_b32 v17, v6, v15
    s_waitcnt lgkmcnt(0)
    v_add_f32 v14, v14, v16
    v_add_f32 v15, v15, v17
    v_xor_b32 v6, 2, v2
    v_lshlrev_b32 v6, 2, v6
    ds_bpermute_b32 v16, v6, v14
    ds_bpermute_b32 v17, v6, v15
    s_waitcnt lgkmcnt(0)
    v_add_f32 v14, v14, v16
    v_add_f32 v15, v15, v17
    v_xor_b32 v6, 4, v2
    v_lshlrev_b32 v6, 2, v6
    ds_bpermute_b32 v16, v6, v14
    ds_bpermute_b32 v17, v6, v15
    s_waitcnt lgkmcnt(0)
    v_add_f32 v14, v14, v16
    v_add_f32 v15, v15, v17
    v_xor_b32 v6, 8, v2
    v_lshlrev_b32 v6, 2, v6
    ds_bpermute_b32 v16, v6, v14
    ds_bpermute_b32 v17, v6, v15
    s_waitcnt lgkmcnt(0)
    v_add_f32 v14, v14, v16
    v_add_f32 v15, v15, v17
    v_xor_b32 v6, 16, v2
    v_lshlrev_b32 v6, 2, v6
    ds_bpermute_b32 v16, v6, v14
    ds_bpermute_b32 v17, v6, v15
    s_waitcnt lgkmcnt(0)
    v_add_f32 v14, v14, v16
    v_add_f32 v15, v15, v17
    v_xor_b32 v6, 32, v2
    v_lshlrev_b32 v6, 2, v6
    ds_bpermute_b32 v16, v6, v14
    ds_bpermute_b32 v17, v6, v15
    s_waitcnt lgkmcnt(0)
    v_add_f32 v14, v14, v16
    v_add_f32 v15, v15, v17
    v_mov_b32 v16, 0
    v_cmp_eq_u32 vcc, 0, v2
    s_nop 1
    v_cndmask_b32 v16, v16, v14, vcc
    v_cmp_eq_u32 vcc, 1, v2
    s_nop 1
    v_cndmask_b32 v16, v16, v15, vcc
    v_lshlrev_b32 v6, 6, v1
    v_lshl_add_u32 v6, v2, 2, v6
    v_cmp_gt_u32 vcc, 16, v2
    s_and_saveexec_b64 s[32:33], vcc
    s_cbranch_execz bdone_prep_kernel_9
    buffer_store_dword v16, v6, s[12:15], 0 offen
bdone_prep_kernel_9:
    s_mov_b64 exec, s[32:33]
    s_branch end_prep_kernel_1
rolec_prep_kernel_3:
    s_branch roled_prep_kernel_4
    s_waitcnt lgkmcnt(0)
    s_add_u32 s12, s20, 0x100000
    s_addc_u32 s13, s21, 0
    s_and_b32 s13, s13, 0xffff
    s_mov_b32 s14, 0x800000
    s_mov_b32 s15, 0x20000
    s_sub_u32 s24, s2, 684
    s_lshl_b32 s24, s24, 4
    v_lshrrev_b32 v1, 4, v0
    v_add_u32 v1, s24, v1
    v_lshlrev_b32 v1, 11, v1
    v_and_b32 v2, 15, v0
    v_lshl_add_u32 v1, v2, 6, v1
    v_mov_b32 v4, 0
    v_mov_b32 v5, 0
    v_mov_b32 v6, 0
    v_mov_b32 v7, 0
    buffer_store_dwordx4 v[4:7], v1, s[12:15], 0 offen offset:1024
    buffer_store_dwordx4 v[4:7], v1, s[12:15], 0 offen offset:1040
    buffer_store_dwordx4 v[4:7], v1, s[12:15], 0 offen offset:1056
    buffer_store_dwordx4 v[4:7], v1, s[12:15], 0 offen offset:1072
    s_branch end_prep_kernel_1
roled_prep_kernel_4:
    s_cmp_ge_u32 s2, 684
    s_cbranch_scc1 rolee_prep_kernel_10
    s_waitcnt lgkmcnt(0)
    s_add_u32 s12, s20, 0x900000
    s_addc_u32 s13, s21, 0
    s_and_b32 s13, s13, 0xffff
    s_mov_b32 s14, 0x400000
    s_mov_b32 s15, 0x20000
    s_sub_u32 s24, s2, 940
    s_lshl_b32 s24, s24, 5
    v_lshrrev_b32 v1, 3, v0
    v_add_u32 v1, s24, v1
    v_lshlrev_b32 v1, 10, v1
    v_and_b32 v2, 3, v0
    v_mul_u32_u24 v3, 48, v2
    v_add_u32 v1, v1, v3
    v_and_b32 v3, 4, v0
    v_lshl_add_u32 v1, v3, 7, v1
    v_mov_b32 v8, 0x3f803f80
    v_cmp_eq_u32 vcc, 0, v2
    v_mov_b32 v4, 0
    s_nop 1
    v_cndmask_b32 v8, v4, v8, vcc
    v_mov_b32 v9, v8
    v_mov_b32 v10, v8
    v_mov_b32 v11, v8
    v_mov_b32 v5, 0
    v_mov_b32 v6, 0
    v_mov_b32 v7, 0
    buffer_store_dwordx4 v[8:11], v1, s[12:15], 0 offen offset:320
    buffer_store_dwordx4 v[4:7], v1, s[12:15], 0 offen offset:336
    buffer_store_dwordx4 v[4:7], v1, s[12:15], 0 offen offset:352
    s_branch end_prep_kernel_1
rolee_prep_kernel_10:
    s_sub_u32 s24, s2, 684
    s_cmp_ge_u32 s24, 200
    s_cbranch_scc1 rolee2_prep_kernel_11
    s_load_dwordx2 s[4:5], s[0:1], 16
    s_mov_b32 s25, 819200
    s_mov_b32 s26, 0x2000000
    s_mov_b32 s27, 640
    s_branch rolee3_prep_kernel_12
rolee2_prep_kernel_11:
    s_load_dwordx2 s[4:5], s[0:1], 48
    s_sub_u32 s24, s24, 200
    s_mov_b32 s25, 2211840
    s_mov_b32 s26, 0x2100000
    s_mov_b32 s27, 1728
rolee3_prep_kernel_12:
    s_waitcnt lgkmcnt(0)
    s_mov_b32 s8, s4
    s_and_b32 s9, s5, 0xffff
    s_mov_b32 s10, s25
    s_mov_b32 s11, 0x20000
    s_add_u32 s12, s20, s26
    s_addc_u32 s13, s21, 0
    s_and_b32 s13, s13, 0xffff
    s_mov_b32 s14, s25
    s_mov_b32 s15, 0x20000
    s_lshl_b32 s24, s24, 8
    v_add_u32 v1, s24, v0
    v_lshlrev_b32 v2, 4, v1
    buffer_load_dwordx4 v[8:11], v2, s[8:11], 0 offen
    s_mov_b32 s28, 52429
    v_mul_lo_u32 v3, v1, s28
    v_mul_hi_u32 v4, v1, s28
    v_lshrrev_b32 v3, 22, v3
    v_lshl_or_b32 v3, v4, 10, v3
    v_mul_u32_u24 v4, 80, v3
    v_sub_u32 v4, v1, v4
    s_movk_i32 s28, 6554
    v_mul_lo_u32 v5, v4, s28
    v_lshrrev_b32 v5, 16, v5
    v_mul_u32_u24 v6, 10, v5
    v_sub_u32 v6, v4, v6
    v_mul_lo_u32 v5, v5, s27
    v_add_u32 v5, v5, v3
    v_mul_u32_u24 v5, 160, v5
    v_lshl_add_u32 v5, v6, 4, v5
    s_waitcnt vmcnt(0)
    buffer_store_dwordx4 v[8:11], v5, s[12:15], 0 offen
end_prep_kernel_1:
    s_endpgm
.globl attn_kernel
.p2align 8
.type attn_kernel,@function
attn_kernel:
    s_cmp_ge_u32 s2, 256
    s_cbranch_scc1 end_attn_kernel_1
    s_load_dwordx4 s[80:83], s[0:1], 64
    s_and_b32 s3, s2, 31
    s_lshr_b32 s4, s2, 5
    v_and_b32 v1, 63, v0
    v_lshrrev_b32 v2, 6, v0
    s_nop 0
    v_readfirstlane_b32 s5, v2
    s_waitcnt lgkmcnt(0)
    s_add_u32 s8, s82, 0x100000
    s_addc_u32 s9, s83, 0
    s_and_b32 s9, s9, 0xffff
    s_mov_b32 s10, 0xc00000
    s_mov_b32 s11, 0x20000
    s_add_u32 s12, s82, 0xd00000
    s_addc_u32 s13, s83, 0
    s_and_b32 s13, s13, 0xffff
    s_mov_b32 s14, 0x280000
    s_mov_b32 s15, 0x20000
    v_lshlrev_b32 v3, 4, v1
    s_lshl_b32 s20, s3, 17
    s_lshl_b32 s21, s4, 3
    s_add_u32 s21, s21, s5
    s_lshl_b32 s22, s21, 11
    s_add_u32 s22, s22, s20
    buffer_load_dwordx4 v[4:7], v3, s[8:11], s22 offen
    buffer_load_dwordx4 v[8:11], v3, s[8:11], s22 offen offset:1024
    s_lshl_b32 s23, s5, 11
    s_add_u32 s24, s20, s23
    s_add_u32 s25, s24, 0x800000
    s_add_u32 s24, s24, 0x400000
    s_mov_b32 s26, 0
    s_add_u32 s16, s82, 0x30000
    s_addc_u32 s17, s83, 0
    s_and_b32 s17, s17, 0xffff
    s_mov_b32 s18, 0x500
    s_mov_b32 s19, 0x20000
    v_lshlrev_b32 v17, 2, v1
    buffer_load_dword v12, v17, s[16:19], 0 offen offset:0
    buffer_load_dword v13, v17, s[16:19], 0 offen offset:256
    buffer_load_dword v14, v17, s[16:19], 0 offen offset:512
    buffer_load_dword v15, v17, s[16:19], 0 offen offset:768
    buffer_load_dword v16, v17, s[16:19], 0 offen offset:1024
    s_add_u32 m0, s26, s23
    s_nop 0
    buffer_load_dwordx4 v3, s[8:11], s24 offen lds
    buffer_load_dwordx4 v3, s[8:11], s24 offen offset:1024 lds
    s_add_u32 m0, m0, 16384
    s_nop 0
    buffer_load_dwordx4 v3, s[8:11], s25 offen lds
    buffer_load_dwordx4 v3, s[8:11], s25 offen offset:1024 lds
    s_add_u32 s24, s24, 16384
    s_add_u32 s25, s25, 16384
    s_add_u32 s26, s26, 32768
    s_cmp_eq_u32 s26, 98304
    s_cselect_b32 s26, 0, s26
    s_add_u32 m0, s26, s23
    s_nop 0
    buffer_load_dwordx4 v3, s[8:11], s24 offen lds
    buffer_load_dwordx4 v3, s[8:11], s24 offen offset:1024 lds
    s_add_u32 m0, m0, 16384
    s_nop 0
    buffer_load_dwordx4 v3, s[8:11], s25 offen lds
    buffer_load_dwordx4 v3, s[8:11], s25 offen offset:1024 lds
    s_add_u32 s24, s24, 16384
    s_add_u32 s25, s25, 16384
    s_add_u32 s26, s26, 32768
    s_cmp_eq_u32 s26, 98304
    s_cselect_b32 s26, 0, s26
    v_mov_b32 v132, 0x42c80000
    v_mov_b32 v92, 0
    v_mov_b32 v93, 0
    v_mov_b32 v94, 0
    v_mov_b32 v95, 0
    v_mov_b32 v96, 0
    v_mov_b32 v97, 0
    v_mov_b32 v98, 0
    v_mov_b32 v99, 0
    v_mov_b32 v100, 0
    v_mov_b32 v101, 0
    v_mov_b32 v102, 0
    v_mov_b32 v103, 0
    v_mov_b32 v104, 0
    v_mov_b32 v105, 0
    v_mov_b32 v106, 0
    v_mov_b32 v107, 0
    s_mov_b32 s40, -1
    s_mov_b32 s41, 0
    s_mov_b32 s42, 0xfffff
    s_mov_b32 s43, 0xfffff
    v_and_b32 v124, 31, v1
    v_mov_b32 v125, 0x3f803f80
    v_cmp_eq_u32 vcc, 20, v124
    s_nop 1
    v_cndmask_b32 v124, v92, v125, vcc
    v_mov_b32 v24, 0
    v_mov_b32 v25, 0
    v_mov_b32 v26, 0
    v_mov_b32 v27, 0
    v_mov_b32 v36, v124
    v_mov_b32 v37, v124
    v_mov_b32 v38, v124
    v_mov_b32 v39, v124
    v_mov_b32 v40, v124
    v_mov_b32 v41, v124
    v_mov_b32 v42, v124
    v_mov_b32 v43, v124
    v_mov_b32 v32, 0
    v_mov_b32 v33, 0
    v_mov_b32 v34, 0
    v_mov_b32 v35, 0
    v_mov_b32 v44, v124
    v_mov_b32 v45, v124
    v_mov_b32 v46, v124
    v_mov_b32 v47, v124
    v_mov_b32 v48, v124
    v_mov_b32 v49, v124
    v_mov_b32 v50, v124
    v_mov_b32 v51, v124
    s_mov_b32 s27, 0
    s_mov_b32 s28, 32768
    v_mov_b32 v130, v3
    v_add_u32 v131, s28, v3
    s_waitcnt vmcnt(8)
    v_mov_b32 v10, 0
    v_mov_b32 v11, 0
    v_cmp_gt_u32 vcc, 32, v1
    s_nop 1
    v_cndmask_b32 v8, v10, v8, vcc
    v_cndmask_b32 v9, v10, v9, vcc
    v_max3_f32 v12, v12, v13, v14
    v_max3_f32 v12, v12, v15, v16
    v_xor_b32 v13, 1, v1
    v_lshlrev_b32 v13, 2, v13
    ds_bpermute_b32 v14, v13, v12
    s_waitcnt lgkmcnt(0)
    v_max_f32 v12, v12, v14
    v_xor_b32 v13, 2, v1
    v_lshlrev_b32 v13, 2, v13
    ds_bpermute_b32 v14, v13, v12
    s_waitcnt lgkmcnt(0)
    v_max_f32 v12, v12, v14
    v_xor_b32 v13, 4, v1
    v_lshlrev_b32 v13, 2, v13
    ds_bpermute_b32 v14, v13, v12
    s_waitcnt lgkmcnt(0)
    v_max_f32 v12, v12, v14
    v_xor_b32 v13, 8, v1
    v_lshlrev_b32 v13, 2, v13
    ds_bpermute_b32 v14, v13, v12
    s_waitcnt lgkmcnt(0)
    v_max_f32 v12, v12, v14
    v_xor_b32 v13, 16, v1
    v_lshlrev_b32 v13, 2, v13
    ds_bpermute_b32 v14, v13, v12
    s_waitcnt lgkmcnt(0)
    v_max_f32 v12, v12, v14
    v_xor_b32 v13, 32, v1
    v_lshlrev_b32 v13, 2, v13
    ds_bpermute_b32 v14, v13, v12
    s_waitcnt lgkmcnt(0)
    v_max_f32 v12, v12, v14
    v_mov_b32 v13, 0
    v_lshlrev_b32 v14, 16, v4
    v_and_b32 v15, 0xffff0000, v4
    v_add_f32 v13, v13, abs(v14)
    v_add_f32 v13, v13, abs(v15)
    v_lshlrev_b32 v14, 16, v5
    v_and_b32 v15, 0xffff0000, v5
    v_add_f32 v13, v13, abs(v14)
    v_add_f32 v13, v13, abs(v15)
    v_lshlrev_b32 v14, 16, v6
    v_and_b32 v15, 0xffff0000, v6
    v_add_f32 v13, v13, abs(v14)
    v_add_f32 v13, v13, abs(v15)
    v_lshlrev_b32 v14, 16, v7
    v_and_b32 v15, 0xffff0000, v7
    v_add_f32 v13, v13, abs(v14)
    v_add_f32 v13, v13, abs(v15)
    v_lshlrev_b32 v14, 16, v8
    v_and_b32 v15, 0xffff0000, v8
    v_add_f32 v13, v13, abs(v14)
    v_add_f32 v13, v13, abs(v15)
    v_lshlrev_b32 v14, 16, v9
    v_and_b32 v15, 0xffff0000, v9
    v_add_f32 v13, v13, abs(v14)
    v_add_f32 v13, v13, abs(v15)
    v_lshlrev_b32 v14, 16, v10
    v_and_b32 v15, 0xffff0000, v10
    v_add_f32 v13, v13, abs(v14)
    v_add_f32 v13, v13, abs(v15)
    v_lshlrev_b32 v14, 16, v11
    v_and_b32 v15, 0xffff0000, v11
    v_add_f32 v13, v13, abs(v14)
    v_add_f32 v13, v13, abs(v15)
    v_mov_b32 v14, v13
    s_nop 1
    v_permlane32_swap_b32 v13, v14
    v_add_f32 v13, v13, v14
    v_mul_f32 v12, v12, v13
    v_mul_f32 v12, 0x3f828f5c, v12
    s_waitcnt vmcnt(4)
    s_barrier
    ds_read_b128 v[20:23], v130 offset:0
    s_mov_b64 exec, s[40:41]
    ds_read_b64 v[24:25], v130 offset:1024
    s_mov_b64 exec, -1
    s_waitcnt lgkmcnt(0)
    v_mfma_f32_32x32x16_bf16 v[52:67], v[20:23], v[4:7], 0
    v_mfma_f32_32x32x16_bf16 v[52:67], v[24:27], v[8:11], v[52:67]
    ds_read_b128 v[28:31], v130 offset:2048
    s_mov_b64 exec, s[40:41]
    ds_read_b64 v[32:33], v130 offset:3072
    s_mov_b64 exec, -1
    s_nop 7
    s_nop 7
    v_max3_f32 v124, v52, v53, v54
    v_max3_f32 v125, v55, v56, v57
    v_max3_f32 v126, v58, v59, v60
    v_max3_f32 v127, v61, v62, v63
    v_max3_f32 v128, v64, v65, v66
    v_max3_f32 v124, v124, v125, v126
    v_max3_f32 v127, v127, v128, v67
    v_max_f32 v124, v124, v127
    v_mov_b32 v125, v124
    s_nop 1
    v_permlane32_swap_b32 v124, v125
    v_max_f32 v124, v124, v125
    v_sub_f32 v108, 0, v124
    v_sub_f32 v109, 0, v124
    v_sub_f32 v110, 0, v124
    v_sub_f32 v111, 0, v124
    v_sub_f32 v112, 0, v124
    v_sub_f32 v113, 0, v124
    v_sub_f32 v114, 0, v124
    v_sub_f32 v115, 0, v124
    v_sub_f32 v116, 0, v124
    v_sub_f32 v117, 0, v124
    v_sub_f32 v118, 0, v124
    v_sub_f32 v119, 0, v124
    v_sub_f32 v120, 0, v124
    v_sub_f32 v121, 0, v124
    v_sub_f32 v122, 0, v124
    v_sub_f32 v123, 0, v124
    v_sub_f32 v52, v52, v124
    v_sub_f32 v53, v53, v124
    v_sub_f32 v54, v54, v124
    v_sub_f32 v55, v55, v124
    v_sub_f32 v56, v56, v124
    v_sub_f32 v57, v57, v124
    v_sub_f32 v58, v58, v124
    v_sub_f32 v59, v59, v124
    v_sub_f32 v60, v60, v124
    v_sub_f32 v61, v61, v124
    v_sub_f32 v62, v62, v124
    v_sub_f32 v63, v63, v124
    v_sub_f32 v64, v64, v124
    v_sub_f32 v65, v65, v124
    v_sub_f32 v66, v66, v124
    v_sub_f32 v67, v67, v124
    v_sub_f32 v12, v12, v124
    v_cmp_nle_f32 vcc, v12, v132
    s_waitcnt lgkmcnt(0)
    s_mov_b32 s29, 8
    v_mov_b32 v84, 0
    v_mov_b32 v85, 0
    v_mov_b32 v86, 0
    v_mov_b32 v87, 0
    v_mov_b32 v88, 0
    v_mov_b32 v89, 0
    v_mov_b32 v90, 0
    v_mov_b32 v91, 0
INIT_attn_kernel_4:
    s_cbranch_vccnz generic_attn_kernel_2
chunk_attn_kernel_5:
    s_waitcnt vmcnt(0)
    s_barrier
    s_cmp_le_u32 s29, 2
    s_cbranch_scc1 nodma_attn_kernel_6
    s_add_u32 m0, s26, s23
    s_nop 0
    buffer_load_dwordx4 v3, s[8:11], s24 offen lds
    buffer_load_dwordx4 v3, s[8:11], s24 offen offset:1024 lds
    s_add_u32 m0, m0, 16384
    s_nop 0
    buffer_load_dwordx4 v3, s[8:11], s25 offen lds
    buffer_load_dwordx4 v3, s[8:11], s25 offen offset:1024 lds
    s_add_u32 s24, s24, 16384
    s_add_u32 s25, s25, 16384
    s_add_u32 s26, s26, 32768
    s_cmp_eq_u32 s26, 98304
    s_cselect_b32 s26, 0, s26
nodma_attn_kernel_6:
    ds_read_b128 v[20:23], v130 offset:4096
    s_mov_b64 exec, s[40:41]
    ds_read_b64 v[24:25], v130 offset:5120
    s_mov_b64 exec, -1
    s_mov_b64 exec, s[42:43]
    ds_read_b128 v[36:39], v130 offset:16384
    ds_read_b128 v[40:43], v130 offset:17408
    s_mov_b64 exec, -1
    v_mfma_f32_32x32x16_bf16 v[92:107], v[44:47], v[84:87], v[92:107]
    v_exp_f32 v52, v52
    v_exp_f32 v53, v53
    v_exp_f32 v54, v54
    v_exp_f32 v55, v55
    v_mfma_f32_32x32x16_bf16 v[92:107], v[48:51], v[88:91], v[92:107]
    v_exp_f32 v56, v56
    v_exp_f32 v57, v57
    v_exp_f32 v58, v58
    v_exp_f32 v59, v59
    v_mfma_f32_32x32x16_bf16 v[68:83], v[28:31], v[4:7], v[108:123]
    v_exp_f32 v60, v60
    v_exp_f32 v61, v61
    v_exp_f32 v62, v62
    v_exp_f32 v63, v63
    v_mfma_f32_32x32x16_bf16 v[68:83], v[32:35], v[8:11], v[68:83]
    v_exp_f32 v64, v64
    v_exp_f32 v65, v65
    v_exp_f32 v66, v66
    v_exp_f32 v67, v67
    s_nop 0
    v_cvt_pk_bf16_f32 v84, v52, v53
    v_cvt_pk_bf16_f32 v85, v54, v55
    v_cvt_pk_bf16_f32 v86, v56, v57
    v_cvt_pk_bf16_f32 v87, v58, v59
    v_cvt_pk_bf16_f32 v88, v60, v61
    v_cvt_pk_bf16_f32 v89, v62, v63
    v_cvt_pk_bf16_f32 v90, v64, v65
    v_cvt_pk_bf16_f32 v91, v66, v67
    s_waitcnt lgkmcnt(0)
    s_nop 0
    ds_read_b128 v[28:31], v130 offset:6144
    s_mov_b64 exec, s[40:41]
    ds_read_b64 v[32:33], v130 offset:7168
    s_mov_b64 exec, -1
    s_mov_b64 exec, s[42:43]
    ds_read_b128 v[44:47], v130 offset:18432
    ds_read_b128 v[48:51], v130 offset:19456
    s_mov_b64 exec, -1
    v_mfma_f32_32x32x16_bf16 v[92:107], v[36:39], v[84:87], v[92:107]
    v_exp_f32 v68, v68
    v_exp_f32 v69, v69
    v_exp_f32 v70, v70
    v_exp_f32 v71, v71
    v_mfma_f32_32x32x16_bf16 v[92:107], v[40:43], v[88:91], v[92:107]
    v_exp_f32 v72, v72
    v_exp_f32 v73, v73
    v_exp_f32 v74, v74
    v_exp_f32 v75, v75
    v_mfma_f32_32x32x16_bf16 v[52:67], v[20:23], v[4:7], v[108:123]
    v_exp_f32 v76, v76
    v_exp_f32 v77, v77
    v_exp_f32 v78, v78
    v_exp_f32 v79, v79
    v_mfma_f32_32x32x16_bf16 v[52:67], v[24:27], v[8:11], v[52:67]
    v_exp_f32 v80, v80
    v_exp_f32 v81, v81
    v_exp_f32 v82, v82
    v_exp_f32 v83, v83
    s_nop 0
    v_cvt_pk_bf16_f32 v84, v68, v69
    v_cvt_pk_bf16_f32 v85, v70, v71
    v_cvt_pk_bf16_f32 v86, v72, v73
    v_cvt_pk_bf16_f32 v87, v74, v75
    v_cvt_pk_bf16_f32 v88, v76, v77
    v_cvt_pk_bf16_f32 v89, v78, v79
    v_cvt_pk_bf16_f32 v90, v80, v81
    v_cvt_pk_bf16_f32 v91, v82, v83
    s_waitcnt lgkmcnt(0)
    s_nop 0
    ds_read_b128 v[20:23], v130 offset:8192
    s_mov_b64 exec, s[40:41]
    ds_read_b64 v[24:25], v130 offset:9216
    s_mov_b64 exec, -1
    s_mov_b64 exec, s[42:43]
    ds_read_b128 v[36:39], v130 offset:20480
    ds_read_b128 v[40:43], v130 offset:21504
    s_mov_b64 exec, -1
    v_mfma_f32_32x32x16_bf16 v[92:107], v[44:47], v[84:87], v[92:107]
    v_exp_f32 v52, v52
    v_exp_f32 v53, v53
    v_exp_f32 v54, v54
    v_exp_f32 v55, v55
    v_mfma_f32_32x32x16_bf16 v[92:107], v[48:51], v[88:91], v[92:107]
    v_exp_f32 v56, v56
    v_exp_f32 v57, v57
    v_exp_f32 v58, v58
    v_exp_f32 v59, v59
    v_mfma_f32_32x32x16_bf16 v[68:83], v[28:31], v[4:7], v[108:123]
    v_exp_f32 v60, v60
    v_exp_f32 v61, v61
    v_exp_f32 v62, v62
    v_exp_f32 v63, v63
    v_mfma_f32_32x32x16_bf16 v[68:83], v[32:35], v[8:11], v[68:83]
    v_exp_f32 v64, v64
    v_exp_f32 v65, v65
    v_exp_f32 v66, v66
    v_exp_f32 v67, v67
    s_nop 0
    v_cvt_pk_bf16_f32 v84, v52, v53
    v_cvt_pk_bf16_f32 v85, v54, v55
    v_cvt_pk_bf16_f32 v86, v56, v57
    v_cvt_pk_bf16_f32 v87, v58, v59
    v_cvt_pk_bf16_f32 v88, v60, v61
    v_cvt_pk_bf16_f32 v89, v62, v63
    v_cvt_pk_bf16_f32 v90, v64, v65
    v_cvt_pk_bf16_f32 v91, v66, v67
    s_waitcnt lgkmcnt(0)
    s_nop 0
    ds_read_b128 v[28:31], v130 offset:10240
    s_mov_b64 exec, s[40:41]
    ds_read_b64 v[32:33], v130 offset:11264
    s_mov_b64 exec, -1
    s_mov_b64 exec, s[42:43]
    ds_read_b128 v[44:47], v130 offset:22528
    ds_read_b128 v[48:51], v130 offset:23552
    s_mov_b64 exec, -1
    v_mfma_f32_32x32x16_bf16 v[92:107], v[36:39], v[84:87], v[92:107]
    v_exp_f32 v68, v68
    v_exp_f32 v69, v69
    v_exp_f32 v70, v70
    v_exp_f32 v71, v71
    v_mfma_f32_32x32x16_bf16 v[92:107], v[40:43], v[88:91], v[92:107]
    v_exp_f32 v72, v72
    v_exp_f32 v73, v73
    v_exp_f32 v74, v74
    v_exp_f32 v75, v75
    v_mfma_f32_32x32x16_bf16 v[52:67], v[20:23], v[4:7], v[108:123]
    v_exp_f32 v76, v76
    v_exp_f32 v77, v77
    v_exp_f32 v78, v78
    v_exp_f32 v79, v79
    v_mfma_f32_32x32x16_bf16 v[52:67], v[24:27], v[8:11], v[52:67]
    v_exp_f32 v80, v80
    v_exp_f32 v81, v81
    v_exp_f32 v82, v82
    v_exp_f32 v83, v83
    s_nop 0
    v_cvt_pk_bf16_f32 v84, v68, v69
    v_cvt_pk_bf16_f32 v85, v70, v71
    v_cvt_pk_bf16_f32 v86, v72, v73
    v_cvt_pk_bf16_f32 v87, v74, v75
    v_cvt_pk_bf16_f32 v88, v76, v77
    v_cvt_pk_bf16_f32 v89, v78, v79
    v_cvt_pk_bf16_f32 v90, v80, v81
    v_cvt_pk_bf16_f32 v91, v82, v83
    s_waitcnt lgkmcnt(0)
    s_nop 0
    ds_read_b128 v[20:23], v130 offset:12288
    s_mov_b64 exec, s[40:41]
    ds_read_b64 v[24:25], v130 offset:13312
    s_mov_b64 exec, -1
    s_mov_b64 exec, s[42:43]
    ds_read_b128 v[36:39], v130 offset:24576
    ds_read_b128 v[40:43], v130 offset:25600
    s_mov_b64 exec, -1
    v_mfma_f32_32x32x16_bf16 v[92:107], v[44:47], v[84:87], v[92:107]
    v_exp_f32 v52, v52
    v_exp_f32 v53, v53
    v_exp_f32 v54, v54
    v_exp_f32 v55, v55
    v_mfma_f32_32x32x16_bf16 v[92:107], v[48:51], v[88:91], v[92:107]
    v_exp_f32 v56, v56
    v_exp_f32 v57, v57
    v_exp_f32 v58, v58
    v_exp_f32 v59, v59
    v_mfma_f32_32x32x16_bf16 v[68:83], v[28:31], v[4:7], v[108:123]
    v_exp_f32 v60, v60
    v_exp_f32 v61, v61
    v_exp_f32 v62, v62
    v_exp_f32 v63, v63
    v_mfma_f32_32x32x16_bf16 v[68:83], v[32:35], v[8:11], v[68:83]
    v_exp_f32 v64, v64
    v_exp_f32 v65, v65
    v_exp_f32 v66, v66
    v_exp_f32 v67, v67
    s_nop 0
    v_cvt_pk_bf16_f32 v84, v52, v53
    v_cvt_pk_bf16_f32 v85, v54, v55
    v_cvt_pk_bf16_f32 v86, v56, v57
    v_cvt_pk_bf16_f32 v87, v58, v59
    v_cvt_pk_bf16_f32 v88, v60, v61
    v_cvt_pk_bf16_f32 v89, v62, v63
    v_cvt_pk_bf16_f32 v90, v64, v65
    v_cvt_pk_bf16_f32 v91, v66, v67
    s_waitcnt lgkmcnt(0)
    s_nop 0
    ds_read_b128 v[28:31], v130 offset:14336
    s_mov_b64 exec, s[40:41]
    ds_read_b64 v[32:33], v130 offset:15360
    s_mov_b64 exec, -1
    s_mov_b64 exec, s[42:43]
    ds_read_b128 v[44:47], v130 offset:26624
    ds_read_b128 v[48:51], v130 offset:27648
    s_mov_b64 exec, -1
    v_mfma_f32_32x32x16_bf16 v[92:107], v[36:39], v[84:87], v[92:107]
    v_exp_f32 v68, v68
    v_exp_f32 v69, v69
    v_exp_f32 v70, v70
    v_exp_f32 v71, v71
    v_mfma_f32_32x32x16_bf16 v[92:107], v[40:43], v[88:91], v[92:107]
    v_exp_f32 v72, v72
    v_exp_f32 v73, v73
    v_exp_f32 v74, v74
    v_exp_f32 v75, v75
    v_mfma_f32_32x32x16_bf16 v[52:67], v[20:23], v[4:7], v[108:123]
    v_exp_f32 v76, v76
    v_exp_f32 v77, v77
    v_exp_f32 v78, v78
    v_exp_f32 v79, v79
    v_mfma_f32_32x32x16_bf16 v[52:67], v[24:27], v[8:11], v[52:67]
    v_exp_f32 v80, v80
    v_exp_f32 v81, v81
    v_exp_f32 v82, v82
    v_exp_f32 v83, v83
    s_nop 0
    v_cvt_pk_bf16_f32 v84, v68, v69
    v_cvt_pk_bf16_f32 v85, v70, v71
    v_cvt_pk_bf16_f32 v86, v72, v73
    v_cvt_pk_bf16_f32 v87, v74, v75
    v_cvt_pk_bf16_f32 v88, v76, v77
    v_cvt_pk_bf16_f32 v89, v78, v79
    v_cvt_pk_bf16_f32 v90, v80, v81
    v_cvt_pk_bf16_f32 v91, v82, v83
    s_waitcnt lgkmcnt(0)
    s_nop 0
    ds_read_b128 v[20:23], v131 offset:0
    s_mov_b64 exec, s[40:41]
    ds_read_b64 v[24:25], v131 offset:1024
    s_mov_b64 exec, -1
    s_mov_b64 exec, s[42:43]
    ds_read_b128 v[36:39], v130 offset:28672
    ds_read_b128 v[40:43], v130 offset:29696
    s_mov_b64 exec, -1
    v_mfma_f32_32x32x16_bf16 v[92:107], v[44:47], v[84:87], v[92:107]
    v_exp_f32 v52, v52
    v_exp_f32 v53, v53
    v_exp_f32 v54, v54
    v_exp_f32 v55, v55
    v_mfma_f32_32x32x16_bf16 v[92:107], v[48:51], v[88:91], v[92:107]
    v_exp_f32 v56, v56
    v_exp_f32 v57, v57
    v_exp_f32 v58, v58
    v_exp_f32 v59, v59
    v_mfma_f32_32x32x16_bf16 v[68:83], v[28:31], v[4:7], v[108:123]
    v_exp_f32 v60, v60
    v_exp_f32 v61, v61
    v_exp_f32 v62, v62
    v_exp_f32 v63, v63
    v_mfma_f32_32x32x16_bf16 v[68:83], v[32:35], v[8:11], v[68:83]
    v_exp_f32 v64, v64
    v_exp_f32 v65, v65
    v_exp_f32 v66, v66
    v_exp_f32 v67, v67
    s_nop 0
    v_cvt_pk_bf16_f32 v84, v52, v53
    v_cvt_pk_bf16_f32 v85, v54, v55
    v_cvt_pk_bf16_f32 v86, v56, v57
    v_cvt_pk_bf16_f32 v87, v58, v59
    v_cvt_pk_bf16_f32 v88, v60, v61
    v_cvt_pk_bf16_f32 v89, v62, v63
    v_cvt_pk_bf16_f32 v90, v64, v65
    v_cvt_pk_bf16_f32 v91, v66, v67
    s_waitcnt lgkmcnt(0)
    s_nop 0
    ds_read_b128 v[28:31], v131 offset:2048
    s_mov_b64 exec, s[40:41]
    ds_read_b64 v[32:33], v131 offset:3072
    s_mov_b64 exec, -1
    s_mov_b64 exec, s[42:43]
    ds_read_b128 v[44:47], v130 offset:30720
    ds_read_b128 v[48:51], v130 offset:31744
    s_mov_b64 exec, -1
    v_mfma_f32_32x32x16_bf16 v[92:107], v[36:39], v[84:87], v[92:107]
    v_exp_f32 v68, v68
    v_exp_f32 v69, v69
    v_exp_f32 v70, v70
    v_exp_f32 v71, v71
    v_mfma_f32_32x32x16_bf16 v[92:107], v[40:43], v[88:91], v[92:107]
    v_exp_f32 v72, v72
    v_exp_f32 v73, v73
    v_exp_f32 v74, v74
    v_exp_f32 v75, v75
    v_mfma_f32_32x32x16_bf16 v[52:67], v[20:23], v[4:7], v[108:123]
    v_exp_f32 v76, v76
    v_exp_f32 v77, v77
    v_exp_f32 v78, v78
    v_exp_f32 v79, v79
    v_mfma_f32_32x32x16_bf16 v[52:67], v[24:27], v[8:11], v[52:67]
    v_exp_f32 v80, v80
    v_exp_f32 v81, v81
    v_exp_f32 v82, v82
    v_exp_f32 v83, v83
    s_nop 0
    v_cvt_pk_bf16_f32 v84, v68, v69
    v_cvt_pk_bf16_f32 v85, v70, v71
    v_cvt_pk_bf16_f32 v86, v72, v73
    v_cvt_pk_bf16_f32 v87, v74, v75
    v_cvt_pk_bf16_f32 v88, v76, v77
    v_cvt_pk_bf16_f32 v89, v78, v79
    v_cvt_pk_bf16_f32 v90, v80, v81
    v_cvt_pk_bf16_f32 v91, v82, v83
    s_waitcnt lgkmcnt(0)
    s_nop 0
    s_mov_b32 s27, s28
    s_add_u32 s28, s28, 32768
    s_cmp_eq_u32 s28, 98304
    s_cselect_b32 s28, 0, s28
    v_add_u32 v130, s27, v3
    v_add_u32 v131, s28, v3
    s_sub_u32 s29, s29, 1
    s_cmp_lg_u32 s29, 0
    s_cbranch_scc1 chunk_attn_kernel_5
    s_branch fin_attn_kernel_3
generic_attn_kernel_2:
chunk_attn_kernel_7:
    s_waitcnt vmcnt(0)
    s_barrier
    s_cmp_le_u32 s29, 2
    s_cbranch_scc1 nodma_attn_kernel_8
    s_add_u32 m0, s26, s23
    s_nop 0
    buffer_load_dwordx4 v3, s[8:11], s24 offen lds
    buffer_load_dwordx4 v3, s[8:11], s24 offen offset:1024 lds
    s_add_u32 m0, m0, 16384
    s_nop 0
    buffer_load_dwordx4 v3, s[8:11], s25 offen lds
    buffer_load_dwordx4 v3, s[8:11], s25 offen offset:1024 lds
    s_add_u32 s24, s24, 16384
    s_add_u32 s25, s25, 16384
    s_add_u32 s26, s26, 32768
    s_cmp_eq_u32 s26, 98304
    s_cselect_b32 s26, 0, s26
nodma_attn_kernel_8:
    ds_read_b128 v[20:23], v130 offset:4096
    s_mov_b64 exec, s[40:41]
    ds_read_b64 v[24:25], v130 offset:5120
    s_mov_b64 exec, -1
    s_mov_b64 exec, s[42:43]
    ds_read_b128 v[36:39], v130 offset:16384
    ds_read_b128 v[40:43], v130 offset:17408
    s_mov_b64 exec, -1
    v_mfma_f32_32x32x16_bf16 v[92:107], v[44:47], v[84:87], v[92:107]
    v_max3_f32 v124, v52, v53, v54
    v_max3_f32 v125, v55, v56, v57
    v_max3_f32 v126, v58, v59, v60
    v_max3_f32 v127, v61, v62, v63
    v_mfma_f32_32x32x16_bf16 v[92:107], v[48:51], v[88:91], v[92:107]
    v_max3_f32 v128, v64, v65, v66
    v_max3_f32 v124, v124, v125, v126
    v_max3_f32 v127, v127, v128, v67
    v_max_f32 v124, v124, v127
    v_mfma_f32_32x32x16_bf16 v[68:83], v[28:31], v[4:7], v[108:123]
    v_cmp_lt_f32 vcc, 0x41000000, v124
    v_mfma_f32_32x32x16_bf16 v[68:83], v[32:35], v[8:11], v[68:83]
    s_nop 4
    s_cbranch_vccnz slow_attn_kernel_9
back_attn_kernel_10:
    v_exp_f32 v52, v52
    v_exp_f32 v53, v53
    v_exp_f32 v54, v54
    v_exp_f32 v55, v55
    v_exp_f32 v56, v56
    v_exp_f32 v57, v57
    v_exp_f32 v58, v58
    v_exp_f32 v59, v59
    v_exp_f32 v60, v60
    v_exp_f32 v61, v61
    v_exp_f32 v62, v62
    v_exp_f32 v63, v63
    v_exp_f32 v64, v64
    v_exp_f32 v65, v65
    v_exp_f32 v66, v66
    v_exp_f32 v67, v67
    s_nop 0
    v_cvt_pk_bf16_f32 v84, v52, v53
    v_cvt_pk_bf16_f32 v85, v54, v55
    v_cvt_pk_bf16_f32 v86, v56, v57
    v_cvt_pk_bf16_f32 v87, v58, v59
    v_cvt_pk_bf16_f32 v88, v60, v61
    v_cvt_pk_bf16_f32 v89, v62, v63
    v_cvt_pk_bf16_f32 v90, v64, v65
    v_cvt_pk_bf16_f32 v91, v66, v67
    s_waitcnt lgkmcnt(0)
    s_nop 0
    ds_read_b128 v[28:31], v130 offset:6144
    s_mov_b64 exec, s[40:41]
    ds_read_b64 v[32:33], v130 offset:7168
    s_mov_b64 exec, -1
    s_mov_b64 exec, s[42:43]
    ds_read_b128 v[44:47], v130 offset:18432
    ds_read_b128 v[48:51], v130 offset:19456
    s_mov_b64 exec, -1
    v_mfma_f32_32x32x16_bf16 v[92:107], v[36:39], v[84:87], v[92:107]
    v_max3_f32 v124, v68, v69, v70
    v_max3_f32 v125, v71, v72, v73
    v_max3_f32 v126, v74, v75, v76
    v_max3_f32 v127, v77, v78, v79
    v_mfma_f32_32x32x16_bf16 v[92:107], v[40:43], v[88:91], v[92:107]
    v_max3_f32 v128, v80, v81, v82
    v_max3_f32 v124, v124, v125, v126
    v_max3_f32 v127, v127, v128, v83
    v_max_f32 v124, v124, v127
    v_mfma_f32_32x32x16_bf16 v[52:67], v[20:23], v[4:7], v[108:123]
    v_cmp_lt_f32 vcc, 0x41000000, v124
    v_mfma_f32_32x32x16_bf16 v[52:67], v[24:27], v[8:11], v[52:67]
    s_nop 4
    s_cbranch_vccnz slow_attn_kernel_11
back_attn_kernel_12:
    v_exp_f32 v68, v68
    v_exp_f32 v69, v69
    v_exp_f32 v70, v70
    v_exp_f32 v71, v71
    v_exp_f32 v72, v72
    v_exp_f32 v73, v73
    v_exp_f32 v74, v74
    v_exp_f32 v75, v75
    v_exp_f32 v76, v76
    v_exp_f32 v77, v77
    v_exp_f32 v78, v78
    v_exp_f32 v79, v79
    v_exp_f32 v80, v80
    v_exp_f32 v81, v81
    v_exp_f32 v82, v82
    v_exp_f32 v83, v83
    s_nop 0
    v_cvt_pk_bf16_f32 v84, v68, v69
    v_cvt_pk_bf16_f32 v85, v70, v71
    v_cvt_pk_bf16_f32 v86, v72, v73
    v_cvt_pk_bf16_f32 v87, v74, v75
    v_cvt_pk_bf16_f32 v88, v76, v77
    v_cvt_pk_bf16_f32 v89, v78, v79
    v_cvt_pk_bf16_f32 v90, v80, v81
    v_cvt_pk_bf16_f32 v91, v82, v83
    s_waitcnt lgkmcnt(0)
    s_nop 0
    ds_read_b128 v[20:23], v130 offset:8192
    s_mov_b64 exec, s[40:41]
    ds_read_b64 v[24:25], v130 offset:9216
    s_mov_b64 exec, -1
    s_mov_b64 exec, s[42:43]
    ds_read_b128 v[36:39], v130 offset:20480
    ds_read_b128 v[40:43], v130 offset:21504
    s_mov_b64 exec, -1
    v_mfma_f32_32x32x16_bf16 v[92:107], v[44:47], v[84:87], v[92:107]
    v_max3_f32 v124, v52, v53, v54
    v_max3_f32 v125, v55, v56, v57
    v_max3_f32 v126, v58, v59, v60
    v_max3_f32 v127, v61, v62, v63
    v_mfma_f32_32x32x16_bf16 v[92:107], v[48:51], v[88:91], v[92:107]
    v_max3_f32 v128, v64, v65, v66
    v_max3_f32 v124, v124, v125, v126
    v_max3_f32 v127, v127, v128, v67
    v_max_f32 v124, v124, v127
    v_mfma_f32_32x32x16_bf16 v[68:83], v[28:31], v[4:7], v[108:123]
    v_cmp_lt_f32 vcc, 0x41000000, v124
    v_mfma_f32_32x32x16_bf16 v[68:83], v[32:35], v[8:11], v[68:83]
    s_nop 4
    s_cbranch_vccnz slow_attn_kernel_13
back_attn_kernel_14:
    v_exp_f32 v52, v52
    v_exp_f32 v53, v53
    v_exp_f32 v54, v54
    v_exp_f32 v55, v55
    v_exp_f32 v56, v56
    v_exp_f32 v57, v57
    v_exp_f32 v58, v58
    v_exp_f32 v59, v59
    v_exp_f32 v60, v60
    v_exp_f32 v61, v61
    v_exp_f32 v62, v62
    v_exp_f32 v63, v63
    v_exp_f32 v64, v64
    v_exp_f32 v65, v65
    v_exp_f32 v66, v66
    v_exp_f32 v67, v67
    s_nop 0
    v_cvt_pk_bf16_f32 v84, v52, v53
    v_cvt_pk_bf16_f32 v85, v54, v55
    v_cvt_pk_bf16_f32 v86, v56, v57
    v_cvt_pk_bf16_f32 v87, v58, v59
    v_cvt_pk_bf16_f32 v88, v60, v61
    v_cvt_pk_bf16_f32 v89, v62, v63
    v_cvt_pk_bf16_f32 v90, v64, v65
    v_cvt_pk_bf16_f32 v91, v66, v67
    s_waitcnt lgkmcnt(0)
    s_nop 0
    ds_read_b128 v[28:31], v130 offset:10240
    s_mov_b64 exec, s[40:41]
    ds_read_b64 v[32:33], v130 offset:11264
    s_mov_b64 exec, -1
    s_mov_b64 exec, s[42:43]
    ds_read_b128 v[44:47], v130 offset:22528
    ds_read_b128 v[48:51], v130 offset:23552
    s_mov_b64 exec, -1
    v_mfma_f32_32x32x16_bf16 v[92:107], v[36:39], v[84:87], v[92:107]
    v_max3_f32 v124, v68, v69, v70
    v_max3_f32 v125, v71, v72, v73
    v_max3_f32 v126, v74, v75, v76
    v_max3_f32 v127, v77, v78, v79
    v_mfma_f32_32x32x16_bf16 v[92:107], v[40:43], v[88:91], v[92:107]
    v_max3_f32 v128, v80, v81, v82
    v_max3_f32 v124, v124, v125, v126
    v_max3_f32 v127, v127, v128, v83
    v_max_f32 v124, v124, v127
    v_mfma_f32_32x32x16_bf16 v[52:67], v[20:23], v[4:7], v[108:123]
    v_cmp_lt_f32 vcc, 0x41000000, v124
    v_mfma_f32_32x32x16_bf16 v[52:67], v[24:27], v[8:11], v[52:67]
    s_nop 4
    s_cbranch_vccnz slow_attn_kernel_15
back_attn_kernel_16:
    v_exp_f32 v68, v68
    v_exp_f32 v69, v69
    v_exp_f32 v70, v70
    v_exp_f32 v71, v71
    v_exp_f32 v72, v72
    v_exp_f32 v73, v73
    v_exp_f32 v74, v74
    v_exp_f32 v75, v75
    v_exp_f32 v76, v76
    v_exp_f32 v77, v77
    v_exp_f32 v78, v78
    v_exp_f32 v79, v79
    v_exp_f32 v80, v80
    v_exp_f32 v81, v81
    v_exp_f32 v82, v82
    v_exp_f32 v83, v83
    s_nop 0
    v_cvt_pk_bf16_f32 v84, v68, v69
    v_cvt_pk_bf16_f32 v85, v70, v71
    v_cvt_pk_bf16_f32 v86, v72, v73
    v_cvt_pk_bf16_f32 v87, v74, v75
    v_cvt_pk_bf16_f32 v88, v76, v77
    v_cvt_pk_bf16_f32 v89, v78, v79
    v_cvt_pk_bf16_f32 v90, v80, v81
    v_cvt_pk_bf16_f32 v91, v82, v83
    s_waitcnt lgkmcnt(0)
    s_nop 0
    ds_read_b128 v[20:23], v130 offset:12288
    s_mov_b64 exec, s[40:41]
    ds_read_b64 v[24:25], v130 offset:13312
    s_mov_b64 exec, -1
    s_mov_b64 exec, s[42:43]
    ds_read_b128 v[36:39], v130 offset:24576
    ds_read_b128 v[40:43], v130 offset:25600
    s_mov_b64 exec, -1
    v_mfma_f32_32x32x16_bf16 v[92:107], v[44:47], v[84:87], v[92:107]
    v_max3_f32 v124, v52, v53, v54
    v_max3_f32 v125, v55, v56, v57
    v_max3_f32 v126, v58, v59, v60
    v_max3_f32 v127, v61, v62, v63
    v_mfma_f32_32x32x16_bf16 v[92:107], v[48:51], v[88:91], v[92:107]
    v_max3_f32 v128, v64, v65, v66
    v_max3_f32 v124, v124, v125, v126
    v_max3_f32 v127, v127, v128, v67
    v_max_f32 v124, v124, v127
    v_mfma_f32_32x32x16_bf16 v[68:83], v[28:31], v[4:7], v[108:123]
    v_cmp_lt_f32 vcc, 0x41000000, v124
    v_mfma_f32_32x32x16_bf16 v[68:83], v[32:35], v[8:11], v[68:83]
    s_nop 4
    s_cbranch_vccnz slow_attn_kernel_17
back_attn_kernel_18:
    v_exp_f32 v52, v52
    v_exp_f32 v53, v53
    v_exp_f32 v54, v54
    v_exp_f32 v55, v55
    v_exp_f32 v56, v56
    v_exp_f32 v57, v57
    v_exp_f32 v58, v58
    v_exp_f32 v59, v59
    v_exp_f32 v60, v60
    v_exp_f32 v61, v61
    v_exp_f32 v62, v62
    v_exp_f32 v63, v63
    v_exp_f32 v64, v64
    v_exp_f32 v65, v65
    v_exp_f32 v66, v66
    v_exp_f32 v67, v67
    s_nop 0
    v_cvt_pk_bf16_f32 v84, v52, v53
    v_cvt_pk_bf16_f32 v85, v54, v55
    v_cvt_pk_bf16_f32 v86, v56, v57
    v_cvt_pk_bf16_f32 v87, v58, v59
    v_cvt_pk_bf16_f32 v88, v60, v61
    v_cvt_pk_bf16_f32 v89, v62, v63
    v_cvt_pk_bf16_f32 v90, v64, v65
    v_cvt_pk_bf16_f32 v91, v66, v67
    s_waitcnt lgkmcnt(0)
    s_nop 0
    ds_read_b128 v[28:31], v130 offset:14336
    s_mov_b64 exec, s[40:41]
    ds_read_b64 v[32:33], v130 offset:15360
    s_mov_b64 exec, -1
    s_mov_b64 exec, s[42:43]
    ds_read_b128 v[44:47], v130 offset:26624
    ds_read_b128 v[48:51], v130 offset:27648
    s_mov_b64 exec, -1
    v_mfma_f32_32x32x16_bf16 v[92:107], v[36:39], v[84:87], v[92:107]
    v_max3_f32 v124, v68, v69, v70
    v_max3_f32 v125, v71, v72, v73
    v_max3_f32 v126, v74, v75, v76
    v_max3_f32 v127, v77, v78, v79
    v_mfma_f32_32x32x16_bf16 v[92:107], v[40:43], v[88:91], v[92:107]
    v_max3_f32 v128, v80, v81, v82
    v_max3_f32 v124, v124, v125, v126
    v_max3_f32 v127, v127, v128, v83
    v_max_f32 v124, v124, v127
    v_mfma_f32_32x32x16_bf16 v[52:67], v[20:23], v[4:7], v[108:123]
    v_cmp_lt_f32 vcc, 0x41000000, v124
    v_mfma_f32_32x32x16_bf16 v[52:67], v[24:27], v[8:11], v[52:67]
    s_nop 4
    s_cbranch_vccnz slow_attn_kernel_19
back_attn_kernel_20:
    v_exp_f32 v68, v68
    v_exp_f32 v69, v69
    v_exp_f32 v70, v70
    v_exp_f32 v71, v71
    v_exp_f32 v72, v72
    v_exp_f32 v73, v73
    v_exp_f32 v74, v74
    v_exp_f32 v75, v75
    v_exp_f32 v76, v76
    v_exp_f32 v77, v77
    v_exp_f32 v78, v78
    v_exp_f32 v79, v79
    v_exp_f32 v80, v80
    v_exp_f32 v81, v81
    v_exp_f32 v82, v82
    v_exp_f32 v83, v83
    s_nop 0
    v_cvt_pk_bf16_f32 v84, v68, v69
    v_cvt_pk_bf16_f32 v85, v70, v71
    v_cvt_pk_bf16_f32 v86, v72, v73
    v_cvt_pk_bf16_f32 v87, v74, v75
    v_cvt_pk_bf16_f32 v88, v76, v77
    v_cvt_pk_bf16_f32 v89, v78, v79
    v_cvt_pk_bf16_f32 v90, v80, v81
    v_cvt_pk_bf16_f32 v91, v82, v83
    s_waitcnt lgkmcnt(0)
    s_nop 0
    ds_read_b128 v[20:23], v131 offset:0
    s_mov_b64 exec, s[40:41]
    ds_read_b64 v[24:25], v131 offset:1024
    s_mov_b64 exec, -1
    s_mov_b64 exec, s[42:43]
    ds_read_b128 v[36:39], v130 offset:28672
    ds_read_b128 v[40:43], v130 offset:29696
    s_mov_b64 exec, -1
    v_mfma_f32_32x32x16_bf16 v[92:107], v[44:47], v[84:87], v[92:107]
    v_max3_f32 v124, v52, v53, v54
    v_max3_f32 v125, v55, v56, v57
    v_max3_f32 v126, v58, v59, v60
    v_max3_f32 v127, v61, v62, v63
    v_mfma_f32_32x32x16_bf16 v[92:107], v[48:51], v[88:91], v[92:107]
    v_max3_f32 v128, v64, v65, v66
    v_max3_f32 v124, v124, v125, v126
    v_max3_f32 v127, v127, v128, v67
    v_max_f32 v124, v124, v127
    v_mfma_f32_32x32x16_bf16 v[68:83], v[28:31], v[4:7], v[108:123]
    v_cmp_lt_f32 vcc, 0x41000000, v124
    v_mfma_f32_32x32x16_bf16 v[68:83], v[32:35], v[8:11], v[68:83]
    s_nop 4
    s_cbranch_vccnz slow_attn_kernel_21
back_attn_kernel_22:
    v_exp_f32 v52, v52
    v_exp_f32 v53, v53
    v_exp_f32 v54, v54
    v_exp_f32 v55, v55
    v_exp_f32 v56, v56
    v_exp_f32 v57, v57
    v_exp_f32 v58, v58
    v_exp_f32 v59, v59
    v_exp_f32 v60, v60
    v_exp_f32 v61, v61
    v_exp_f32 v62, v62
    v_exp_f32 v63, v63
    v_exp_f32 v64, v64
    v_exp_f32 v65, v65
    v_exp_f32 v66, v66
    v_exp_f32 v67, v67
    s_nop 0
    v_cvt_pk_bf16_f32 v84, v52, v53
    v_cvt_pk_bf16_f32 v85, v54, v55
    v_cvt_pk_bf16_f32 v86, v56, v57
    v_cvt_pk_bf16_f32 v87, v58, v59
    v_cvt_pk_bf16_f32 v88, v60, v61
    v_cvt_pk_bf16_f32 v89, v62, v63
    v_cvt_pk_bf16_f32 v90, v64, v65
    v_cvt_pk_bf16_f32 v91, v66, v67
    s_waitcnt lgkmcnt(0)
    s_nop 0
    ds_read_b128 v[28:31], v131 offset:2048
    s_mov_b64 exec, s[40:41]
    ds_read_b64 v[32:33], v131 offset:3072
    s_mov_b64 exec, -1
    s_mov_b64 exec, s[42:43]
    ds_read_b128 v[44:47], v130 offset:30720
    ds_read_b128 v[48:51], v130 offset:31744
    s_mov_b64 exec, -1
    v_mfma_f32_32x32x16_bf16 v[92:107], v[36:39], v[84:87], v[92:107]
    v_max3_f32 v124, v68, v69, v70
    v_max3_f32 v125, v71, v72, v73
    v_max3_f32 v126, v74, v75, v76
    v_max3_f32 v127, v77, v78, v79
    v_mfma_f32_32x32x16_bf16 v[92:107], v[40:43], v[88:91], v[92:107]
    v_max3_f32 v128, v80, v81, v82
    v_max3_f32 v124, v124, v125, v126
    v_max3_f32 v127, v127, v128, v83
    v_max_f32 v124, v124, v127
    v_mfma_f32_32x32x16_bf16 v[52:67], v[20:23], v[4:7], v[108:123]
    v_cmp_lt_f32 vcc, 0x41000000, v124
    v_mfma_f32_32x32x16_bf16 v[52:67], v[24:27], v[8:11], v[52:67]
    s_nop 4
    s_cbranch_vccnz slow_attn_kernel_23
back_attn_kernel_24:
    v_exp_f32 v68, v68
    v_exp_f32 v69, v69
    v_exp_f32 v70, v70
    v_exp_f32 v71, v71
    v_exp_f32 v72, v72
    v_exp_f32 v73, v73
    v_exp_f32 v74, v74
    v_exp_f32 v75, v75
    v_exp_f32 v76, v76
    v_exp_f32 v77, v77
    v_exp_f32 v78, v78
    v_exp_f32 v79, v79
    v_exp_f32 v80, v80
    v_exp_f32 v81, v81
    v_exp_f32 v82, v82
    v_exp_f32 v83, v83
    s_nop 0
    v_cvt_pk_bf16_f32 v84, v68, v69
    v_cvt_pk_bf16_f32 v85, v70, v71
    v_cvt_pk_bf16_f32 v86, v72, v73
    v_cvt_pk_bf16_f32 v87, v74, v75
    v_cvt_pk_bf16_f32 v88, v76, v77
    v_cvt_pk_bf16_f32 v89, v78, v79
    v_cvt_pk_bf16_f32 v90, v80, v81
    v_cvt_pk_bf16_f32 v91, v82, v83
    s_waitcnt lgkmcnt(0)
    s_nop 0
    s_mov_b32 s27, s28
    s_add_u32 s28, s28, 32768
    s_cmp_eq_u32 s28, 98304
    s_cselect_b32 s28, 0, s28
    v_add_u32 v130, s27, v3
    v_add_u32 v131, s28, v3
    s_sub_u32 s29, s29, 1
    s_cmp_lg_u32 s29, 0
    s_cbranch_scc1 chunk_attn_kernel_7
fin_attn_kernel_3:
    v_mfma_f32_32x32x16_bf16 v[92:107], v[44:47], v[84:87], v[92:107]
    v_mfma_f32_32x32x16_bf16 v[92:107], v[48:51], v[88:91], v[92:107]
    s_nop 7
    s_nop 7
    v_mov_b32 v124, v100
    v_mov_b32 v125, v100
    s_nop 1
    v_permlane32_swap_b32 v124, v125
    v_rcp_f32 v125, v125
    s_nop 0
    v_mul_f32 v92, v92, v125
    v_mul_f32 v93, v93, v125
    v_mul_f32 v94, v94, v125
    v_mul_f32 v95, v95, v125
    v_mul_f32 v96, v96, v125
    v_mul_f32 v97, v97, v125
    v_mul_f32 v98, v98, v125
    v_mul_f32 v99, v99, v125
    v_mul_f32 v100, v100, v125
    v_mul_f32 v101, v101, v125
    v_mul_f32 v102, v102, v125
    v_mul_f32 v103, v103, v125
    v_cvt_pk_bf16_f32 v84, v92, v93
    v_cvt_pk_bf16_f32 v85, v94, v95
    v_cvt_pk_bf16_f32 v86, v96, v97
    v_cvt_pk_bf16_f32 v87, v98, v99
    v_cvt_pk_bf16_f32 v88, v100, v101
    v_cvt_pk_bf16_f32 v89, v102, v103
    s_lshr_b32 s22, s21, 1
    s_mul_i32 s22, s22, 20
    s_lshl_b32 s22, s22, 12
    s_and_b32 s30, s21, 1
    s_lshl_b32 s30, s30, 11
    s_add_u32 s22, s22, s30
    v_and_b32 v124, 31, v1
    v_bfe_u32 v126, v124, 2, 2
    v_sub_u32 v126, 0, v126
    v_lshlrev_b32 v124, 6, v124
    v_add_u32 v124, s22, v124
    v_lshrrev_b32 v125, 5, v1
    s_mul_i32 s22, s3, 20
    v_lshl_add_u32 v127, v125, 2, s22
    v_lshrrev_b32 v128, 5, v127
    v_lshl_add_u32 v128, v128, 12, v124
    v_lshrrev_b32 v129, 3, v127
    v_xor_b32 v129, v129, v126
    v_and_b32 v129, 3, v129
    v_lshl_add_u32 v128, v129, 4, v128
    v_bfe_u32 v129, v127, 2, 1
    v_lshl_add_u32 v128, v129, 3, v128
    buffer_store_dwordx2 v[84:85], v128, s[12:15], 0 offen
    v_lshl_add_u32 v127, v125, 2, s22
    v_add_u32 v127, 8, v127
    v_lshrrev_b32 v128, 5, v127
    v_lshl_add_u32 v128, v128, 12, v124
    v_lshrrev_b32 v129, 3, v127
    v_xor_b32 v129, v129, v126
    v_and_b32 v129, 3, v129
    v_lshl_add_u32 v128, v129, 4, v128
    v_bfe_u32 v129, v127, 2, 1
    v_lshl_add_u32 v128, v129, 3, v128
    buffer_store_dwordx2 v[86:87], v128, s[12:15], 0 offen
    v_lshl_add_u32 v127, v125, 2, s22
    v_add_u32 v127, 16, v127
    v_lshrrev_b32 v128, 5, v127
    v_lshl_add_u32 v128, v128, 12, v124
    v_lshrrev_b32 v129, 3, v127
    v_xor_b32 v129, v129, v126
    v_and_b32 v129, 3, v129
    v_lshl_add_u32 v128, v129, 4, v128
    v_bfe_u32 v129, v127, 2, 1
    v_lshl_add_u32 v128, v129, 3, v128
    v_mov_b32 v129, 0x7ffffff0
    v_cmp_gt_u32 vcc, 32, v1
    s_nop 1
    v_cndmask_b32 v128, v129, v128, vcc
    buffer_store_dwordx2 v[88:89], v128, s[12:15], 0 offen
    s_branch end_attn_kernel_1
slow_attn_kernel_9:
    s_nop 7
    s_nop 7
    v_mov_b32 v125, v124
    s_nop 1
    v_permlane32_swap_b32 v124, v125
    v_max_f32 v124, v124, v125
    v_max_f32 v124, 0, v124
    v_sub_f32 v125, 0, v124
    v_exp_f32 v125, v125
    v_sub_f32 v108, v108, v124
    v_sub_f32 v109, v109, v124
    v_sub_f32 v110, v110, v124
    v_sub_f32 v111, v111, v124
    v_sub_f32 v112, v112, v124
    v_sub_f32 v113, v113, v124
    v_sub_f32 v114, v114, v124
    v_sub_f32 v115, v115, v124
    v_sub_f32 v116, v116, v124
    v_sub_f32 v117, v117, v124
    v_sub_f32 v118, v118, v124
    v_sub_f32 v119, v119, v124
    v_sub_f32 v120, v120, v124
    v_sub_f32 v121, v121, v124
    v_sub_f32 v122, v122, v124
    v_sub_f32 v123, v123, v124
    v_sub_f32 v52, v52, v124
    v_sub_f32 v53, v53, v124
    v_sub_f32 v54, v54, v124
    v_sub_f32 v55, v55, v124
    v_sub_f32 v56, v56, v124
    v_sub_f32 v57, v57, v124
    v_sub_f32 v58, v58, v124
    v_sub_f32 v59, v59, v124
    v_sub_f32 v60, v60, v124
    v_sub_f32 v61, v61, v124
    v_sub_f32 v62, v62, v124
    v_sub_f32 v63, v63, v124
    v_sub_f32 v64, v64, v124
    v_sub_f32 v65, v65, v124
    v_sub_f32 v66, v66, v124
    v_sub_f32 v67, v67, v124
    v_sub_f32 v68, v68, v124
    v_sub_f32 v69, v69, v124
    v_sub_f32 v70, v70, v124
    v_sub_f32 v71, v71, v124
    v_sub_f32 v72, v72, v124
    v_sub_f32 v73, v73, v124
    v_sub_f32 v74, v74, v124
    v_sub_f32 v75, v75, v124
    v_sub_f32 v76, v76, v124
    v_sub_f32 v77, v77, v124
    v_sub_f32 v78, v78, v124
    v_sub_f32 v79, v79, v124
    v_sub_f32 v80, v80, v124
    v_sub_f32 v81, v81, v124
    v_sub_f32 v82, v82, v124
    v_sub_f32 v83, v83, v124
    v_mul_f32 v92, v92, v125
    v_mul_f32 v93, v93, v125
    v_mul_f32 v94, v94, v125
    v_mul_f32 v95, v95, v125
    v_mul_f32 v96, v96, v125
    v_mul_f32 v97, v97, v125
    v_mul_f32 v98, v98, v125
    v_mul_f32 v99, v99, v125
    v_mul_f32 v100, v100, v125
    v_mul_f32 v101, v101, v125
    v_mul_f32 v102, v102, v125
    v_mul_f32 v103, v103, v125
    v_mul_f32 v104, v104, v125
    v_mul_f32 v105, v105, v125
    v_mul_f32 v106, v106, v125
    v_mul_f32 v107, v107, v125
    s_branch back_attn_kernel_10
slow_attn_kernel_11:
    s_nop 7
    s_nop 7
    v_mov_b32 v125, v124
    s_nop 1
    v_permlane32_swap_b32 v124, v125
    v_max_f32 v124, v124, v125
    v_max_f32 v124, 0, v124
    v_sub_f32 v125, 0, v124
    v_exp_f32 v125, v125
    v_sub_f32 v108, v108, v124
    v_sub_f32 v109, v109, v124
    v_sub_f32 v110, v110, v124
    v_sub_f32 v111, v111, v124
    v_sub_f32 v112, v112, v124
    v_sub_f32 v113, v113, v124
    v_sub_f32 v114, v114, v124
    v_sub_f32 v115, v115, v124
    v_sub_f32 v116, v116, v124
    v_sub_f32 v117, v117, v124
    v_sub_f32 v118, v118, v124
    v_sub_f32 v119, v119, v124
    v_sub_f32 v120, v120, v124
    v_sub_f32 v121, v121, v124
    v_sub_f32 v122, v122, v124
    v_sub_f32 v123, v123, v124
    v_sub_f32 v68, v68, v124
    v_sub_f32 v69, v69, v124
    v_sub_f32 v70, v70, v124
    v_sub_f32 v71, v71, v124
    v_sub_f32 v72, v72, v124
    v_sub_f32 v73, v73, v124
    v_sub_f32 v74, v74, v124
    v_sub_f32 v75, v75, v124
    v_sub_f32 v76, v76, v124
    v_sub_f32 v77, v77, v124
    v_sub_f32 v78, v78, v124
    v_sub_f32 v79, v79, v124
    v_sub_f32 v80, v80, v124
    v_sub_f32 v81, v81, v124
    v_sub_f32 v82, v82, v124
    v_sub_f32 v83, v83, v124
    v_sub_f32 v52, v52, v124
    v_sub_f32 v53, v53, v124
    v_sub_f32 v54, v54, v124
    v_sub_f32 v55, v55, v124
    v_sub_f32 v56, v56, v124
    v_sub_f32 v57, v57, v124
    v_sub_f32 v58, v58, v124
    v_sub_f32 v59, v59, v124
    v_sub_f32 v60, v60, v124
    v_sub_f32 v61, v61, v124
    v_sub_f32 v62, v62, v124
    v_sub_f32 v63, v63, v124
    v_sub_f32 v64, v64, v124
    v_sub_f32 v65, v65, v124
    v_sub_f32 v66, v66, v124
    v_sub_f32 v67, v67, v124
    v_mul_f32 v92, v92, v125
    v_mul_f32 v93, v93, v125
    v_mul_f32 v94, v94, v125
    v_mul_f32 v95, v95, v125
    v_mul_f32 v96, v96, v125
    v_mul_f32 v97, v97, v125
    v_mul_f32 v98, v98, v125
    v_mul_f32 v99, v99, v125
    v_mul_f32 v100, v100, v125
    v_mul_f32 v101, v101, v125
    v_mul_f32 v102, v102, v125
    v_mul_f32 v103, v103, v125
    v_mul_f32 v104, v104, v125
    v_mul_f32 v105, v105, v125
    v_mul_f32 v106, v106, v125
    v_mul_f32 v107, v107, v125
    s_branch back_attn_kernel_12
slow_attn_kernel_13:
    s_nop 7
    s_nop 7
    v_mov_b32 v125, v124
    s_nop 1
    v_permlane32_swap_b32 v124, v125
    v_max_f32 v124, v124, v125
    v_max_f32 v124, 0, v124
    v_sub_f32 v125, 0, v124
    v_exp_f32 v125, v125
    v_sub_f32 v108, v108, v124
    v_sub_f32 v109, v109, v124
    v_sub_f32 v110, v110, v124
    v_sub_f32 v111, v111, v124
    v_sub_f32 v112, v112, v124
    v_sub_f32 v113, v113, v124
    v_sub_f32 v114, v114, v124
    v_sub_f32 v115, v115, v124
    v_sub_f32 v116, v116, v124
    v_sub_f32 v117, v117, v124
    v_sub_f32 v118, v118, v124
    v_sub_f32 v119, v119, v124
    v_sub_f32 v120, v120, v124
    v_sub_f32 v121, v121, v124
    v_sub_f32 v122, v122, v124
    v_sub_f32 v123, v123, v124
    v_sub_f32 v52, v52, v124
    v_sub_f32 v53, v53, v124
    v_sub_f32 v54, v54, v124
    v_sub_f32 v55, v55, v124
    v_sub_f32 v56, v56, v124
    v_sub_f32 v57, v57, v124
    v_sub_f32 v58, v58, v124
    v_sub_f32 v59, v59, v124
    v_sub_f32 v60, v60, v124
    v_sub_f32 v61, v61, v124
    v_sub_f32 v62, v62, v124
    v_sub_f32 v63, v63, v124
    v_sub_f32 v64, v64, v124
    v_sub_f32 v65, v65, v124
    v_sub_f32 v66, v66, v124
    v_sub_f32 v67, v67, v124
    v_sub_f32 v68, v68, v124
    v_sub_f32 v69, v69, v124
    v_sub_f32 v70, v70, v124
    v_sub_f32 v71, v71, v124
    v_sub_f32 v72, v72, v124
    v_sub_f32 v73, v73, v124
    v_sub_f32 v74, v74, v124
    v_sub_f32 v75, v75, v124
    v_sub_f32 v76, v76, v124
    v_sub_f32 v77, v77, v124
    v_sub_f32 v78, v78, v124
    v_sub_f32 v79, v79, v124
    v_sub_f32 v80, v80, v124
    v_sub_f32 v81, v81, v124
    v_sub_f32 v82, v82, v124
    v_sub_f32 v83, v83, v124
    v_mul_f32 v92, v92, v125
    v_mul_f32 v93, v93, v125
    v_mul_f32 v94, v94, v125
    v_mul_f32 v95, v95, v125
    v_mul_f32 v96, v96, v125
    v_mul_f32 v97, v97, v125
    v_mul_f32 v98, v98, v125
    v_mul_f32 v99, v99, v125
    v_mul_f32 v100, v100, v125
    v_mul_f32 v101, v101, v125
    v_mul_f32 v102, v102, v125
    v_mul_f32 v103, v103, v125
    v_mul_f32 v104, v104, v125
    v_mul_f32 v105, v105, v125
    v_mul_f32 v106, v106, v125
    v_mul_f32 v107, v107, v125
    s_branch back_attn_kernel_14
slow_attn_kernel_15:
    s_nop 7
    s_nop 7
    v_mov_b32 v125, v124
    s_nop 1
    v_permlane32_swap_b32 v124, v125
    v_max_f32 v124, v124, v125
    v_max_f32 v124, 0, v124
    v_sub_f32 v125, 0, v124
    v_exp_f32 v125, v125
    v_sub_f32 v108, v108, v124
    v_sub_f32 v109, v109, v124
    v_sub_f32 v110, v110, v124
    v_sub_f32 v111, v111, v124
    v_sub_f32 v112, v112, v124
    v_sub_f32 v113, v113, v124
    v_sub_f32 v114, v114, v124
    v_sub_f32 v115, v115, v124
    v_sub_f32 v116, v116, v124
    v_sub_f32 v117, v117, v124
    v_sub_f32 v118, v118, v124
    v_sub_f32 v119, v119, v124
    v_sub_f32 v120, v120, v124
    v_sub_f32 v121, v121, v124
    v_sub_f32 v122, v122, v124
    v_sub_f32 v123, v123, v124
    v_sub_f32 v68, v68, v124
    v_sub_f32 v69, v69, v124
    v_sub_f32 v70, v70, v124
    v_sub_f32 v71, v71, v124
    v_sub_f32 v72, v72, v124
    v_sub_f32 v73, v73, v124
    v_sub_f32 v74, v74, v124
    v_sub_f32 v75, v75, v124
    v_sub_f32 v76, v76, v124
    v_sub_f32 v77, v77, v124
    v_sub_f32 v78, v78, v124
    v_sub_f32 v79, v79, v124
    v_sub_f32 v80, v80, v124
    v_sub_f32 v81, v81, v124
    v_sub_f32 v82, v82, v124
    v_sub_f32 v83, v83, v124
    v_sub_f32 v52, v52, v124
    v_sub_f32 v53, v53, v124
    v_sub_f32 v54, v54, v124
    v_sub_f32 v55, v55, v124
    v_sub_f32 v56, v56, v124
    v_sub_f32 v57, v57, v124
    v_sub_f32 v58, v58, v124
    v_sub_f32 v59, v59, v124
    v_sub_f32 v60, v60, v124
    v_sub_f32 v61, v61, v124
    v_sub_f32 v62, v62, v124
    v_sub_f32 v63, v63, v124
    v_sub_f32 v64, v64, v124
    v_sub_f32 v65, v65, v124
    v_sub_f32 v66, v66, v124
    v_sub_f32 v67, v67, v124
    v_mul_f32 v92, v92, v125
    v_mul_f32 v93, v93, v125
    v_mul_f32 v94, v94, v125
    v_mul_f32 v95, v95, v125
    v_mul_f32 v96, v96, v125
    v_mul_f32 v97, v97, v125
    v_mul_f32 v98, v98, v125
    v_mul_f32 v99, v99, v125
    v_mul_f32 v100, v100, v125
    v_mul_f32 v101, v101, v125
    v_mul_f32 v102, v102, v125
    v_mul_f32 v103, v103, v125
    v_mul_f32 v104, v104, v125
    v_mul_f32 v105, v105, v125
    v_mul_f32 v106, v106, v125
    v_mul_f32 v107, v107, v125
    s_branch back_attn_kernel_16
slow_attn_kernel_17:
    s_nop 7
    s_nop 7
    v_mov_b32 v125, v124
    s_nop 1
    v_permlane32_swap_b32 v124, v125
    v_max_f32 v124, v124, v125
    v_max_f32 v124, 0, v124
    v_sub_f32 v125, 0, v124
    v_exp_f32 v125, v125
    v_sub_f32 v108, v108, v124
    v_sub_f32 v109, v109, v124
    v_sub_f32 v110, v110, v124
    v_sub_f32 v111, v111, v124
    v_sub_f32 v112, v112, v124
    v_sub_f32 v113, v113, v124
    v_sub_f32 v114, v114, v124
    v_sub_f32 v115, v115, v124
    v_sub_f32 v116, v116, v124
    v_sub_f32 v117, v117, v124
    v_sub_f32 v118, v118, v124
    v_sub_f32 v119, v119, v124
    v_sub_f32 v120, v120, v124
    v_sub_f32 v121, v121, v124
    v_sub_f32 v122, v122, v124
    v_sub_f32 v123, v123, v124
    v_sub_f32 v52, v52, v124
    v_sub_f32 v53, v53, v124
    v_sub_f32 v54, v54, v124
    v_sub_f32 v55, v55, v124
    v_sub_f32 v56, v56, v124
    v_sub_f32 v57, v57, v124
    v_sub_f32 v58, v58, v124
    v_sub_f32 v59, v59, v124
    v_sub_f32 v60, v60, v124
    v_sub_f32 v61, v61, v124
    v_sub_f32 v62, v62, v124
    v_sub_f32 v63, v63, v124
    v_sub_f32 v64, v64, v124
    v_sub_f32 v65, v65, v124
    v_sub_f32 v66, v66, v124
    v_sub_f32 v67, v67, v124
    v_sub_f32 v68, v68, v124
    v_sub_f32 v69, v69, v124
    v_sub_f32 v70, v70, v124
    v_sub_f32 v71, v71, v124
    v_sub_f32 v72, v72, v124
    v_sub_f32 v73, v73, v124
    v_sub_f32 v74, v74, v124
    v_sub_f32 v75, v75, v124
    v_sub_f32 v76, v76, v124
    v_sub_f32 v77, v77, v124
    v_sub_f32 v78, v78, v124
    v_sub_f32 v79, v79, v124
    v_sub_f32 v80, v80, v124
    v_sub_f32 v81, v81, v124
    v_sub_f32 v82, v82, v124
    v_sub_f32 v83, v83, v124
    v_mul_f32 v92, v92, v125
    v_mul_f32 v93, v93, v125
    v_mul_f32 v94, v94, v125
    v_mul_f32 v95, v95, v125
    v_mul_f32 v96, v96, v125
    v_mul_f32 v97, v97, v125
    v_mul_f32 v98, v98, v125
    v_mul_f32 v99, v99, v125
    v_mul_f32 v100, v100, v125
    v_mul_f32 v101, v101, v125
    v_mul_f32 v102, v102, v125
    v_mul_f32 v103, v103, v125
    v_mul_f32 v104, v104, v125
    v_mul_f32 v105, v105, v125
    v_mul_f32 v106, v106, v125
    v_mul_f32 v107, v107, v125
    s_branch back_attn_kernel_18
slow_attn_kernel_19:
    s_nop 7
    s_nop 7
    v_mov_b32 v125, v124
    s_nop 1
    v_permlane32_swap_b32 v124, v125
    v_max_f32 v124, v124, v125
    v_max_f32 v124, 0, v124
    v_sub_f32 v125, 0, v124
    v_exp_f32 v125, v125
    v_sub_f32 v108, v108, v124
    v_sub_f32 v109, v109, v124
    v_sub_f32 v110, v110, v124
    v_sub_f32 v111, v111, v124
    v_sub_f32 v112, v112, v124
    v_sub_f32 v113, v113, v124
    v_sub_f32 v114, v114, v124
    v_sub_f32 v115, v115, v124
    v_sub_f32 v116, v116, v124
    v_sub_f32 v117, v117, v124
    v_sub_f32 v118, v118, v124
    v_sub_f32 v119, v119, v124
    v_sub_f32 v120, v120, v124
    v_sub_f32 v121, v121, v124
    v_sub_f32 v122, v122, v124
    v_sub_f32 v123, v123, v124
    v_sub_f32 v68, v68, v124
    v_sub_f32 v69, v69, v124
    v_sub_f32 v70, v70, v124
    v_sub_f32 v71, v71, v124
    v_sub_f32 v72, v72, v124
    v_sub_f32 v73, v73, v124
    v_sub_f32 v74, v74, v124
    v_sub_f32 v75, v75, v124
    v_sub_f32 v76, v76, v124
    v_sub_f32 v77, v77, v124
    v_sub_f32 v78, v78, v124
    v_sub_f32 v79, v79, v124
    v_sub_f32 v80, v80, v124
    v_sub_f32 v81, v81, v124
    v_sub_f32 v82, v82, v124
    v_sub_f32 v83, v83, v124
    v_sub_f32 v52, v52, v124
    v_sub_f32 v53, v53, v124
    v_sub_f32 v54, v54, v124
    v_sub_f32 v55, v55, v124
    v_sub_f32 v56, v56, v124
    v_sub_f32 v57, v57, v124
    v_sub_f32 v58, v58, v124
    v_sub_f32 v59, v59, v124
    v_sub_f32 v60, v60, v124
    v_sub_f32 v61, v61, v124
    v_sub_f32 v62, v62, v124
    v_sub_f32 v63, v63, v124
    v_sub_f32 v64, v64, v124
    v_sub_f32 v65, v65, v124
    v_sub_f32 v66, v66, v124
    v_sub_f32 v67, v67, v124
    v_mul_f32 v92, v92, v125
    v_mul_f32 v93, v93, v125
    v_mul_f32 v94, v94, v125
    v_mul_f32 v95, v95, v125
    v_mul_f32 v96, v96, v125
    v_mul_f32 v97, v97, v125
    v_mul_f32 v98, v98, v125
    v_mul_f32 v99, v99, v125
    v_mul_f32 v100, v100, v125
    v_mul_f32 v101, v101, v125
    v_mul_f32 v102, v102, v125
    v_mul_f32 v103, v103, v125
    v_mul_f32 v104, v104, v125
    v_mul_f32 v105, v105, v125
    v_mul_f32 v106, v106, v125
    v_mul_f32 v107, v107, v125
    s_branch back_attn_kernel_20
slow_attn_kernel_21:
    s_nop 7
    s_nop 7
    v_mov_b32 v125, v124
    s_nop 1
    v_permlane32_swap_b32 v124, v125
    v_max_f32 v124, v124, v125
    v_max_f32 v124, 0, v124
    v_sub_f32 v125, 0, v124
    v_exp_f32 v125, v125
    v_sub_f32 v108, v108, v124
    v_sub_f32 v109, v109, v124
    v_sub_f32 v110, v110, v124
    v_sub_f32 v111, v111, v124
    v_sub_f32 v112, v112, v124
    v_sub_f32 v113, v113, v124
    v_sub_f32 v114, v114, v124
    v_sub_f32 v115, v115, v124
    v_sub_f32 v116, v116, v124
    v_sub_f32 v117, v117, v124
    v_sub_f32 v118, v118, v124
    v_sub_f32 v119, v119, v124
    v_sub_f32 v120, v120, v124
    v_sub_f32 v121, v121, v124
    v_sub_f32 v122, v122, v124
    v_sub_f32 v123, v123, v124
    v_sub_f32 v52, v52, v124
    v_sub_f32 v53, v53, v124
    v_sub_f32 v54, v54, v124
    v_sub_f32 v55, v55, v124
    v_sub_f32 v56, v56, v124
    v_sub_f32 v57, v57, v124
    v_sub_f32 v58, v58, v124
    v_sub_f32 v59, v59, v124
    v_sub_f32 v60, v60, v124
    v_sub_f32 v61, v61, v124
    v_sub_f32 v62, v62, v124
    v_sub_f32 v63, v63, v124
    v_sub_f32 v64, v64, v124
    v_sub_f32 v65, v65, v124
    v_sub_f32 v66, v66, v124
    v_sub_f32 v67, v67, v124
    v_sub_f32 v68, v68, v124
    v_sub_f32 v69, v69, v124
    v_sub_f32 v70, v70, v124
    v_sub_f32 v71, v71, v124
    v_sub_f32 v72, v72, v124
    v_sub_f32 v73, v73, v124
    v_sub_f32 v74, v74, v124
    v_sub_f32 v75, v75, v124
    v_sub_f32 v76, v76, v124
    v_sub_f32 v77, v77, v124
    v_sub_f32 v78, v78, v124
    v_sub_f32 v79, v79, v124
    v_sub_f32 v80, v80, v124
    v_sub_f32 v81, v81, v124
    v_sub_f32 v82, v82, v124
    v_sub_f32 v83, v83, v124
    v_mul_f32 v92, v92, v125
    v_mul_f32 v93, v93, v125
    v_mul_f32 v94, v94, v125
    v_mul_f32 v95, v95, v125
    v_mul_f32 v96, v96, v125
    v_mul_f32 v97, v97, v125
    v_mul_f32 v98, v98, v125
    v_mul_f32 v99, v99, v125
    v_mul_f32 v100, v100, v125
    v_mul_f32 v101, v101, v125
    v_mul_f32 v102, v102, v125
    v_mul_f32 v103, v103, v125
    v_mul_f32 v104, v104, v125
    v_mul_f32 v105, v105, v125
    v_mul_f32 v106, v106, v125
    v_mul_f32 v107, v107, v125
    s_branch back_attn_kernel_22
slow_attn_kernel_23:
    s_nop 7
    s_nop 7
    v_mov_b32 v125, v124
    s_nop 1
    v_permlane32_swap_b32 v124, v125
    v_max_f32 v124, v124, v125
    v_max_f32 v124, 0, v124
    v_sub_f32 v125, 0, v124
    v_exp_f32 v125, v125
    v_sub_f32 v108, v108, v124
    v_sub_f32 v109, v109, v124
    v_sub_f32 v110, v110, v124
    v_sub_f32 v111, v111, v124
    v_sub_f32 v112, v112, v124
    v_sub_f32 v113, v113, v124
    v_sub_f32 v114, v114, v124
    v_sub_f32 v115, v115, v124
    v_sub_f32 v116, v116, v124
    v_sub_f32 v117, v117, v124
    v_sub_f32 v118, v118, v124
    v_sub_f32 v119, v119, v124
    v_sub_f32 v120, v120, v124
    v_sub_f32 v121, v121, v124
    v_sub_f32 v122, v122, v124
    v_sub_f32 v123, v123, v124
    v_sub_f32 v68, v68, v124
    v_sub_f32 v69, v69, v124
    v_sub_f32 v70, v70, v124
    v_sub_f32 v71, v71, v124
    v_sub_f32 v72, v72, v124
    v_sub_f32 v73, v73, v124
    v_sub_f32 v74, v74, v124
    v_sub_f32 v75, v75, v124
    v_sub_f32 v76, v76, v124
    v_sub_f32 v77, v77, v124
    v_sub_f32 v78, v78, v124
    v_sub_f32 v79, v79, v124
    v_sub_f32 v80, v80, v124
    v_sub_f32 v81, v81, v124
    v_sub_f32 v82, v82, v124
    v_sub_f32 v83, v83, v124
    v_sub_f32 v52, v52, v124
    v_sub_f32 v53, v53, v124
    v_sub_f32 v54, v54, v124
    v_sub_f32 v55, v55, v124
    v_sub_f32 v56, v56, v124
    v_sub_f32 v57, v57, v124
    v_sub_f32 v58, v58, v124
    v_sub_f32 v59, v59, v124
    v_sub_f32 v60, v60, v124
    v_sub_f32 v61, v61, v124
    v_sub_f32 v62, v62, v124
    v_sub_f32 v63, v63, v124
    v_sub_f32 v64, v64, v124
    v_sub_f32 v65, v65, v124
    v_sub_f32 v66, v66, v124
    v_sub_f32 v67, v67, v124
    v_mul_f32 v92, v92, v125
    v_mul_f32 v93, v93, v125
    v_mul_f32 v94, v94, v125
    v_mul_f32 v95, v95, v125
    v_mul_f32 v96, v96, v125
    v_mul_f32 v97, v97, v125
    v_mul_f32 v98, v98, v125
    v_mul_f32 v99, v99, v125
    v_mul_f32 v100, v100, v125
    v_mul_f32 v101, v101, v125
    v_mul_f32 v102, v102, v125
    v_mul_f32 v103, v103, v125
    v_mul_f32 v104, v104, v125
    v_mul_f32 v105, v105, v125
    v_mul_f32 v106, v106, v125
    v_mul_f32 v107, v107, v125
    s_branch back_attn_kernel_24
end_attn_kernel_1:
    s_endpgm
.globl geglu_kernel
.p2align 8
.type geglu_kernel,@function
geglu_kernel:
    s_cmp_ge_u32 s2, 256
    s_cbranch_scc1 end_geglu_kernel_1
    s_load_dwordx16 s[64:79], s[0:1], 0
    s_load_dwordx4 s[80:83], s[0:1], 64
    s_and_b32 s3, s2, 1
    s_lshl_b32 s3, s3, 3
    s_bfe_u32 s4, s2, 0x30003
    s_add_u32 s3, s3, s4
    s_lshr_b32 s5, s2, 6
    s_bfe_u32 s6, s2, 0x20001
    s_lshl_b32 s4, s6, 2
    s_cmp_eq_u32 s6, 3
    s_cselect_b32 s7, 1, 0
    s_sub_u32 s4, s4, s7
    s_add_u32 s4, s4, s5
    s_cmp_ge_u32 s6, 2
    s_cselect_b32 s7, 3, 4
    s_cmp_ge_u32 s5, s7
    s_cbranch_scc1 end_geglu_kernel_1
    v_and_b32 v1, 63, v0
    v_lshrrev_b32 v2, 6, v0
    s_nop 0
    v_readfirstlane_b32 s5, v2
    s_lshr_b32 s62, s5, 2
    s_and_b32 s5, s5, 3
    s_mul_i32 s56, s3, 128
    s_mul_i32 s57, s4, 128
    s_lshr_b32 s6, s5, 1
    s_and_b32 s7, s5, 1
    s_mov_b32 s58, 1280
    v_lshrrev_b32 v3, 4, v1
    v_xor_b32 v3, v3, v1
    v_and_b32 v3, 7, v3
    v_lshrrev_b32 v4, 3, v1
    v_add_u32 v4, s56, v4
    v_mul_lo_u32 v5, v4, s58
    v_lshl_add_u32 v5, v3, 4, v5
    v_lshrrev_b32 v3, 4, v1
    v_add_u32 v3, 4, v3
    v_xor_b32 v3, v3, v1
    v_and_b32 v3, 7, v3
    v_lshrrev_b32 v4, 3, v1
    v_add_u32 v4, s56, v4
    v_mul_lo_u32 v6, v4, s58
    v_lshl_add_u32 v6, v3, 4, v6
    v_lshrrev_b32 v3, 4, v1
    v_lshlrev_b32 v4, 2, v3
    v_xor_b32 v4, v4, v1
    v_and_b32 v4, 15, v4
    v_mul_u32_u24 v7, 3456, v3
    v_lshl_add_u32 v7, v4, 4, v7
    s_lshl_b32 s58, s57, 1
    v_add_u32 v7, s58, v7
    s_lshl_b32 s52, s5, 12
    s_mul_i32 s48, s5, 40960
    s_mul_i32 s49, s5, 55296
    s_mov_b32 s50, 2048
    s_mov_b32 s51, 2048
    s_waitcnt lgkmcnt(0)
    s_add_u32 s8, s82, 0x1000000
    s_addc_u32 s9, s83, 0
    s_and_b32 s9, s9, 0xffff
    s_mov_b32 s10, 0x280000
    s_mov_b32 s11, 0x20000
    s_mov_b32 s12, s72
    s_and_b32 s13, s73, 0xffff
    s_mov_b32 s14, 0x21c000
    s_mov_b32 s15, 0x20000
    s_mov_b32 s16, s74
    s_and_b32 s17, s75, 0xffff
    s_mov_b32 s18, 0x21c000
    s_mov_b32 s19, 0x20000
    s_cmp_eq_u32 s62, 0
    s_cbranch_scc1 comp_geglu_kernel_2
    s_add_u32 s53, s50, s52
    s_add_u32 m0, s53, 0
    s_add_u32 s54, s48, 0
    buffer_load_dwordx4 v5, s[8:11], s54 offen lds
    s_add_u32 m0, s53, 16384
    s_add_u32 s54, s49, 0
    buffer_load_dwordx4 v7, s[12:15], s54 offen lds
    s_add_u32 m0, s53, 32768
    s_add_u32 s54, s49, 0
    buffer_load_dwordx4 v7, s[16:19], s54 offen lds
    s_add_u32 s53, s50, s52
    s_add_u32 m0, s53, 1024
    s_add_u32 s54, s48, 10240
    buffer_load_dwordx4 v6, s[8:11], s54 offen lds
    s_add_u32 m0, s53, 17408
    s_add_u32 s54, s49, 13824
    buffer_load_dwordx4 v7, s[12:15], s54 offen lds
    s_add_u32 m0, s53, 33792
    s_add_u32 s54, s49, 13824
    buffer_load_dwordx4 v7, s[16:19], s54 offen lds
    s_add_u32 s53, s50, s52
    s_add_u32 m0, s53, 2048
    s_add_u32 s54, s48, 20480
    buffer_load_dwordx4 v5, s[8:11], s54 offen lds
    s_add_u32 m0, s53, 18432
    s_add_u32 s54, s49, 27648
    buffer_load_dwordx4 v7, s[12:15], s54 offen lds
    s_add_u32 m0, s53, 34816
    s_add_u32 s54, s49, 27648
    buffer_load_dwordx4 v7, s[16:19], s54 offen lds
    s_add_u32 s53, s50, s52
    s_add_u32 m0, s53, 3072
    s_add_u32 s54, s48, 30720
    buffer_load_dwordx4 v6, s[8:11], s54 offen lds
    s_add_u32 m0, s53, 19456
    s_add_u32 s54, s49, 41472
    buffer_load_dwordx4 v7, s[12:15], s54 offen lds
    s_add_u32 m0, s53, 35840
    s_add_u32 s54, s49, 41472
    buffer_load_dwordx4 v7, s[16:19], s54 offen lds
    s_add_u32 s48, s48, 128
    s_add_u32 s49, s49, 221184
    s_add_u32 s50, s50, 49152
    s_cmp_eq_u32 s50, 149504
    s_cselect_b32 s50, 2048, s50
    s_add_u32 s53, s50, s52
    s_add_u32 m0, s53, 0
    s_add_u32 s54, s48, 0
    buffer_load_dwordx4 v5, s[8:11], s54 offen lds
    s_add_u32 m0, s53, 16384
    s_add_u32 s54, s49, 0
    buffer_load_dwordx4 v7, s[12:15], s54 offen lds
    s_add_u32 m0, s53, 32768
    s_add_u32 s54, s49, 0
    buffer_load_dwordx4 v7, s[16:19], s54 offen lds
    s_add_u32 s53, s50, s52
    s_add_u32 m0, s53, 1024
    s_add_u32 s54, s48, 10240
    buffer_load_dwordx4 v6, s[8:11], s54 offen lds
    s_add_u32 m0, s53, 17408
    s_add_u32 s54, s49, 13824
    buffer_load_dwordx4 v7, s[12:15], s54 offen lds
    s_add_u32 m0, s53, 33792
    s_add_u32 s54, s49, 13824
    buffer_load_dwordx4 v7, s[16:19], s54 offen lds
    s_add_u32 s53, s50, s52
    s_add_u32 m0, s53, 2048
    s_add_u32 s54, s48, 20480
    buffer_load_dwordx4 v5, s[8:11], s54 offen lds
    s_add_u32 m0, s53, 18432
    s_add_u32 s54, s49, 27648
    buffer_load_dwordx4 v7, s[12:15], s54 offen lds
    s_add_u32 m0, s53, 34816
    s_add_u32 s54, s49, 27648
    buffer_load_dwordx4 v7, s[16:19], s54 offen lds
    s_add_u32 s53, s50, s52
    s_add_u32 m0, s53, 3072
    s_add_u32 s54, s48, 30720
    buffer_load_dwordx4 v6, s[8:11], s54 offen lds
    s_add_u32 m0, s53, 19456
    s_add_u32 s54, s49, 41472
    buffer_load_dwordx4 v7, s[12:15], s54 offen lds
    s_add_u32 m0, s53, 35840
    s_add_u32 s54, s49, 41472
    buffer_load_dwordx4 v7, s[16:19], s54 offen lds
    s_add_u32 s48, s48, 128
    s_add_u32 s49, s49, 221184
    s_add_u32 s50, s50, 49152
    s_cmp_eq_u32 s50, 149504
    s_cselect_b32 s50, 2048, s50
    s_waitcnt vmcnt(12)
    s_barrier
    s_mov_b32 s55, 8
ld_geglu_kernel_3:
    s_waitcnt vmcnt(0)
    s_barrier
    s_add_u32 s53, s50, s52
    s_add_u32 m0, s53, 0
    s_add_u32 s54, s48, 0
    buffer_load_dwordx4 v5, s[8:11], s54 offen lds
    s_add_u32 m0, s53, 16384
    s_add_u32 s54, s49, 0
    buffer_load_dwordx4 v7, s[12:15], s54 offen lds
    s_add_u32 m0, s53, 32768
    s_add_u32 s54, s49, 0
    buffer_load_dwordx4 v7, s[16:19], s54 offen lds
    s_add_u32 s53, s50, s52
    s_add_u32 m0, s53, 1024
    s_add_u32 s54, s48, 10240
    buffer_load_dwordx4 v6, s[8:11], s54 offen lds
    s_add_u32 m0, s53, 17408
    s_add_u32 s54, s49, 13824
    buffer_load_dwordx4 v7, s[12:15], s54 offen lds
    s_add_u32 m0, s53, 33792
    s_add_u32 s54, s49, 13824
    buffer_load_dwordx4 v7, s[16:19], s54 offen lds
    s_add_u32 s53, s50, s52
    s_add_u32 m0, s53, 2048
    s_add_u32 s54, s48, 20480
    buffer_load_dwordx4 v5, s[8:11], s54 offen lds
    s_add_u32 m0, s53, 18432
    s_add_u32 s54, s49, 27648
    buffer_load_dwordx4 v7, s[12:15], s54 offen lds
    s_add_u32 m0, s53, 34816
    s_add_u32 s54, s49, 27648
    buffer_load_dwordx4 v7, s[16:19], s54 offen lds
    s_add_u32 s53, s50, s52
    s_add_u32 m0, s53, 3072
    s_add_u32 s54, s48, 30720
    buffer_load_dwordx4 v6, s[8:11], s54 offen lds
    s_add_u32 m0, s53, 19456
    s_add_u32 s54, s49, 41472
    buffer_load_dwordx4 v7, s[12:15], s54 offen lds
    s_add_u32 m0, s53, 35840
    s_add_u32 s54, s49, 41472
    buffer_load_dwordx4 v7, s[16:19], s54 offen lds
    s_add_u32 s48, s48, 128
    s_add_u32 s49, s49, 221184
    s_add_u32 s50, s50, 49152
    s_cmp_eq_u32 s50, 149504
    s_cselect_b32 s50, 2048, s50
    s_sub_u32 s55, s55, 1
    s_cmp_lg_u32 s55, 0
    s_cbranch_scc1 ld_geglu_kernel_3
    s_waitcnt vmcnt(0)
    s_barrier
    s_endpgm
comp_geglu_kernel_2:
    s_mov_b32 s20, s82
    s_and_b32 s21, s83, 0xffff
    s_mov_b32 s22, 0x100000
    s_mov_b32 s23, 0x20000
    s_add_u32 s24, s82, 0x1600000
    s_addc_u32 s25, s83, 0
    s_and_b32 s25, s25, 0xffff
    s_mov_b32 s26, 0x6c0000
    s_mov_b32 s27, 0x20000
    v_add_u32 v25, s56, v0
    v_lshlrev_b32 v25, 6, v25
    v_add_u32 v25, 0x8000, v25
    buffer_load_dwordx4 v[8:11], v25, s[20:23], 0 offen offset:0
    buffer_load_dwordx4 v[12:15], v25, s[20:23], 0 offen offset:16
    buffer_load_dwordx4 v[16:19], v25, s[20:23], 0 offen offset:32
    buffer_load_dwordx4 v[20:23], v25, s[20:23], 0 offen offset:48
    v_add_u32 v26, s57, v0
    v_mov_b32 v24, 1920
    v_mov_b32 v25, 3520
    v_cmp_gt_u32 vcc, 128, v0
    s_nop 1
    v_cndmask_b32 v24, v25, v24, vcc
    v_add_u32 v26, v26, v24
    v_lshlrev_b32 v26, 2, v26
    v_add_u32 v26, 0x40000, v26
    buffer_load_dword v24, v26, s[20:23], 0 offen
    s_mov_b32 s58, 21504
    buffer_load_dword v27, v26, s[20:23], s58 offen
    s_mov_b32 s58, 43008
    buffer_load_dword v28, v26, s[20:23], s58 offen
    s_mov_b32 s58, 64512
    buffer_load_dword v29, v26, s[20:23], s58 offen
    v_lshrrev_b32 v42, 5, v1
    v_and_b32 v43, 31, v1
    s_lshl_b32 s58, s6, 13
    v_bfe_u32 v3, v43, 1, 3
    v_add_u32 v4, 0, v42
    v_xor_b32 v3, v3, v4
    v_lshlrev_b32 v4, 7, v43
    v_lshl_add_u32 v30, v3, 4, v4
    v_add_u32 v30, s58, v30
    v_bfe_u32 v3, v43, 1, 3
    v_add_u32 v4, 2, v42
    v_xor_b32 v3, v3, v4
    v_lshlrev_b32 v4, 7, v43
    v_lshl_add_u32 v31, v3, 4, v4
    v_add_u32 v31, s58, v31
    v_bfe_u32 v3, v43, 1, 3
    v_add_u32 v4, 4, v42
    v_xor_b32 v3, v3, v4
    v_lshlrev_b32 v4, 7, v43
    v_lshl_add_u32 v32, v3, 4, v4
    v_add_u32 v32, s58, v32
    v_bfe_u32 v3, v43, 1, 3
    v_add_u32 v4, 6, v42
    v_xor_b32 v3, v3, v4
    v_lshlrev_b32 v4, 7, v43
    v_lshl_add_u32 v33, v3, 4, v4
    v_add_u32 v33, s58, v33
    v_bfe_u32 v44, v1, 2, 2
    s_lshl_b32 s58, s7, 1
    s_add_u32 s58, s58, 0
    v_xor_b32 v3, s58, v44
    v_lshlrev_b32 v3, 6, v3
    v_lshl_add_u32 v3, v44, 8, v3
    v_lshl_add_u32 v3, v42, 11, v3
    v_and_b32 v4, 1, v1
    v_lshl_add_u32 v3, v4, 5, v3
    v_bfe_u32 v4, v1, 4, 1
    v_lshl_add_u32 v3, v4, 4, v3
    v_bfe_u32 v4, v1, 1, 1
    v_lshl_add_u32 v3, v4, 3, v3
    v_add_u32 v34, 16384, v3
    s_lshl_b32 s58, s7, 1
    s_add_u32 s58, s58, 1
    v_xor_b32 v3, s58, v44
    v_lshlrev_b32 v3, 6, v3
    v_lshl_add_u32 v3, v44, 8, v3
    v_lshl_add_u32 v3, v42, 11, v3
    v_and_b32 v4, 1, v1
    v_lshl_add_u32 v3, v4, 5, v3
    v_bfe_u32 v4, v1, 4, 1
    v_lshl_add_u32 v3, v4, 4, v3
    v_bfe_u32 v4, v1, 1, 1
    v_lshl_add_u32 v3, v4, 3, v3
    v_add_u32 v35, 16384, v3
    s_waitcnt lgkmcnt(0)
    s_barrier
    v_add_u32 v36, s51, v30
    v_add_u32 v37, s51, v31
    v_add_u32 v38, s51, v32
    v_add_u32 v39, s51, v33
    v_add_u32 v40, s51, v34
    v_add_u32 v41, s51, v35
    s_add_u32 s51, s51, 49152
    s_cmp_eq_u32 s51, 149504
    s_cselect_b32 s51, 2048, s51
    ds_read_b128 v[48:51], v36 offset:0
    ds_read_b128 v[52:55], v36 offset:4096
    ds_read_b64_tr_b16 v[72:73], v40 offset:0
    ds_read_b64_tr_b16 v[74:75], v40 offset:1024
    ds_read_b64_tr_b16 v[76:77], v41 offset:0
    ds_read_b64_tr_b16 v[78:79], v41 offset:1024
    ds_read_b64_tr_b16 v[80:81], v40 offset:16384
    ds_read_b64_tr_b16 v[82:83], v40 offset:17408
    ds_read_b64_tr_b16 v[84:85], v41 offset:16384
    ds_read_b64_tr_b16 v[86:87], v41 offset:17408
    ds_read_b128 v[56:59], v37 offset:0
    ds_read_b128 v[60:63], v37 offset:4096
    ds_read_b64_tr_b16 v[88:89], v40 offset:4096
    ds_read_b64_tr_b16 v[90:91], v40 offset:5120
    ds_read_b64_tr_b16 v[92:93], v41 offset:4096
    ds_read_b64_tr_b16 v[94:95], v41 offset:5120
    ds_read_b64_tr_b16 v[96:97], v40 offset:20480
    ds_read_b64_tr_b16 v[98:99], v40 offset:21504
    ds_read_b64_tr_b16 v[100:101], v41 offset:20480
    ds_read_b64_tr_b16 v[102:103], v41 offset:21504
    s_waitcnt lgkmcnt(10)
    ds_read_b128 v[64:67], v38 offset:0
    ds_read_b128 v[68:71], v38 offset:4096
    v_mfma_f32_32x32x16_bf16 v[120:135], v[72:75], v[48:51], 0
    ds_read_b64_tr_b16 v[104:105], v40 offset:8192
    v_mfma_f32_32x32x16_bf16 v[136:151], v[72:75], v[52:55], 0
    ds_read_b64_tr_b16 v[106:107], v40 offset:9216
    v_mfma_f32_32x32x16_bf16 v[152:167], v[76:79], v[48:51], 0
    ds_read_b64_tr_b16 v[108:109], v41 offset:8192
    v_mfma_f32_32x32x16_bf16 v[168:183], v[76:79], v[52:55], 0
    ds_read_b64_tr_b16 v[110:111], v41 offset:9216
    v_mfma_f32_32x32x16_bf16 v[184:199], v[80:83], v[48:51], 0
    ds_read_b64_tr_b16 v[112:113], v40 offset:24576
    v_mfma_f32_32x32x16_bf16 v[200:215], v[80:83], v[52:55], 0
    ds_read_b64_tr_b16 v[114:115], v40 offset:25600
    v_mfma_f32_32x32x16_bf16 v[216:231], v[84:87], v[48:51], 0
    ds_read_b64_tr_b16 v[116:117], v41 offset:24576
    v_mfma_f32_32x32x16_bf16 v[232:247], v[84:87], v[52:55], 0
    ds_read_b64_tr_b16 v[118:119], v41 offset:25600
    s_waitcnt lgkmcnt(10)
    ds_read_b128 v[48:51], v39 offset:0
    ds_read_b128 v[52:55], v39 offset:4096
    v_mfma_f32_32x32x16_bf16 v[120:135], v[88:91], v[56:59], v[120:135]
    ds_read_b64_tr_b16 v[72:73], v40 offset:12288
    v_mfma_f32_32x32x16_bf16 v[136:151], v[88:91], v[60:63], v[136:151]
    ds_read_b64_tr_b16 v[74:75], v40 offset:13312
    v_mfma_f32_32x32x16_bf16 v[152:167], v[92:95], v[56:59], v[152:167]
    ds_read_b64_tr_b16 v[76:77], v41 offset:12288
    v_mfma_f32_32x32x16_bf16 v[168:183], v[92:95], v[60:63], v[168:183]
    ds_read_b64_tr_b16 v[78:79], v41 offset:13312
    v_mfma_f32_32x32x16_bf16 v[184:199], v[96:99], v[56:59], v[184:199]
    ds_read_b64_tr_b16 v[80:81], v40 offset:28672
    v_mfma_f32_32x32x16_bf16 v[200:215], v[96:99], v[60:63], v[200:215]
    ds_read_b64_tr_b16 v[82:83], v40 offset:29696
    v_mfma_f32_32x32x16_bf16 v[216:231], v[100:103], v[56:59], v[216:231]
    ds_read_b64_tr_b16 v[84:85], v41 offset:28672
    v_mfma_f32_32x32x16_bf16 v[232:247], v[100:103], v[60:63], v[232:247]
    ds_read_b64_tr_b16 v[86:87], v41 offset:29696
    s_waitcnt lgkmcnt(10)
    s_barrier
    v_add_u32 v36, s51, v30
    v_add_u32 v37, s51, v31
    v_add_u32 v38, s51, v32
    v_add_u32 v39, s51, v33
    v_add_u32 v40, s51, v34
    v_add_u32 v41, s51, v35
    s_add_u32 s51, s51, 49152
    s_cmp_eq_u32 s51, 149504
    s_cselect_b32 s51, 2048, s51
    ds_read_b128 v[56:59], v36 offset:0
    ds_read_b128 v[60:63], v36 offset:4096
    v_mfma_f32_32x32x16_bf16 v[120:135], v[104:107], v[64:67], v[120:135]
    ds_read_b64_tr_b16 v[88:89], v40 offset:0
    v_mfma_f32_32x32x16_bf16 v[136:151], v[104:107], v[68:71], v[136:151]
    ds_read_b64_tr_b16 v[90:91], v40 offset:1024
    v_mfma_f32_32x32x16_bf16 v[152:167], v[108:111], v[64:67], v[152:167]
    ds_read_b64_tr_b16 v[92:93], v41 offset:0
    v_mfma_f32_32x32x16_bf16 v[168:183], v[108:111], v[68:71], v[168:183]
    ds_read_b64_tr_b16 v[94:95], v41 offset:1024
    v_mfma_f32_32x32x16_bf16 v[184:199], v[112:115], v[64:67], v[184:199]
    ds_read_b64_tr_b16 v[96:97], v40 offset:16384
    v_mfma_f32_32x32x16_bf16 v[200:215], v[112:115], v[68:71], v[200:215]
    ds_read_b64_tr_b16 v[98:99], v40 offset:17408
    v_mfma_f32_32x32x16_bf16 v[216:231], v[116:119], v[64:67], v[216:231]
    ds_read_b64_tr_b16 v[100:101], v41 offset:16384
    v_mfma_f32_32x32x16_bf16 v[232:247], v[116:119], v[68:71], v[232:247]
    ds_read_b64_tr_b16 v[102:103], v41 offset:17408
    s_waitcnt lgkmcnt(10)
    ds_read_b128 v[64:67], v37 offset:0
    ds_read_b128 v[68:71], v37 offset:4096
    v_mfma_f32_32x32x16_bf16 v[120:135], v[72:75], v[48:51], v[120:135]
    ds_read_b64_tr_b16 v[104:105], v40 offset:4096
    v_mfma_f32_32x32x16_bf16 v[136:151], v[72:75], v[52:55], v[136:151]
    ds_read_b64_tr_b16 v[106:107], v40 offset:5120
    v_mfma_f32_32x32x16_bf16 v[152:167], v[76:79], v[48:51], v[152:167]
    ds_read_b64_tr_b16 v[108:109], v41 offset:4096
    v_mfma_f32_32x32x16_bf16 v[168:183], v[76:79], v[52:55], v[168:183]
    ds_read_b64_tr_b16 v[110:111], v41 offset:5120
    v_mfma_f32_32x32x16_bf16 v[184:199], v[80:83], v[48:51], v[184:199]
    ds_read_b64_tr_b16 v[112:113], v40 offset:20480
    v_mfma_f32_32x32x16_bf16 v[200:215], v[80:83], v[52:55], v[200:215]
    ds_read_b64_tr_b16 v[114:115], v40 offset:21504
    v_mfma_f32_32x32x16_bf16 v[216:231], v[84:87], v[48:51], v[216:231]
    ds_read_b64_tr_b16 v[116:117], v41 offset:20480
    v_mfma_f32_32x32x16_bf16 v[232:247], v[84:87], v[52:55], v[232:247]
    ds_read_b64_tr_b16 v[118:119], v41 offset:21504
    s_waitcnt lgkmcnt(10)
    s_waitcnt vmcnt(0)
    v_add_f32 v24, v24, v27
    v_add_f32 v24, v24, v28
    v_add_f32 v24, v24, v29
    v_add_f32 v8, v8, v10
    v_add_f32 v9, v9, v11
    v_add_f32 v8, v8, v12
    v_add_f32 v9, v9, v13
    v_add_f32 v8, v8, v14
    v_add_f32 v9, v9, v15
    v_add_f32 v8, v8, v16
    v_add_f32 v9, v9, v17
    v_add_f32 v8, v8, v18
    v_add_f32 v9, v9, v19
    v_add_f32 v8, v8, v20
    v_add_f32 v9, v9, v21
    v_add_f32 v8, v8, v22
    v_add_f32 v9, v9, v23
    v_mul_f32 v8, 0x3acccccd, v8
    v_mul_f32 v9, 0x3acccccd, v9
    v_fma_f32 v9, -v8, v8, v9
    v_max_f32 v9, 0, v9
    v_add_f32 v9, 0x3727c5ac, v9
    v_rsq_f32 v9, v9
    s_nop 0
    v_mul_f32 v8, v8, v9
    v_sub_f32 v8, 0, v8
    v_lshlrev_b32 v3, 3, v0
    v_cmp_gt_u32 vcc, 128, v0
    s_and_saveexec_b64 s[60:61], vcc
    s_cbranch_execz aux_geglu_kernel_4
    ds_write_b64 v3, v[8:9] offset:0
aux_geglu_kernel_4:
    s_mov_b64 exec, s[60:61]
    v_lshlrev_b32 v3, 2, v0
    v_cmp_gt_u32 vcc, 256, v0
    s_and_saveexec_b64 s[60:61], vcc
    s_cbranch_execz aux_geglu_kernel_5
    ds_write_b32 v3, v24 offset:1024
aux_geglu_kernel_5:
    s_mov_b64 exec, s[60:61]
    s_mov_b32 s55, 2
loop_geglu_kernel_6:
    ds_read_b128 v[48:51], v38 offset:0
    ds_read_b128 v[52:55], v38 offset:4096
    v_mfma_f32_32x32x16_bf16 v[120:135], v[88:91], v[56:59], v[120:135]
    ds_read_b64_tr_b16 v[72:73], v40 offset:8192
    v_mfma_f32_32x32x16_bf16 v[136:151], v[88:91], v[60:63], v[136:151]
    ds_read_b64_tr_b16 v[74:75], v40 offset:9216
    v_mfma_f32_32x32x16_bf16 v[152:167], v[92:95], v[56:59], v[152:167]
    ds_read_b64_tr_b16 v[76:77], v41 offset:8192
    v_mfma_f32_32x32x16_bf16 v[168:183], v[92:95], v[60:63], v[168:183]
    ds_read_b64_tr_b16 v[78:79], v41 offset:9216
    v_mfma_f32_32x32x16_bf16 v[184:199], v[96:99], v[56:59], v[184:199]
    ds_read_b64_tr_b16 v[80:81], v40 offset:24576
    v_mfma_f32_32x32x16_bf16 v[200:215], v[96:99], v[60:63], v[200:215]
    ds_read_b64_tr_b16 v[82:83], v40 offset:25600
    v_mfma_f32_32x32x16_bf16 v[216:231], v[100:103], v[56:59], v[216:231]
    ds_read_b64_tr_b16 v[84:85], v41 offset:24576
    v_mfma_f32_32x32x16_bf16 v[232:247], v[100:103], v[60:63], v[232:247]
    ds_read_b64_tr_b16 v[86:87], v41 offset:25600
    s_waitcnt lgkmcnt(10)
    ds_read_b128 v[56:59], v39 offset:0
    ds_read_b128 v[60:63], v39 offset:4096
    v_mfma_f32_32x32x16_bf16 v[120:135], v[104:107], v[64:67], v[120:135]
    ds_read_b64_tr_b16 v[88:89], v40 offset:12288
    v_mfma_f32_32x32x16_bf16 v[136:151], v[104:107], v[68:71], v[136:151]
    ds_read_b64_tr_b16 v[90:91], v40 offset:13312
    v_mfma_f32_32x32x16_bf16 v[152:167], v[108:111], v[64:67], v[152:167]
    ds_read_b64_tr_b16 v[92:93], v41 offset:12288
    v_mfma_f32_32x32x16_bf16 v[168:183], v[108:111], v[68:71], v[168:183]
    ds_read_b64_tr_b16 v[94:95], v41 offset:13312
    v_mfma_f32_32x32x16_bf16 v[184:199], v[112:115], v[64:67], v[184:199]
    ds_read_b64_tr_b16 v[96:97], v40 offset:28672
    v_mfma_f32_32x32x16_bf16 v[200:215], v[112:115], v[68:71], v[200:215]
    ds_read_b64_tr_b16 v[98:99], v40 offset:29696
    v_mfma_f32_32x32x16_bf16 v[216:231], v[116:119], v[64:67], v[216:231]
    ds_read_b64_tr_b16 v[100:101], v41 offset:28672
    v_mfma_f32_32x32x16_bf16 v[232:247], v[116:119], v[68:71], v[232:247]
    ds_read_b64_tr_b16 v[102:103], v41 offset:29696
    s_waitcnt lgkmcnt(10)
    s_barrier
    v_add_u32 v36, s51, v30
    v_add_u32 v37, s51, v31
    v_add_u32 v38, s51, v32
    v_add_u32 v39, s51, v33
    v_add_u32 v40, s51, v34
    v_add_u32 v41, s51, v35
    s_add_u32 s51, s51, 49152
    s_cmp_eq_u32 s51, 149504
    s_cselect_b32 s51, 2048, s51
    ds_read_b128 v[64:67], v36 offset:0
    ds_read_b128 v[68:71], v36 offset:4096
    v_mfma_f32_32x32x16_bf16 v[120:135], v[72:75], v[48:51], v[120:135]
    ds_read_b64_tr_b16 v[104:105], v40 offset:0
    v_mfma_f32_32x32x16_bf16 v[136:151], v[72:75], v[52:55], v[136:151]
    ds_read_b64_tr_b16 v[106:107], v40 offset:1024
    v_mfma_f32_32x32x16_bf16 v[152:167], v[76:79], v[48:51], v[152:167]
    ds_read_b64_tr_b16 v[108:109], v41 offset:0
    v_mfma_f32_32x32x16_bf16 v[168:183], v[76:79], v[52:55], v[168:183]
    ds_read_b64_tr_b16 v[110:111], v41 offset:1024
    v_mfma_f32_32x32x16_bf16 v[184:199], v[80:83], v[48:51], v[184:199]
    ds_read_b64_tr_b16 v[112:113], v40 offset:16384
    v_mfma_f32_32x32x16_bf16 v[200:215], v[80:83], v[52:55], v[200:215]
    ds_read_b64_tr_b16 v[114:115], v40 offset:17408
    v_mfma_f32_32x32x16_bf16 v[216:231], v[84:87], v[48:51], v[216:231]
    ds_read_b64_tr_b16 v[116:117], v41 offset:16384
    v_mfma_f32_32x32x16_bf16 v[232:247], v[84:87], v[52:55], v[232:247]
    ds_read_b64_tr_b16 v[118:119], v41 offset:17408
    s_waitcnt lgkmcnt(10)
    ds_read_b128 v[48:51], v37 offset:0
    ds_read_b128 v[52:55], v37 offset:4096
    v_mfma_f32_32x32x16_bf16 v[120:135], v[88:91], v[56:59], v[120:135]
    ds_read_b64_tr_b16 v[72:73], v40 offset:4096
    v_mfma_f32_32x32x16_bf16 v[136:151], v[88:91], v[60:63], v[136:151]
    ds_read_b64_tr_b16 v[74:75], v40 offset:5120
    v_mfma_f32_32x32x16_bf16 v[152:167], v[92:95], v[56:59], v[152:167]
    ds_read_b64_tr_b16 v[76:77], v41 offset:4096
    v_mfma_f32_32x32x16_bf16 v[168:183], v[92:95], v[60:63], v[168:183]
    ds_read_b64_tr_b16 v[78:79], v41 offset:5120
    v_mfma_f32_32x32x16_bf16 v[184:199], v[96:99], v[56:59], v[184:199]
    ds_read_b64_tr_b16 v[80:81], v40 offset:20480
    v_mfma_f32_32x32x16_bf16 v[200:215], v[96:99], v[60:63], v[200:215]
    ds_read_b64_tr_b16 v[82:83], v40 offset:21504
    v_mfma_f32_32x32x16_bf16 v[216:231], v[100:103], v[56:59], v[216:231]
    ds_read_b64_tr_b16 v[84:85], v41 offset:20480
    v_mfma_f32_32x32x16_bf16 v[232:247], v[100:103], v[60:63], v[232:247]
    ds_read_b64_tr_b16 v[86:87], v41 offset:21504
    s_waitcnt lgkmcnt(10)
    ds_read_b128 v[56:59], v38 offset:0
    ds_read_b128 v[60:63], v38 offset:4096
    v_mfma_f32_32x32x16_bf16 v[120:135], v[104:107], v[64:67], v[120:135]
    ds_read_b64_tr_b16 v[88:89], v40 offset:8192
    v_mfma_f32_32x32x16_bf16 v[136:151], v[104:107], v[68:71], v[136:151]
    ds_read_b64_tr_b16 v[90:91], v40 offset:9216
    v_mfma_f32_32x32x16_bf16 v[152:167], v[108:111], v[64:67], v[152:167]
    ds_read_b64_tr_b16 v[92:93], v41 offset:8192
    v_mfma_f32_32x32x16_bf16 v[168:183], v[108:111], v[68:71], v[168:183]
    ds_read_b64_tr_b16 v[94:95], v41 offset:9216
    v_mfma_f32_32x32x16_bf16 v[184:199], v[112:115], v[64:67], v[184:199]
    ds_read_b64_tr_b16 v[96:97], v40 offset:24576
    v_mfma_f32_32x32x16_bf16 v[200:215], v[112:115], v[68:71], v[200:215]
    ds_read_b64_tr_b16 v[98:99], v40 offset:25600
    v_mfma_f32_32x32x16_bf16 v[216:231], v[116:119], v[64:67], v[216:231]
    ds_read_b64_tr_b16 v[100:101], v41 offset:24576
    v_mfma_f32_32x32x16_bf16 v[232:247], v[116:119], v[68:71], v[232:247]
    ds_read_b64_tr_b16 v[102:103], v41 offset:25600
    s_waitcnt lgkmcnt(10)
    ds_read_b128 v[64:67], v39 offset:0
    ds_read_b128 v[68:71], v39 offset:4096
    v_mfma_f32_32x32x16_bf16 v[120:135], v[72:75], v[48:51], v[120:135]
    ds_read_b64_tr_b16 v[104:105], v40 offset:12288
    v_mfma_f32_32x32x16_bf16 v[136:151], v[72:75], v[52:55], v[136:151]
    ds_read_b64_tr_b16 v[106:107], v40 offset:13312
    v_mfma_f32_32x32x16_bf16 v[152:167], v[76:79], v[48:51], v[152:167]
    ds_read_b64_tr_b16 v[108:109], v41 offset:12288
    v_mfma_f32_32x32x16_bf16 v[168:183], v[76:79], v[52:55], v[168:183]
    ds_read_b64_tr_b16 v[110:111], v41 offset:13312
    v_mfma_f32_32x32x16_bf16 v[184:199], v[80:83], v[48:51], v[184:199]
    ds_read_b64_tr_b16 v[112:113], v40 offset:28672
    v_mfma_f32_32x32x16_bf16 v[200:215], v[80:83], v[52:55], v[200:215]
    ds_read_b64_tr_b16 v[114:115], v40 offset:29696
    v_mfma_f32_32x32x16_bf16 v[216:231], v[84:87], v[48:51], v[216:231]
    ds_read_b64_tr_b16 v[116:117], v41 offset:28672
    v_mfma_f32_32x32x16_bf16 v[232:247], v[84:87], v[52:55], v[232:247]
    ds_read_b64_tr_b16 v[118:119], v41 offset:29696
    s_waitcnt lgkmcnt(10)
    s_barrier
    v_add_u32 v36, s51, v30
    v_add_u32 v37, s51, v31
    v_add_u32 v38, s51, v32
    v_add_u32 v39, s51, v33
    v_add_u32 v40, s51, v34
    v_add_u32 v41, s51, v35
    s_add_u32 s51, s51, 49152
    s_cmp_eq_u32 s51, 149504
    s_cselect_b32 s51, 2048, s51
    ds_read_b128 v[48:51], v36 offset:0
    ds_read_b128 v[52:55], v36 offset:4096
    v_mfma_f32_32x32x16_bf16 v[120:135], v[88:91], v[56:59], v[120:135]
    ds_read_b64_tr_b16 v[72:73], v40 offset:0
    v_mfma_f32_32x32x16_bf16 v[136:151], v[88:91], v[60:63], v[136:151]
    ds_read_b64_tr_b16 v[74:75], v40 offset:1024
    v_mfma_f32_32x32x16_bf16 v[152:167], v[92:95], v[56:59], v[152:167]
    ds_read_b64_tr_b16 v[76:77], v41 offset:0
    v_mfma_f32_32x32x16_bf16 v[168:183], v[92:95], v[60:63], v[168:183]
    ds_read_b64_tr_b16 v[78:79], v41 offset:1024
    v_mfma_f32_32x32x16_bf16 v[184:199], v[96:99], v[56:59], v[184:199]
    ds_read_b64_tr_b16 v[80:81], v40 offset:16384
    v_mfma_f32_32x32x16_bf16 v[200:215], v[96:99], v[60:63], v[200:215]
    ds_read_b64_tr_b16 v[82:83], v40 offset:17408
    v_mfma_f32_32x32x16_bf16 v[216:231], v[100:103], v[56:59], v[216:231]
    ds_read_b64_tr_b16 v[84:85], v41 offset:16384
    v_mfma_f32_32x32x16_bf16 v[232:247], v[100:103], v[60:63], v[232:247]
    ds_read_b64_tr_b16 v[86:87], v41 offset:17408
    s_waitcnt lgkmcnt(10)
    ds_read_b128 v[56:59], v37 offset:0
    ds_read_b128 v[60:63], v37 offset:4096
    v_mfma_f32_32x32x16_bf16 v[120:135], v[104:107], v[64:67], v[120:135]
    ds_read_b64_tr_b16 v[88:89], v40 offset:4096
    v_mfma_f32_32x32x16_bf16 v[136:151], v[104:107], v[68:71], v[136:151]
    ds_read_b64_tr_b16 v[90:91], v40 offset:5120
    v_mfma_f32_32x32x16_bf16 v[152:167], v[108:111], v[64:67], v[152:167]
    ds_read_b64_tr_b16 v[92:93], v41 offset:4096
    v_mfma_f32_32x32x16_bf16 v[168:183], v[108:111], v[68:71], v[168:183]
    ds_read_b64_tr_b16 v[94:95], v41 offset:5120
    v_mfma_f32_32x32x16_bf16 v[184:199], v[112:115], v[64:67], v[184:199]
    ds_read_b64_tr_b16 v[96:97], v40 offset:20480
    v_mfma_f32_32x32x16_bf16 v[200:215], v[112:115], v[68:71], v[200:215]
    ds_read_b64_tr_b16 v[98:99], v40 offset:21504
    v_mfma_f32_32x32x16_bf16 v[216:231], v[116:119], v[64:67], v[216:231]
    ds_read_b64_tr_b16 v[100:101], v41 offset:20480
    v_mfma_f32_32x32x16_bf16 v[232:247], v[116:119], v[68:71], v[232:247]
    ds_read_b64_tr_b16 v[102:103], v41 offset:21504
    s_waitcnt lgkmcnt(10)
    ds_read_b128 v[64:67], v38 offset:0
    ds_read_b128 v[68:71], v38 offset:4096
    v_mfma_f32_32x32x16_bf16 v[120:135], v[72:75], v[48:51], v[120:135]
    ds_read_b64_tr_b16 v[104:105], v40 offset:8192
    v_mfma_f32_32x32x16_bf16 v[136:151], v[72:75], v[52:55], v[136:151]
    ds_read_b64_tr_b16 v[106:107], v40 offset:9216
    v_mfma_f32_32x32x16_bf16 v[152:167], v[76:79], v[48:51], v[152:167]
    ds_read_b64_tr_b16 v[108:109], v41 offset:8192
    v_mfma_f32_32x32x16_bf16 v[168:183], v[76:79], v[52:55], v[168:183]
    ds_read_b64_tr_b16 v[110:111], v41 offset:9216
    v_mfma_f32_32x32x16_bf16 v[184:199], v[80:83], v[48:51], v[184:199]
    ds_read_b64_tr_b16 v[112:113], v40 offset:24576
    v_mfma_f32_32x32x16_bf16 v[200:215], v[80:83], v[52:55], v[200:215]
    ds_read_b64_tr_b16 v[114:115], v40 offset:25600
    v_mfma_f32_32x32x16_bf16 v[216:231], v[84:87], v[48:51], v[216:231]
    ds_read_b64_tr_b16 v[116:117], v41 offset:24576
    v_mfma_f32_32x32x16_bf16 v[232:247], v[84:87], v[52:55], v[232:247]
    ds_read_b64_tr_b16 v[118:119], v41 offset:25600
    s_waitcnt lgkmcnt(10)
    ds_read_b128 v[48:51], v39 offset:0
    ds_read_b128 v[52:55], v39 offset:4096
    v_mfma_f32_32x32x16_bf16 v[120:135], v[88:91], v[56:59], v[120:135]
    ds_read_b64_tr_b16 v[72:73], v40 offset:12288
    v_mfma_f32_32x32x16_bf16 v[136:151], v[88:91], v[60:63], v[136:151]
    ds_read_b64_tr_b16 v[74:75], v40 offset:13312
    v_mfma_f32_32x32x16_bf16 v[152:167], v[92:95], v[56:59], v[152:167]
    ds_read_b64_tr_b16 v[76:77], v41 offset:12288
    v_mfma_f32_32x32x16_bf16 v[168:183], v[92:95], v[60:63], v[168:183]
    ds_read_b64_tr_b16 v[78:79], v41 offset:13312
    v_mfma_f32_32x32x16_bf16 v[184:199], v[96:99], v[56:59], v[184:199]
    ds_read_b64_tr_b16 v[80:81], v40 offset:28672
    v_mfma_f32_32x32x16_bf16 v[200:215], v[96:99], v[60:63], v[200:215]
    ds_read_b64_tr_b16 v[82:83], v40 offset:29696
    v_mfma_f32_32x32x16_bf16 v[216:231], v[100:103], v[56:59], v[216:231]
    ds_read_b64_tr_b16 v[84:85], v41 offset:28672
    v_mfma_f32_32x32x16_bf16 v[232:247], v[100:103], v[60:63], v[232:247]
    ds_read_b64_tr_b16 v[86:87], v41 offset:29696
    s_waitcnt lgkmcnt(10)
    s_barrier
    v_add_u32 v36, s51, v30
    v_add_u32 v37, s51, v31
    v_add_u32 v38, s51, v32
    v_add_u32 v39, s51, v33
    v_add_u32 v40, s51, v34
    v_add_u32 v41, s51, v35
    s_add_u32 s51, s51, 49152
    s_cmp_eq_u32 s51, 149504
    s_cselect_b32 s51, 2048, s51
    ds_read_b128 v[56:59], v36 offset:0
    ds_read_b128 v[60:63], v36 offset:4096
    v_mfma_f32_32x32x16_bf16 v[120:135], v[104:107], v[64:67], v[120:135]
    ds_read_b64_tr_b16 v[88:89], v40 offset:0
    v_mfma_f32_32x32x16_bf16 v[136:151], v[104:107], v[68:71], v[136:151]
    ds_read_b64_tr_b16 v[90:91], v40 offset:1024
    v_mfma_f32_32x32x16_bf16 v[152:167], v[108:111], v[64:67], v[152:167]
    ds_read_b64_tr_b16 v[92:93], v41 offset:0
    v_mfma_f32_32x32x16_bf16 v[168:183], v[108:111], v[68:71], v[168:183]
    ds_read_b64_tr_b16 v[94:95], v41 offset:1024
    v_mfma_f32_32x32x16_bf16 v[184:199], v[112:115], v[64:67], v[184:199]
    ds_read_b64_tr_b16 v[96:97], v40 offset:16384
    v_mfma_f32_32x32x16_bf16 v[200:215], v[112:115], v[68:71], v[200:215]
    ds_read_b64_tr_b16 v[98:99], v40 offset:17408
    v_mfma_f32_32x32x16_bf16 v[216:231], v[116:119], v[64:67], v[216:231]
    ds_read_b64_tr_b16 v[100:101], v41 offset:16384
    v_mfma_f32_32x32x16_bf16 v[232:247], v[116:119], v[68:71], v[232:247]
    ds_read_b64_tr_b16 v[102:103], v41 offset:17408
    s_waitcnt lgkmcnt(10)
    ds_read_b128 v[64:67], v37 offset:0
    ds_read_b128 v[68:71], v37 offset:4096
    v_mfma_f32_32x32x16_bf16 v[120:135], v[72:75], v[48:51], v[120:135]
    ds_read_b64_tr_b16 v[104:105], v40 offset:4096
    v_mfma_f32_32x32x16_bf16 v[136:151], v[72:75], v[52:55], v[136:151]
    ds_read_b64_tr_b16 v[106:107], v40 offset:5120
    v_mfma_f32_32x32x16_bf16 v[152:167], v[76:79], v[48:51], v[152:167]
    ds_read_b64_tr_b16 v[108:109], v41 offset:4096
    v_mfma_f32_32x32x16_bf16 v[168:183], v[76:79], v[52:55], v[168:183]
    ds_read_b64_tr_b16 v[110:111], v41 offset:5120
    v_mfma_f32_32x32x16_bf16 v[184:199], v[80:83], v[48:51], v[184:199]
    ds_read_b64_tr_b16 v[112:113], v40 offset:20480
    v_mfma_f32_32x32x16_bf16 v[200:215], v[80:83], v[52:55], v[200:215]
    ds_read_b64_tr_b16 v[114:115], v40 offset:21504
    v_mfma_f32_32x32x16_bf16 v[216:231], v[84:87], v[48:51], v[216:231]
    ds_read_b64_tr_b16 v[116:117], v41 offset:20480
    v_mfma_f32_32x32x16_bf16 v[232:247], v[84:87], v[52:55], v[232:247]
    ds_read_b64_tr_b16 v[118:119], v41 offset:21504
    s_waitcnt lgkmcnt(10)
    s_sub_u32 s55, s55, 1
    s_cmp_lg_u32 s55, 0
    s_cbranch_scc1 loop_geglu_kernel_6
    ds_read_b128 v[48:51], v38 offset:0
    ds_read_b128 v[52:55], v38 offset:4096
    v_mfma_f32_32x32x16_bf16 v[120:135], v[88:91], v[56:59], v[120:135]
    ds_read_b64_tr_b16 v[72:73], v40 offset:8192
    v_mfma_f32_32x32x16_bf16 v[136:151], v[88:91], v[60:63], v[136:151]
    ds_read_b64_tr_b16 v[74:75], v40 offset:9216
    v_mfma_f32_32x32x16_bf16 v[152:167], v[92:95], v[56:59], v[152:167]
    ds_read_b64_tr_b16 v[76:77], v41 offset:8192
    v_mfma_f32_32x32x16_bf16 v[168:183], v[92:95], v[60:63], v[168:183]
    ds_read_b64_tr_b16 v[78:79], v41 offset:9216
    v_mfma_f32_32x32x16_bf16 v[184:199], v[96:99], v[56:59], v[184:199]
    ds_read_b64_tr_b16 v[80:81], v40 offset:24576
    v_mfma_f32_32x32x16_bf16 v[200:215], v[96:99], v[60:63], v[200:215]
    ds_read_b64_tr_b16 v[82:83], v40 offset:25600
    v_mfma_f32_32x32x16_bf16 v[216:231], v[100:103], v[56:59], v[216:231]
    ds_read_b64_tr_b16 v[84:85], v41 offset:24576
    v_mfma_f32_32x32x16_bf16 v[232:247], v[100:103], v[60:63], v[232:247]
    ds_read_b64_tr_b16 v[86:87], v41 offset:25600
    s_waitcnt lgkmcnt(10)
    ds_read_b128 v[56:59], v39 offset:0
    ds_read_b128 v[60:63], v39 offset:4096
    v_mfma_f32_32x32x16_bf16 v[120:135], v[104:107], v[64:67], v[120:135]
    ds_read_b64_tr_b16 v[88:89], v40 offset:12288
    v_mfma_f32_32x32x16_bf16 v[136:151], v[104:107], v[68:71], v[136:151]
    ds_read_b64_tr_b16 v[90:91], v40 offset:13312
    v_mfma_f32_32x32x16_bf16 v[152:167], v[108:111], v[64:67], v[152:167]
    ds_read_b64_tr_b16 v[92:93], v41 offset:12288
    v_mfma_f32_32x32x16_bf16 v[168:183], v[108:111], v[68:71], v[168:183]
    ds_read_b64_tr_b16 v[94:95], v41 offset:13312
    v_mfma_f32_32x32x16_bf16 v[184:199], v[112:115], v[64:67], v[184:199]
    ds_read_b64_tr_b16 v[96:97], v40 offset:28672
    v_mfma_f32_32x32x16_bf16 v[200:215], v[112:115], v[68:71], v[200:215]
    ds_read_b64_tr_b16 v[98:99], v40 offset:29696
    v_mfma_f32_32x32x16_bf16 v[216:231], v[116:119], v[64:67], v[216:231]
    ds_read_b64_tr_b16 v[100:101], v41 offset:28672
    v_mfma_f32_32x32x16_bf16 v[232:247], v[116:119], v[68:71], v[232:247]
    ds_read_b64_tr_b16 v[102:103], v41 offset:29696
    s_waitcnt lgkmcnt(10)
    s_barrier
    v_add_u32 v36, s51, v30
    v_add_u32 v37, s51, v31
    v_add_u32 v38, s51, v32
    v_add_u32 v39, s51, v33
    v_add_u32 v40, s51, v34
    v_add_u32 v41, s51, v35
    s_add_u32 s51, s51, 49152
    s_cmp_eq_u32 s51, 149504
    s_cselect_b32 s51, 2048, s51
    ds_read_b128 v[64:67], v36 offset:0
    ds_read_b128 v[68:71], v36 offset:4096
    v_mfma_f32_32x32x16_bf16 v[120:135], v[72:75], v[48:51], v[120:135]
    ds_read_b64_tr_b16 v[104:105], v40 offset:0
    v_mfma_f32_32x32x16_bf16 v[136:151], v[72:75], v[52:55], v[136:151]
    ds_read_b64_tr_b16 v[106:107], v40 offset:1024
    v_mfma_f32_32x32x16_bf16 v[152:167], v[76:79], v[48:51], v[152:167]
    ds_read_b64_tr_b16 v[108:109], v41 offset:0
    v_mfma_f32_32x32x16_bf16 v[168:183], v[76:79], v[52:55], v[168:183]
    ds_read_b64_tr_b16 v[110:111], v41 offset:1024
    v_mfma_f32_32x32x16_bf16 v[184:199], v[80:83], v[48:51], v[184:199]
    ds_read_b64_tr_b16 v[112:113], v40 offset:16384
    v_mfma_f32_32x32x16_bf16 v[200:215], v[80:83], v[52:55], v[200:215]
    ds_read_b64_tr_b16 v[114:115], v40 offset:17408
    v_mfma_f32_32x32x16_bf16 v[216:231], v[84:87], v[48:51], v[216:231]
    ds_read_b64_tr_b16 v[116:117], v41 offset:16384
    v_mfma_f32_32x32x16_bf16 v[232:247], v[84:87], v[52:55], v[232:247]
    ds_read_b64_tr_b16 v[118:119], v41 offset:17408
    s_waitcnt lgkmcnt(10)
    ds_read_b128 v[48:51], v37 offset:0
    ds_read_b128 v[52:55], v37 offset:4096
    v_mfma_f32_32x32x16_bf16 v[120:135], v[88:91], v[56:59], v[120:135]
    ds_read_b64_tr_b16 v[72:73], v40 offset:4096
    v_mfma_f32_32x32x16_bf16 v[136:151], v[88:91], v[60:63], v[136:151]
    ds_read_b64_tr_b16 v[74:75], v40 offset:5120
    v_mfma_f32_32x32x16_bf16 v[152:167], v[92:95], v[56:59], v[152:167]
    ds_read_b64_tr_b16 v[76:77], v41 offset:4096
    v_mfma_f32_32x32x16_bf16 v[168:183], v[92:95], v[60:63], v[168:183]
    ds_read_b64_tr_b16 v[78:79], v41 offset:5120
    v_mfma_f32_32x32x16_bf16 v[184:199], v[96:99], v[56:59], v[184:199]
    ds_read_b64_tr_b16 v[80:81], v40 offset:20480
    v_mfma_f32_32x32x16_bf16 v[200:215], v[96:99], v[60:63], v[200:215]
    ds_read_b64_tr_b16 v[82:83], v40 offset:21504
    v_mfma_f32_32x32x16_bf16 v[216:231], v[100:103], v[56:59], v[216:231]
    ds_read_b64_tr_b16 v[84:85], v41 offset:20480
    v_mfma_f32_32x32x16_bf16 v[232:247], v[100:103], v[60:63], v[232:247]
    ds_read_b64_tr_b16 v[86:87], v41 offset:21504
    s_waitcnt lgkmcnt(10)
    ds_read_b128 v[56:59], v38 offset:0
    ds_read_b128 v[60:63], v38 offset:4096
    v_mfma_f32_32x32x16_bf16 v[120:135], v[104:107], v[64:67], v[120:135]
    ds_read_b64_tr_b16 v[88:89], v40 offset:8192
    v_mfma_f32_32x32x16_bf16 v[136:151], v[104:107], v[68:71], v[136:151]
    ds_read_b64_tr_b16 v[90:91], v40 offset:9216
    v_mfma_f32_32x32x16_bf16 v[152:167], v[108:111], v[64:67], v[152:167]
    ds_read_b64_tr_b16 v[92:93], v41 offset:8192
    v_mfma_f32_32x32x16_bf16 v[168:183], v[108:111], v[68:71], v[168:183]
    ds_read_b64_tr_b16 v[94:95], v41 offset:9216
    v_mfma_f32_32x32x16_bf16 v[184:199], v[112:115], v[64:67], v[184:199]
    ds_read_b64_tr_b16 v[96:97], v40 offset:24576
    v_mfma_f32_32x32x16_bf16 v[200:215], v[112:115], v[68:71], v[200:215]
    ds_read_b64_tr_b16 v[98:99], v40 offset:25600
    v_mfma_f32_32x32x16_bf16 v[216:231], v[116:119], v[64:67], v[216:231]
    ds_read_b64_tr_b16 v[100:101], v41 offset:24576
    v_mfma_f32_32x32x16_bf16 v[232:247], v[116:119], v[68:71], v[232:247]
    ds_read_b64_tr_b16 v[102:103], v41 offset:25600
    s_waitcnt lgkmcnt(10)
    ds_read_b128 v[64:67], v39 offset:0
    ds_read_b128 v[68:71], v39 offset:4096
    v_mfma_f32_32x32x16_bf16 v[120:135], v[72:75], v[48:51], v[120:135]
    ds_read_b64_tr_b16 v[104:105], v40 offset:12288
    v_mfma_f32_32x32x16_bf16 v[136:151], v[72:75], v[52:55], v[136:151]
    ds_read_b64_tr_b16 v[106:107], v40 offset:13312
    v_mfma_f32_32x32x16_bf16 v[152:167], v[76:79], v[48:51], v[152:167]
    ds_read_b64_tr_b16 v[108:109], v41 offset:12288
    v_mfma_f32_32x32x16_bf16 v[168:183], v[76:79], v[52:55], v[168:183]
    ds_read_b64_tr_b16 v[110:111], v41 offset:13312
    v_mfma_f32_32x32x16_bf16 v[184:199], v[80:83], v[48:51], v[184:199]
    ds_read_b64_tr_b16 v[112:113], v40 offset:28672
    v_mfma_f32_32x32x16_bf16 v[200:215], v[80:83], v[52:55], v[200:215]
    ds_read_b64_tr_b16 v[114:115], v40 offset:29696
    v_mfma_f32_32x32x16_bf16 v[216:231], v[84:87], v[48:51], v[216:231]
    ds_read_b64_tr_b16 v[116:117], v41 offset:28672
    v_mfma_f32_32x32x16_bf16 v[232:247], v[84:87], v[52:55], v[232:247]
    ds_read_b64_tr_b16 v[118:119], v41 offset:29696
    s_waitcnt lgkmcnt(10)
    s_barrier
    v_add_u32 v36, s51, v30
    v_add_u32 v37, s51, v31
    v_add_u32 v38, s51, v32
    v_add_u32 v39, s51, v33
    v_add_u32 v40, s51, v34
    v_add_u32 v41, s51, v35
    s_add_u32 s51, s51, 49152
    s_cmp_eq_u32 s51, 149504
    s_cselect_b32 s51, 2048, s51
    ds_read_b128 v[48:51], v36 offset:0
    ds_read_b128 v[52:55], v36 offset:4096
    v_mfma_f32_32x32x16_bf16 v[120:135], v[88:91], v[56:59], v[120:135]
    ds_read_b64_tr_b16 v[72:73], v40 offset:0
    v_mfma_f32_32x32x16_bf16 v[136:151], v[88:91], v[60:63], v[136:151]
    ds_read_b64_tr_b16 v[74:75], v40 offset:1024
    v_mfma_f32_32x32x16_bf16 v[152:167], v[92:95], v[56:59], v[152:167]
    ds_read_b64_tr_b16 v[76:77], v41 offset:0
    v_mfma_f32_32x32x16_bf16 v[168:183], v[92:95], v[60:63], v[168:183]
    ds_read_b64_tr_b16 v[78:79], v41 offset:1024
    v_mfma_f32_32x32x16_bf16 v[184:199], v[96:99], v[56:59], v[184:199]
    ds_read_b64_tr_b16 v[80:81], v40 offset:16384
    v_mfma_f32_32x32x16_bf16 v[200:215], v[96:99], v[60:63], v[200:215]
    ds_read_b64_tr_b16 v[82:83], v40 offset:17408
    v_mfma_f32_32x32x16_bf16 v[216:231], v[100:103], v[56:59], v[216:231]
    ds_read_b64_tr_b16 v[84:85], v41 offset:16384
    v_mfma_f32_32x32x16_bf16 v[232:247], v[100:103], v[60:63], v[232:247]
    ds_read_b64_tr_b16 v[86:87], v41 offset:17408
    s_waitcnt lgkmcnt(10)
    ds_read_b128 v[56:59], v37 offset:0
    ds_read_b128 v[60:63], v37 offset:4096
    v_mfma_f32_32x32x16_bf16 v[120:135], v[104:107], v[64:67], v[120:135]
    ds_read_b64_tr_b16 v[88:89], v40 offset:4096
    v_mfma_f32_32x32x16_bf16 v[136:151], v[104:107], v[68:71], v[136:151]
    ds_read_b64_tr_b16 v[90:91], v40 offset:5120
    v_mfma_f32_32x32x16_bf16 v[152:167], v[108:111], v[64:67], v[152:167]
    ds_read_b64_tr_b16 v[92:93], v41 offset:4096
    v_mfma_f32_32x32x16_bf16 v[168:183], v[108:111], v[68:71], v[168:183]
    ds_read_b64_tr_b16 v[94:95], v41 offset:5120
    v_mfma_f32_32x32x16_bf16 v[184:199], v[112:115], v[64:67], v[184:199]
    ds_read_b64_tr_b16 v[96:97], v40 offset:20480
    v_mfma_f32_32x32x16_bf16 v[200:215], v[112:115], v[68:71], v[200:215]
    ds_read_b64_tr_b16 v[98:99], v40 offset:21504
    v_mfma_f32_32x32x16_bf16 v[216:231], v[116:119], v[64:67], v[216:231]
    ds_read_b64_tr_b16 v[100:101], v41 offset:20480
    v_mfma_f32_32x32x16_bf16 v[232:247], v[116:119], v[68:71], v[232:247]
    ds_read_b64_tr_b16 v[102:103], v41 offset:21504
    s_waitcnt lgkmcnt(10)
    ds_read_b128 v[64:67], v38 offset:0
    ds_read_b128 v[68:71], v38 offset:4096
    v_mfma_f32_32x32x16_bf16 v[120:135], v[72:75], v[48:51], v[120:135]
    ds_read_b64_tr_b16 v[104:105], v40 offset:8192
    v_mfma_f32_32x32x16_bf16 v[136:151], v[72:75], v[52:55], v[136:151]
    ds_read_b64_tr_b16 v[106:107], v40 offset:9216
    v_mfma_f32_32x32x16_bf16 v[152:167], v[76:79], v[48:51], v[152:167]
    ds_read_b64_tr_b16 v[108:109], v41 offset:8192
    v_mfma_f32_32x32x16_bf16 v[168:183], v[76:79], v[52:55], v[168:183]
    ds_read_b64_tr_b16 v[110:111], v41 offset:9216
    v_mfma_f32_32x32x16_bf16 v[184:199], v[80:83], v[48:51], v[184:199]
    ds_read_b64_tr_b16 v[112:113], v40 offset:24576
    v_mfma_f32_32x32x16_bf16 v[200:215], v[80:83], v[52:55], v[200:215]
    ds_read_b64_tr_b16 v[114:115], v40 offset:25600
    v_mfma_f32_32x32x16_bf16 v[216:231], v[84:87], v[48:51], v[216:231]
    ds_read_b64_tr_b16 v[116:117], v41 offset:24576
    v_mfma_f32_32x32x16_bf16 v[232:247], v[84:87], v[52:55], v[232:247]
    ds_read_b64_tr_b16 v[118:119], v41 offset:25600
    s_waitcnt lgkmcnt(10)
    ds_read_b128 v[48:51], v39 offset:0
    ds_read_b128 v[52:55], v39 offset:4096
    v_mfma_f32_32x32x16_bf16 v[120:135], v[88:91], v[56:59], v[120:135]
    ds_read_b64_tr_b16 v[72:73], v40 offset:12288
    v_mfma_f32_32x32x16_bf16 v[136:151], v[88:91], v[60:63], v[136:151]
    ds_read_b64_tr_b16 v[74:75], v40 offset:13312
    v_mfma_f32_32x32x16_bf16 v[152:167], v[92:95], v[56:59], v[152:167]
    ds_read_b64_tr_b16 v[76:77], v41 offset:12288
    v_mfma_f32_32x32x16_bf16 v[168:183], v[92:95], v[60:63], v[168:183]
    ds_read_b64_tr_b16 v[78:79], v41 offset:13312
    v_mfma_f32_32x32x16_bf16 v[184:199], v[96:99], v[56:59], v[184:199]
    ds_read_b64_tr_b16 v[80:81], v40 offset:28672
    v_mfma_f32_32x32x16_bf16 v[200:215], v[96:99], v[60:63], v[200:215]
    ds_read_b64_tr_b16 v[82:83], v40 offset:29696
    v_mfma_f32_32x32x16_bf16 v[216:231], v[100:103], v[56:59], v[216:231]
    ds_read_b64_tr_b16 v[84:85], v41 offset:28672
    v_mfma_f32_32x32x16_bf16 v[232:247], v[100:103], v[60:63], v[232:247]
    ds_read_b64_tr_b16 v[86:87], v41 offset:29696
    s_waitcnt lgkmcnt(10)
    v_mfma_f32_32x32x16_bf16 v[120:135], v[104:107], v[64:67], v[120:135]
    v_mfma_f32_32x32x16_bf16 v[136:151], v[104:107], v[68:71], v[136:151]
    v_mfma_f32_32x32x16_bf16 v[152:167], v[108:111], v[64:67], v[152:167]
    v_mfma_f32_32x32x16_bf16 v[168:183], v[108:111], v[68:71], v[168:183]
    v_mfma_f32_32x32x16_bf16 v[184:199], v[112:115], v[64:67], v[184:199]
    v_mfma_f32_32x32x16_bf16 v[200:215], v[112:115], v[68:71], v[200:215]
    v_mfma_f32_32x32x16_bf16 v[216:231], v[116:119], v[64:67], v[216:231]
    v_mfma_f32_32x32x16_bf16 v[232:247], v[116:119], v[68:71], v[232:247]
    s_waitcnt lgkmcnt(0)
    v_mfma_f32_32x32x16_bf16 v[120:135], v[72:75], v[48:51], v[120:135]
    v_mfma_f32_32x32x16_bf16 v[136:151], v[72:75], v[52:55], v[136:151]
    v_mfma_f32_32x32x16_bf16 v[152:167], v[76:79], v[48:51], v[152:167]
    v_mfma_f32_32x32x16_bf16 v[168:183], v[76:79], v[52:55], v[168:183]
    v_mfma_f32_32x32x16_bf16 v[184:199], v[80:83], v[48:51], v[184:199]
    v_mfma_f32_32x32x16_bf16 v[200:215], v[80:83], v[52:55], v[200:215]
    v_mfma_f32_32x32x16_bf16 v[216:231], v[84:87], v[48:51], v[216:231]
    v_mfma_f32_32x32x16_bf16 v[232:247], v[84:87], v[52:55], v[232:247]
    s_nop 7
    s_nop 7
    s_lshl_b32 s58, s6, 9
    v_lshlrev_b32 v84, 3, v43
    v_add_u32 v84, s58, v84
    ds_read_b64 v[80:81], v84 offset:0
    ds_read_b64 v[82:83], v84 offset:256
    s_lshl_b32 s58, s3, 1
    s_add_u32 s58, s58, s6
    s_mul_i32 s58, s58, 54
    s_lshl_b32 s60, s4, 2
    s_add_u32 s58, s58, s60
    s_lshl_b32 s60, s7, 1
    s_add_u32 s58, s58, s60
    s_lshl_b32 s58, s58, 12
    v_bfe_u32 v85, v43, 2, 2
    v_sub_u32 v85, 0, v85
    v_lshlrev_b32 v86, 1, v42
    v_xor_b32 v85, v85, v86
    v_and_b32 v85, 3, v85
    v_lshlrev_b32 v88, 6, v43
    v_add_u32 v88, s58, v88
    v_xor_b32 v86, 1, v85
    v_lshl_add_u32 v89, v86, 4, v88
    v_lshl_add_u32 v88, v85, 4, v88
    s_lshl_b32 s58, s7, 6
    s_add_u32 s58, s58, s57
    s_cmp_lt_u32 s58, 1728
    s_cselect_b32 s58, 0, 0x7ff00000
    v_add_u32 v88, s58, v88
    v_add_u32 v89, s58, v89
    v_mov_b32 v100, 0xc0135761
    v_mov_b32 v101, 0xbdd2d3e8
    v_mov_b32 v102, 1.0
    s_lshl_b32 s58, s7, 8
    v_lshlrev_b32 v85, 6, v42
    v_add_u32 v85, s58, v85
    ds_read_b128 v[8:11], v85 offset:1024
    ds_read_b128 v[48:51], v85 offset:1536
    ds_read_b128 v[12:15], v85 offset:1040
    ds_read_b128 v[52:55], v85 offset:1552
    ds_read_b128 v[16:19], v85 offset:1056
    ds_read_b128 v[56:59], v85 offset:1568
    ds_read_b128 v[20:23], v85 offset:1072
    ds_read_b128 v[60:63], v85 offset:1584
    s_waitcnt lgkmcnt(0)
    v_pk_mul_f32 v[64:65], v[120:121], v[80:81] op_sel:[0,1] op_sel_hi:[1,1]
    v_pk_mul_f32 v[72:73], v[184:185], v[80:81] op_sel:[0,1] op_sel_hi:[1,1]
    v_pk_fma_f32 v[64:65], v[8:9], v[80:81], v[64:65] op_sel_hi:[1,0,1]
    v_pk_fma_f32 v[72:73], v[48:49], v[80:81], v[72:73] op_sel_hi:[1,0,1]
    v_pk_mul_f32 v[66:67], v[122:123], v[80:81] op_sel:[0,1] op_sel_hi:[1,1]
    v_pk_mul_f32 v[74:75], v[186:187], v[80:81] op_sel:[0,1] op_sel_hi:[1,1]
    v_pk_fma_f32 v[66:67], v[10:11], v[80:81], v[66:67] op_sel_hi:[1,0,1]
    v_pk_fma_f32 v[74:75], v[50:51], v[80:81], v[74:75] op_sel_hi:[1,0,1]
    v_pk_mul_f32 v[68:69], v[124:125], v[80:81] op_sel:[0,1] op_sel_hi:[1,1]
    v_pk_mul_f32 v[76:77], v[188:189], v[80:81] op_sel:[0,1] op_sel_hi:[1,1]
    v_pk_fma_f32 v[68:69], v[12:13], v[80:81], v[68:69] op_sel_hi:[1,0,1]
    v_pk_fma_f32 v[76:77], v[52:53], v[80:81], v[76:77] op_sel_hi:[1,0,1]
    v_pk_mul_f32 v[70:71], v[126:127], v[80:81] op_sel:[0,1] op_sel_hi:[1,1]
    v_pk_mul_f32 v[78:79], v[190:191], v[80:81] op_sel:[0,1] op_sel_hi:[1,1]
    v_pk_fma_f32 v[70:71], v[14:15], v[80:81], v[70:71] op_sel_hi:[1,0,1]
    v_pk_fma_f32 v[78:79], v[54:55], v[80:81], v[78:79] op_sel_hi:[1,0,1]
    v_pk_mul_f32 v[92:93], v[64:65], v[64:65]
    v_pk_mul_f32 v[72:73], v[72:73], v[64:65]
    v_pk_fma_f32 v[92:93], v[92:93], v[100:101], v[100:101] op_sel:[0,1,0] op_sel_hi:[1,1,0]
    v_pk_mul_f32 v[92:93], v[92:93], v[64:65]
    v_pk_mul_f32 v[94:95], v[66:67], v[66:67]
    v_pk_mul_f32 v[74:75], v[74:75], v[66:67]
    v_pk_fma_f32 v[94:95], v[94:95], v[100:101], v[100:101] op_sel:[0,1,0] op_sel_hi:[1,1,0]
    v_pk_mul_f32 v[94:95], v[94:95], v[66:67]
    v_pk_mul_f32 v[96:97], v[68:69], v[68:69]
    v_pk_mul_f32 v[76:77], v[76:77], v[68:69]
    v_pk_fma_f32 v[96:97], v[96:97], v[100:101], v[100:101] op_sel:[0,1,0] op_sel_hi:[1,1,0]
    v_pk_mul_f32 v[96:97], v[96:97], v[68:69]
    v_pk_mul_f32 v[98:99], v[70:71], v[70:71]
    v_pk_mul_f32 v[78:79], v[78:79], v[70:71]
    v_pk_fma_f32 v[98:99], v[98:99], v[100:101], v[100:101] op_sel:[0,1,0] op_sel_hi:[1,1,0]
    v_pk_mul_f32 v[98:99], v[98:99], v[70:71]
    v_exp_f32 v92, v92
    v_exp_f32 v93, v93
    v_exp_f32 v94, v94
    v_exp_f32 v95, v95
    v_exp_f32 v96, v96
    v_exp_f32 v97, v97
    v_exp_f32 v98, v98
    v_exp_f32 v99, v99
    s_nop 0
    v_pk_add_f32 v[92:93], v[92:93], v[102:103] op_sel_hi:[1,0]
    v_pk_add_f32 v[94:95], v[94:95], v[102:103] op_sel_hi:[1,0]
    v_pk_add_f32 v[96:97], v[96:97], v[102:103] op_sel_hi:[1,0]
    v_pk_add_f32 v[98:99], v[98:99], v[102:103] op_sel_hi:[1,0]
    v_rcp_f32 v92, v92
    v_rcp_f32 v93, v93
    v_rcp_f32 v94, v94
    v_rcp_f32 v95, v95
    v_rcp_f32 v96, v96
    v_rcp_f32 v97, v97
    v_rcp_f32 v98, v98
    v_rcp_f32 v99, v99
    s_nop 0
    v_pk_mul_f32 v[64:65], v[72:73], v[92:93]
    v_pk_mul_f32 v[66:67], v[74:75], v[94:95]
    v_pk_mul_f32 v[68:69], v[76:77], v[96:97]
    v_pk_mul_f32 v[70:71], v[78:79], v[98:99]
    v_cvt_pk_bf16_f32 v72, v64, v65
    v_cvt_pk_bf16_f32 v73, v66, v67
    v_cvt_pk_bf16_f32 v74, v68, v69
    v_cvt_pk_bf16_f32 v75, v70, v71
    buffer_store_dwordx4 v[72:75], v88, s[24:27], 0 offen offset:0
    s_nop 1
    v_pk_mul_f32 v[64:65], v[128:129], v[80:81] op_sel:[0,1] op_sel_hi:[1,1]
    v_pk_mul_f32 v[72:73], v[192:193], v[80:81] op_sel:[0,1] op_sel_hi:[1,1]
    v_pk_fma_f32 v[64:65], v[16:17], v[80:81], v[64:65] op_sel_hi:[1,0,1]
    v_pk_fma_f32 v[72:73], v[56:57], v[80:81], v[72:73] op_sel_hi:[1,0,1]
    v_pk_mul_f32 v[66:67], v[130:131], v[80:81] op_sel:[0,1] op_sel_hi:[1,1]
    v_pk_mul_f32 v[74:75], v[194:195], v[80:81] op_sel:[0,1] op_sel_hi:[1,1]
    v_pk_fma_f32 v[66:67], v[18:19], v[80:81], v[66:67] op_sel_hi:[1,0,1]
    v_pk_fma_f32 v[74:75], v[58:59], v[80:81], v[74:75] op_sel_hi:[1,0,1]
    v_pk_mul_f32 v[68:69], v[132:133], v[80:81] op_sel:[0,1] op_sel_hi:[1,1]
    v_pk_mul_f32 v[76:77], v[196:197], v[80:81] op_sel:[0,1] op_sel_hi:[1,1]
    v_pk_fma_f32 v[68:69], v[20:21], v[80:81], v[68:69] op_sel_hi:[1,0,1]
    v_pk_fma_f32 v[76:77], v[60:61], v[80:81], v[76:77] op_sel_hi:[1,0,1]
    v_pk_mul_f32 v[70:71], v[134:135], v[80:81] op_sel:[0,1] op_sel_hi:[1,1]
    v_pk_mul_f32 v[78:79], v[198:199], v[80:81] op_sel:[0,1] op_sel_hi:[1,1]
    v_pk_fma_f32 v[70:71], v[22:23], v[80:81], v[70:71] op_sel_hi:[1,0,1]
    v_pk_fma_f32 v[78:79], v[62:63], v[80:81], v[78:79] op_sel_hi:[1,0,1]
    v_pk_mul_f32 v[92:93], v[64:65], v[64:65]
    v_pk_mul_f32 v[72:73], v[72:73], v[64:65]
    v_pk_fma_f32 v[92:93], v[92:93], v[100:101], v[100:101] op_sel:[0,1,0] op_sel_hi:[1,1,0]
    v_pk_mul_f32 v[92:93], v[92:93], v[64:65]
    v_pk_mul_f32 v[94:95], v[66:67], v[66:67]
    v_pk_mul_f32 v[74:75], v[74:75], v[66:67]
    v_pk_fma_f32 v[94:95], v[94:95], v[100:101], v[100:101] op_sel:[0,1,0] op_sel_hi:[1,1,0]
    v_pk_mul_f32 v[94:95], v[94:95], v[66:67]
    v_pk_mul_f32 v[96:97], v[68:69], v[68:69]
    v_pk_mul_f32 v[76:77], v[76:77], v[68:69]
    v_pk_fma_f32 v[96:97], v[96:97], v[100:101], v[100:101] op_sel:[0,1,0] op_sel_hi:[1,1,0]
    v_pk_mul_f32 v[96:97], v[96:97], v[68:69]
    v_pk_mul_f32 v[98:99], v[70:71], v[70:71]
    v_pk_mul_f32 v[78:79], v[78:79], v[70:71]
    v_pk_fma_f32 v[98:99], v[98:99], v[100:101], v[100:101] op_sel:[0,1,0] op_sel_hi:[1,1,0]
    v_pk_mul_f32 v[98:99], v[98:99], v[70:71]
    v_exp_f32 v92, v92
    v_exp_f32 v93, v93
    v_exp_f32 v94, v94
    v_exp_f32 v95, v95
    v_exp_f32 v96, v96
    v_exp_f32 v97, v97
    v_exp_f32 v98, v98
    v_exp_f32 v99, v99
    s_nop 0
    v_pk_add_f32 v[92:93], v[92:93], v[102:103] op_sel_hi:[1,0]
    v_pk_add_f32 v[94:95], v[94:95], v[102:103] op_sel_hi:[1,0]
    v_pk_add_f32 v[96:97], v[96:97], v[102:103] op_sel_hi:[1,0]
    v_pk_add_f32 v[98:99], v[98:99], v[102:103] op_sel_hi:[1,0]
    v_rcp_f32 v92, v92
    v_rcp_f32 v93, v93
    v_rcp_f32 v94, v94
    v_rcp_f32 v95, v95
    v_rcp_f32 v96, v96
    v_rcp_f32 v97, v97
    v_rcp_f32 v98, v98
    v_rcp_f32 v99, v99
    s_nop 0
    v_pk_mul_f32 v[64:65], v[72:73], v[92:93]
    v_pk_mul_f32 v[66:67], v[74:75], v[94:95]
    v_pk_mul_f32 v[68:69], v[76:77], v[96:97]
    v_pk_mul_f32 v[70:71], v[78:79], v[98:99]
    v_cvt_pk_bf16_f32 v72, v64, v65
    v_cvt_pk_bf16_f32 v73, v66, v67
    v_cvt_pk_bf16_f32 v74, v68, v69
    v_cvt_pk_bf16_f32 v75, v70, v71
    buffer_store_dwordx4 v[72:75], v89, s[24:27], 0 offen offset:0
    s_nop 1
    v_pk_mul_f32 v[64:65], v[136:137], v[82:83] op_sel:[0,1] op_sel_hi:[1,1]
    v_pk_mul_f32 v[72:73], v[200:201], v[82:83] op_sel:[0,1] op_sel_hi:[1,1]
    v_pk_fma_f32 v[64:65], v[8:9], v[82:83], v[64:65] op_sel_hi:[1,0,1]
    v_pk_fma_f32 v[72:73], v[48:49], v[82:83], v[72:73] op_sel_hi:[1,0,1]
    v_pk_mul_f32 v[66:67], v[138:139], v[82:83] op_sel:[0,1] op_sel_hi:[1,1]
    v_pk_mul_f32 v[74:75], v[202:203], v[82:83] op_sel:[0,1] op_sel_hi:[1,1]
    v_pk_fma_f32 v[66:67], v[10:11], v[82:83], v[66:67] op_sel_hi:[1,0,1]
    v_pk_fma_f32 v[74:75], v[50:51], v[82:83], v[74:75] op_sel_hi:[1,0,1]
    v_pk_mul_f32 v[68:69], v[140:141], v[82:83] op_sel:[0,1] op_sel_hi:[1,1]
    v_pk_mul_f32 v[76:77], v[204:205], v[82:83] op_sel:[0,1] op_sel_hi:[1,1]
    v_pk_fma_f32 v[68:69], v[12:13], v[82:83], v[68:69] op_sel_hi:[1,0,1]
    v_pk_fma_f32 v[76:77], v[52:53], v[82:83], v[76:77] op_sel_hi:[1,0,1]
    v_pk_mul_f32 v[70:71], v[142:143], v[82:83] op_sel:[0,1] op_sel_hi:[1,1]
    v_pk_mul_f32 v[78:79], v[206:207], v[82:83] op_sel:[0,1] op_sel_hi:[1,1]
    v_pk_fma_f32 v[70:71], v[14:15], v[82:83], v[70:71] op_sel_hi:[1,0,1]
    v_pk_fma_f32 v[78:79], v[54:55], v[82:83], v[78:79] op_sel_hi:[1,0,1]
    v_pk_mul_f32 v[92:93], v[64:65], v[64:65]
    v_pk_mul_f32 v[72:73], v[72:73], v[64:65]
    v_pk_fma_f32 v[92:93], v[92:93], v[100:101], v[100:101] op_sel:[0,1,0] op_sel_hi:[1,1,0]
    v_pk_mul_f32 v[92:93], v[92:93], v[64:65]
    v_pk_mul_f32 v[94:95], v[66:67], v[66:67]
    v_pk_mul_f32 v[74:75], v[74:75], v[66:67]
    v_pk_fma_f32 v[94:95], v[94:95], v[100:101], v[100:101] op_sel:[0,1,0] op_sel_hi:[1,1,0]
    v_pk_mul_f32 v[94:95], v[94:95], v[66:67]
    v_pk_mul_f32 v[96:97], v[68:69], v[68:69]
    v_pk_mul_f32 v[76:77], v[76:77], v[68:69]
    v_pk_fma_f32 v[96:97], v[96:97], v[100:101], v[100:101] op_sel:[0,1,0] op_sel_hi:[1,1,0]
    v_pk_mul_f32 v[96:97], v[96:97], v[68:69]
    v_pk_mul_f32 v[98:99], v[70:71], v[70:71]
    v_pk_mul_f32 v[78:79], v[78:79], v[70:71]
    v_pk_fma_f32 v[98:99], v[98:99], v[100:101], v[100:101] op_sel:[0,1,0] op_sel_hi:[1,1,0]
    v_pk_mul_f32 v[98:99], v[98:99], v[70:71]
    v_exp_f32 v92, v92
    v_exp_f32 v93, v93
    v_exp_f32 v94, v94
    v_exp_f32 v95, v95
    v_exp_f32 v96, v96
    v_exp_f32 v97, v97
    v_exp_f32 v98, v98
    v_exp_f32 v99, v99
    s_nop 0
    v_pk_add_f32 v[92:93], v[92:93], v[102:103] op_sel_hi:[1,0]
    v_pk_add_f32 v[94:95], v[94:95], v[102:103] op_sel_hi:[1,0]
    v_pk_add_f32 v[96:97], v[96:97], v[102:103] op_sel_hi:[1,0]
    v_pk_add_f32 v[98:99], v[98:99], v[102:103] op_sel_hi:[1,0]
    v_rcp_f32 v92, v92
    v_rcp_f32 v93, v93
    v_rcp_f32 v94, v94
    v_rcp_f32 v95, v95
    v_rcp_f32 v96, v96
    v_rcp_f32 v97, v97
    v_rcp_f32 v98, v98
    v_rcp_f32 v99, v99
    s_nop 0
    v_pk_mul_f32 v[64:65], v[72:73], v[92:93]
    v_pk_mul_f32 v[66:67], v[74:75], v[94:95]
    v_pk_mul_f32 v[68:69], v[76:77], v[96:97]
    v_pk_mul_f32 v[70:71], v[78:79], v[98:99]
    v_cvt_pk_bf16_f32 v72, v64, v65
    v_cvt_pk_bf16_f32 v73, v66, v67
    v_cvt_pk_bf16_f32 v74, v68, v69
    v_cvt_pk_bf16_f32 v75, v70, v71
    buffer_store_dwordx4 v[72:75], v88, s[24:27], 0 offen offset:2048
    s_nop 1
    v_pk_mul_f32 v[64:65], v[144:145], v[82:83] op_sel:[0,1] op_sel_hi:[1,1]
    v_pk_mul_f32 v[72:73], v[208:209], v[82:83] op_sel:[0,1] op_sel_hi:[1,1]
    v_pk_fma_f32 v[64:65], v[16:17], v[82:83], v[64:65] op_sel_hi:[1,0,1]
    v_pk_fma_f32 v[72:73], v[56:57], v[82:83], v[72:73] op_sel_hi:[1,0,1]
    v_pk_mul_f32 v[66:67], v[146:147], v[82:83] op_sel:[0,1] op_sel_hi:[1,1]
    v_pk_mul_f32 v[74:75], v[210:211], v[82:83] op_sel:[0,1] op_sel_hi:[1,1]
    v_pk_fma_f32 v[66:67], v[18:19], v[82:83], v[66:67] op_sel_hi:[1,0,1]
    v_pk_fma_f32 v[74:75], v[58:59], v[82:83], v[74:75] op_sel_hi:[1,0,1]
    v_pk_mul_f32 v[68:69], v[148:149], v[82:83] op_sel:[0,1] op_sel_hi:[1,1]
    v_pk_mul_f32 v[76:77], v[212:213], v[82:83] op_sel:[0,1] op_sel_hi:[1,1]
    v_pk_fma_f32 v[68:69], v[20:21], v[82:83], v[68:69] op_sel_hi:[1,0,1]
    v_pk_fma_f32 v[76:77], v[60:61], v[82:83], v[76:77] op_sel_hi:[1,0,1]
    v_pk_mul_f32 v[70:71], v[150:151], v[82:83] op_sel:[0,1] op_sel_hi:[1,1]
    v_pk_mul_f32 v[78:79], v[214:215], v[82:83] op_sel:[0,1] op_sel_hi:[1,1]
    v_pk_fma_f32 v[70:71], v[22:23], v[82:83], v[70:71] op_sel_hi:[1,0,1]
    v_pk_fma_f32 v[78:79], v[62:63], v[82:83], v[78:79] op_sel_hi:[1,0,1]
    v_pk_mul_f32 v[92:93], v[64:65], v[64:65]
    v_pk_mul_f32 v[72:73], v[72:73], v[64:65]
    v_pk_fma_f32 v[92:93], v[92:93], v[100:101], v[100:101] op_sel:[0,1,0] op_sel_hi:[1,1,0]
    v_pk_mul_f32 v[92:93], v[92:93], v[64:65]
    v_pk_mul_f32 v[94:95], v[66:67], v[66:67]
    v_pk_mul_f32 v[74:75], v[74:75], v[66:67]
    v_pk_fma_f32 v[94:95], v[94:95], v[100:101], v[100:101] op_sel:[0,1,0] op_sel_hi:[1,1,0]
    v_pk_mul_f32 v[94:95], v[94:95], v[66:67]
    v_pk_mul_f32 v[96:97], v[68:69], v[68:69]
    v_pk_mul_f32 v[76:77], v[76:77], v[68:69]
    v_pk_fma_f32 v[96:97], v[96:97], v[100:101], v[100:101] op_sel:[0,1,0] op_sel_hi:[1,1,0]
    v_pk_mul_f32 v[96:97], v[96:97], v[68:69]
    v_pk_mul_f32 v[98:99], v[70:71], v[70:71]
    v_pk_mul_f32 v[78:79], v[78:79], v[70:71]
    v_pk_fma_f32 v[98:99], v[98:99], v[100:101], v[100:101] op_sel:[0,1,0] op_sel_hi:[1,1,0]
    v_pk_mul_f32 v[98:99], v[98:99], v[70:71]
    v_exp_f32 v92, v92
    v_exp_f32 v93, v93
    v_exp_f32 v94, v94
    v_exp_f32 v95, v95
    v_exp_f32 v96, v96
    v_exp_f32 v97, v97
    v_exp_f32 v98, v98
    v_exp_f32 v99, v99
    s_nop 0
    v_pk_add_f32 v[92:93], v[92:93], v[102:103] op_sel_hi:[1,0]
    v_pk_add_f32 v[94:95], v[94:95], v[102:103] op_sel_hi:[1,0]
    v_pk_add_f32 v[96:97], v[96:97], v[102:103] op_sel_hi:[1,0]
    v_pk_add_f32 v[98:99], v[98:99], v[102:103] op_sel_hi:[1,0]
    v_rcp_f32 v92, v92
    v_rcp_f32 v93, v93
    v_rcp_f32 v94, v94
    v_rcp_f32 v95, v95
    v_rcp_f32 v96, v96
    v_rcp_f32 v97, v97
    v_rcp_f32 v98, v98
    v_rcp_f32 v99, v99
    s_nop 0
    v_pk_mul_f32 v[64:65], v[72:73], v[92:93]
    v_pk_mul_f32 v[66:67], v[74:75], v[94:95]
    v_pk_mul_f32 v[68:69], v[76:77], v[96:97]
    v_pk_mul_f32 v[70:71], v[78:79], v[98:99]
    v_cvt_pk_bf16_f32 v72, v64, v65
    v_cvt_pk_bf16_f32 v73, v66, v67
    v_cvt_pk_bf16_f32 v74, v68, v69
    v_cvt_pk_bf16_f32 v75, v70, v71
    buffer_store_dwordx4 v[72:75], v89, s[24:27], 0 offen offset:2048
    s_nop 1
    ds_read_b128 v[8:11], v85 offset:1152
    ds_read_b128 v[48:51], v85 offset:1664
    ds_read_b128 v[12:15], v85 offset:1168
    ds_read_b128 v[52:55], v85 offset:1680
    ds_read_b128 v[16:19], v85 offset:1184
    ds_read_b128 v[56:59], v85 offset:1696
    ds_read_b128 v[20:23], v85 offset:1200
    ds_read_b128 v[60:63], v85 offset:1712
    s_waitcnt lgkmcnt(0)
    v_pk_mul_f32 v[64:65], v[152:153], v[80:81] op_sel:[0,1] op_sel_hi:[1,1]
    v_pk_mul_f32 v[72:73], v[216:217], v[80:81] op_sel:[0,1] op_sel_hi:[1,1]
    v_pk_fma_f32 v[64:65], v[8:9], v[80:81], v[64:65] op_sel_hi:[1,0,1]
    v_pk_fma_f32 v[72:73], v[48:49], v[80:81], v[72:73] op_sel_hi:[1,0,1]
    v_pk_mul_f32 v[66:67], v[154:155], v[80:81] op_sel:[0,1] op_sel_hi:[1,1]
    v_pk_mul_f32 v[74:75], v[218:219], v[80:81] op_sel:[0,1] op_sel_hi:[1,1]
    v_pk_fma_f32 v[66:67], v[10:11], v[80:81], v[66:67] op_sel_hi:[1,0,1]
    v_pk_fma_f32 v[74:75], v[50:51], v[80:81], v[74:75] op_sel_hi:[1,0,1]
    v_pk_mul_f32 v[68:69], v[156:157], v[80:81] op_sel:[0,1] op_sel_hi:[1,1]
    v_pk_mul_f32 v[76:77], v[220:221], v[80:81] op_sel:[0,1] op_sel_hi:[1,1]
    v_pk_fma_f32 v[68:69], v[12:13], v[80:81], v[68:69] op_sel_hi:[1,0,1]
    v_pk_fma_f32 v[76:77], v[52:53], v[80:81], v[76:77] op_sel_hi:[1,0,1]
    v_pk_mul_f32 v[70:71], v[158:159], v[80:81] op_sel:[0,1] op_sel_hi:[1,1]
    v_pk_mul_f32 v[78:79], v[222:223], v[80:81] op_sel:[0,1] op_sel_hi:[1,1]
    v_pk_fma_f32 v[70:71], v[14:15], v[80:81], v[70:71] op_sel_hi:[1,0,1]
    v_pk_fma_f32 v[78:79], v[54:55], v[80:81], v[78:79] op_sel_hi:[1,0,1]
    v_pk_mul_f32 v[92:93], v[64:65], v[64:65]
    v_pk_mul_f32 v[72:73], v[72:73], v[64:65]
    v_pk_fma_f32 v[92:93], v[92:93], v[100:101], v[100:101] op_sel:[0,1,0] op_sel_hi:[1,1,0]
    v_pk_mul_f32 v[92:93], v[92:93], v[64:65]
    v_pk_mul_f32 v[94:95], v[66:67], v[66:67]
    v_pk_mul_f32 v[74:75], v[74:75], v[66:67]
    v_pk_fma_f32 v[94:95], v[94:95], v[100:101], v[100:101] op_sel:[0,1,0] op_sel_hi:[1,1,0]
    v_pk_mul_f32 v[94:95], v[94:95], v[66:67]
    v_pk_mul_f32 v[96:97], v[68:69], v[68:69]
    v_pk_mul_f32 v[76:77], v[76:77], v[68:69]
    v_pk_fma_f32 v[96:97], v[96:97], v[100:101], v[100:101] op_sel:[0,1,0] op_sel_hi:[1,1,0]
    v_pk_mul_f32 v[96:97], v[96:97], v[68:69]
    v_pk_mul_f32 v[98:99], v[70:71], v[70:71]
    v_pk_mul_f32 v[78:79], v[78:79], v[70:71]
    v_pk_fma_f32 v[98:99], v[98:99], v[100:101], v[100:101] op_sel:[0,1,0] op_sel_hi:[1,1,0]
    v_pk_mul_f32 v[98:99], v[98:99], v[70:71]
    v_exp_f32 v92, v92
    v_exp_f32 v93, v93
    v_exp_f32 v94, v94
    v_exp_f32 v95, v95
    v_exp_f32 v96, v96
    v_exp_f32 v97, v97
    v_exp_f32 v98, v98
    v_exp_f32 v99, v99
    s_nop 0
    v_pk_add_f32 v[92:93], v[92:93], v[102:103] op_sel_hi:[1,0]
    v_pk_add_f32 v[94:95], v[94:95], v[102:103] op_sel_hi:[1,0]
    v_pk_add_f32 v[96:97], v[96:97], v[102:103] op_sel_hi:[1,0]
    v_pk_add_f32 v[98:99], v[98:99], v[102:103] op_sel_hi:[1,0]
    v_rcp_f32 v92, v92
    v_rcp_f32 v93, v93
    v_rcp_f32 v94, v94
    v_rcp_f32 v95, v95
    v_rcp_f32 v96, v96
    v_rcp_f32 v97, v97
    v_rcp_f32 v98, v98
    v_rcp_f32 v99, v99
    s_nop 0
    v_pk_mul_f32 v[64:65], v[72:73], v[92:93]
    v_pk_mul_f32 v[66:67], v[74:75], v[94:95]
    v_pk_mul_f32 v[68:69], v[76:77], v[96:97]
    v_pk_mul_f32 v[70:71], v[78:79], v[98:99]
    v_cvt_pk_bf16_f32 v72, v64, v65
    v_cvt_pk_bf16_f32 v73, v66, v67
    v_cvt_pk_bf16_f32 v74, v68, v69
    v_cvt_pk_bf16_f32 v75, v70, v71
    s_movk_i32 s61, 4096
    buffer_store_dwordx4 v[72:75], v88, s[24:27], s61 offen offset:0
    s_nop 1
    v_pk_mul_f32 v[64:65], v[160:161], v[80:81] op_sel:[0,1] op_sel_hi:[1,1]
    v_pk_mul_f32 v[72:73], v[224:225], v[80:81] op_sel:[0,1] op_sel_hi:[1,1]
    v_pk_fma_f32 v[64:65], v[16:17], v[80:81], v[64:65] op_sel_hi:[1,0,1]
    v_pk_fma_f32 v[72:73], v[56:57], v[80:81], v[72:73] op_sel_hi:[1,0,1]
    v_pk_mul_f32 v[66:67], v[162:163], v[80:81] op_sel:[0,1] op_sel_hi:[1,1]
    v_pk_mul_f32 v[74:75], v[226:227], v[80:81] op_sel:[0,1] op_sel_hi:[1,1]
    v_pk_fma_f32 v[66:67], v[18:19], v[80:81], v[66:67] op_sel_hi:[1,0,1]
    v_pk_fma_f32 v[74:75], v[58:59], v[80:81], v[74:75] op_sel_hi:[1,0,1]
    v_pk_mul_f32 v[68:69], v[164:165], v[80:81] op_sel:[0,1] op_sel_hi:[1,1]
    v_pk_mul_f32 v[76:77], v[228:229], v[80:81] op_sel:[0,1] op_sel_hi:[1,1]
    v_pk_fma_f32 v[68:69], v[20:21], v[80:81], v[68:69] op_sel_hi:[1,0,1]
    v_pk_fma_f32 v[76:77], v[60:61], v[80:81], v[76:77] op_sel_hi:[1,0,1]
    v_pk_mul_f32 v[70:71], v[166:167], v[80:81] op_sel:[0,1] op_sel_hi:[1,1]
    v_pk_mul_f32 v[78:79], v[230:231], v[80:81] op_sel:[0,1] op_sel_hi:[1,1]
    v_pk_fma_f32 v[70:71], v[22:23], v[80:81], v[70:71] op_sel_hi:[1,0,1]
    v_pk_fma_f32 v[78:79], v[62:63], v[80:81], v[78:79] op_sel_hi:[1,0,1]
    v_pk_mul_f32 v[92:93], v[64:65], v[64:65]
    v_pk_mul_f32 v[72:73], v[72:73], v[64:65]
    v_pk_fma_f32 v[92:93], v[92:93], v[100:101], v[100:101] op_sel:[0,1,0] op_sel_hi:[1,1,0]
    v_pk_mul_f32 v[92:93], v[92:93], v[64:65]
    v_pk_mul_f32 v[94:95], v[66:67], v[66:67]
    v_pk_mul_f32 v[74:75], v[74:75], v[66:67]
    v_pk_fma_f32 v[94:95], v[94:95], v[100:101], v[100:101] op_sel:[0,1,0] op_sel_hi:[1,1,0]
    v_pk_mul_f32 v[94:95], v[94:95], v[66:67]
    v_pk_mul_f32 v[96:97], v[68:69], v[68:69]
    v_pk_mul_f32 v[76:77], v[76:77], v[68:69]
    v_pk_fma_f32 v[96:97], v[96:97], v[100:101], v[100:101] op_sel:[0,1,0] op_sel_hi:[1,1,0]
    v_pk_mul_f32 v[96:97], v[96:97], v[68:69]
    v_pk_mul_f32 v[98:99], v[70:71], v[70:71]
    v_pk_mul_f32 v[78:79], v[78:79], v[70:71]
    v_pk_fma_f32 v[98:99], v[98:99], v[100:101], v[100:101] op_sel:[0,1,0] op_sel_hi:[1,1,0]
    v_pk_mul_f32 v[98:99], v[98:99], v[70:71]
    v_exp_f32 v92, v92
    v_exp_f32 v93, v93
    v_exp_f32 v94, v94
    v_exp_f32 v95, v95
    v_exp_f32 v96, v96
    v_exp_f32 v97, v97
    v_exp_f32 v98, v98
    v_exp_f32 v99, v99
    s_nop 0
    v_pk_add_f32 v[92:93], v[92:93], v[102:103] op_sel_hi:[1,0]
    v_pk_add_f32 v[94:95], v[94:95], v[102:103] op_sel_hi:[1,0]
    v_pk_add_f32 v[96:97], v[96:97], v[102:103] op_sel_hi:[1,0]
    v_pk_add_f32 v[98:99], v[98:99], v[102:103] op_sel_hi:[1,0]
    v_rcp_f32 v92, v92
    v_rcp_f32 v93, v93
    v_rcp_f32 v94, v94
    v_rcp_f32 v95, v95
    v_rcp_f32 v96, v96
    v_rcp_f32 v97, v97
    v_rcp_f32 v98, v98
    v_rcp_f32 v99, v99
    s_nop 0
    v_pk_mul_f32 v[64:65], v[72:73], v[92:93]
    v_pk_mul_f32 v[66:67], v[74:75], v[94:95]
    v_pk_mul_f32 v[68:69], v[76:77], v[96:97]
    v_pk_mul_f32 v[70:71], v[78:79], v[98:99]
    v_cvt_pk_bf16_f32 v72, v64, v65
    v_cvt_pk_bf16_f32 v73, v66, v67
    v_cvt_pk_bf16_f32 v74, v68, v69
    v_cvt_pk_bf16_f32 v75, v70, v71
    s_movk_i32 s61, 4096
    buffer_store_dwordx4 v[72:75], v89, s[24:27], s61 offen offset:0
    s_nop 1
    v_pk_mul_f32 v[64:65], v[168:169], v[82:83] op_sel:[0,1] op_sel_hi:[1,1]
    v_pk_mul_f32 v[72:73], v[232:233], v[82:83] op_sel:[0,1] op_sel_hi:[1,1]
    v_pk_fma_f32 v[64:65], v[8:9], v[82:83], v[64:65] op_sel_hi:[1,0,1]
    v_pk_fma_f32 v[72:73], v[48:49], v[82:83], v[72:73] op_sel_hi:[1,0,1]
    v_pk_mul_f32 v[66:67], v[170:171], v[82:83] op_sel:[0,1] op_sel_hi:[1,1]
    v_pk_mul_f32 v[74:75], v[234:235], v[82:83] op_sel:[0,1] op_sel_hi:[1,1]
    v_pk_fma_f32 v[66:67], v[10:11], v[82:83], v[66:67] op_sel_hi:[1,0,1]
    v_pk_fma_f32 v[74:75], v[50:51], v[82:83], v[74:75] op_sel_hi:[1,0,1]
    v_pk_mul_f32 v[68:69], v[172:173], v[82:83] op_sel:[0,1] op_sel_hi:[1,1]
    v_pk_mul_f32 v[76:77], v[236:237], v[82:83] op_sel:[0,1] op_sel_hi:[1,1]
    v_pk_fma_f32 v[68:69], v[12:13], v[82:83], v[68:69] op_sel_hi:[1,0,1]
    v_pk_fma_f32 v[76:77], v[52:53], v[82:83], v[76:77] op_sel_hi:[1,0,1]
    v_pk_mul_f32 v[70:71], v[174:175], v[82:83] op_sel:[0,1] op_sel_hi:[1,1]
    v_pk_mul_f32 v[78:79], v[238:239], v[82:83] op_sel:[0,1] op_sel_hi:[1,1]
    v_pk_fma_f32 v[70:71], v[14:15], v[82:83], v[70:71] op_sel_hi:[1,0,1]
    v_pk_fma_f32 v[78:79], v[54:55], v[82:83], v[78:79] op_sel_hi:[1,0,1]
    v_pk_mul_f32 v[92:93], v[64:65], v[64:65]
    v_pk_mul_f32 v[72:73], v[72:73], v[64:65]
    v_pk_fma_f32 v[92:93], v[92:93], v[100:101], v[100:101] op_sel:[0,1,0] op_sel_hi:[1,1,0]
    v_pk_mul_f32 v[92:93], v[92:93], v[64:65]
    v_pk_mul_f32 v[94:95], v[66:67], v[66:67]
    v_pk_mul_f32 v[74:75], v[74:75], v[66:67]
    v_pk_fma_f32 v[94:95], v[94:95], v[100:101], v[100:101] op_sel:[0,1,0] op_sel_hi:[1,1,0]
    v_pk_mul_f32 v[94:95], v[94:95], v[66:67]
    v_pk_mul_f32 v[96:97], v[68:69], v[68:69]
    v_pk_mul_f32 v[76:77], v[76:77], v[68:69]
    v_pk_fma_f32 v[96:97], v[96:97], v[100:101], v[100:101] op_sel:[0,1,0] op_sel_hi:[1,1,0]
    v_pk_mul_f32 v[96:97], v[96:97], v[68:69]
    v_pk_mul_f32 v[98:99], v[70:71], v[70:71]
    v_pk_mul_f32 v[78:79], v[78:79], v[70:71]
    v_pk_fma_f32 v[98:99], v[98:99], v[100:101], v[100:101] op_sel:[0,1,0] op_sel_hi:[1,1,0]
    v_pk_mul_f32 v[98:99], v[98:99], v[70:71]
    v_exp_f32 v92, v92
    v_exp_f32 v93, v93
    v_exp_f32 v94, v94
    v_exp_f32 v95, v95
    v_exp_f32 v96, v96
    v_exp_f32 v97, v97
    v_exp_f32 v98, v98
    v_exp_f32 v99, v99
    s_nop 0
    v_pk_add_f32 v[92:93], v[92:93], v[102:103] op_sel_hi:[1,0]
    v_pk_add_f32 v[94:95], v[94:95], v[102:103] op_sel_hi:[1,0]
    v_pk_add_f32 v[96:97], v[96:97], v[102:103] op_sel_hi:[1,0]
    v_pk_add_f32 v[98:99], v[98:99], v[102:103] op_sel_hi:[1,0]
    v_rcp_f32 v92, v92
    v_rcp_f32 v93, v93
    v_rcp_f32 v94, v94
    v_rcp_f32 v95, v95
    v_rcp_f32 v96, v96
    v_rcp_f32 v97, v97
    v_rcp_f32 v98, v98
    v_rcp_f32 v99, v99
    s_nop 0
    v_pk_mul_f32 v[64:65], v[72:73], v[92:93]
    v_pk_mul_f32 v[66:67], v[74:75], v[94:95]
    v_pk_mul_f32 v[68:69], v[76:77], v[96:97]
    v_pk_mul_f32 v[70:71], v[78:79], v[98:99]
    v_cvt_pk_bf16_f32 v72, v64, v65
    v_cvt_pk_bf16_f32 v73, v66, v67
    v_cvt_pk_bf16_f32 v74, v68, v69
    v_cvt_pk_bf16_f32 v75, v70, v71
    s_movk_i32 s61, 4096
    buffer_store_dwordx4 v[72:75], v88, s[24:27], s61 offen offset:2048
    s_nop 1
    v_pk_mul_f32 v[64:65], v[176:177], v[82:83] op_sel:[0,1] op_sel_hi:[1,1]
    v_pk_mul_f32 v[72:73], v[240:241], v[82:83] op_sel:[0,1] op_sel_hi:[1,1]
    v_pk_fma_f32 v[64:65], v[16:17], v[82:83], v[64:65] op_sel_hi:[1,0,1]
    v_pk_fma_f32 v[72:73], v[56:57], v[82:83], v[72:73] op_sel_hi:[1,0,1]
    v_pk_mul_f32 v[66:67], v[178:179], v[82:83] op_sel:[0,1] op_sel_hi:[1,1]
    v_pk_mul_f32 v[74:75], v[242:243], v[82:83] op_sel:[0,1] op_sel_hi:[1,1]
    v_pk_fma_f32 v[66:67], v[18:19], v[82:83], v[66:67] op_sel_hi:[1,0,1]
    v_pk_fma_f32 v[74:75], v[58:59], v[82:83], v[74:75] op_sel_hi:[1,0,1]
    v_pk_mul_f32 v[68:69], v[180:181], v[82:83] op_sel:[0,1] op_sel_hi:[1,1]
    v_pk_mul_f32 v[76:77], v[244:245], v[82:83] op_sel:[0,1] op_sel_hi:[1,1]
    v_pk_fma_f32 v[68:69], v[20:21], v[82:83], v[68:69] op_sel_hi:[1,0,1]
    v_pk_fma_f32 v[76:77], v[60:61], v[82:83], v[76:77] op_sel_hi:[1,0,1]
    v_pk_mul_f32 v[70:71], v[182:183], v[82:83] op_sel:[0,1] op_sel_hi:[1,1]
    v_pk_mul_f32 v[78:79], v[246:247], v[82:83] op_sel:[0,1] op_sel_hi:[1,1]
    v_pk_fma_f32 v[70:71], v[22:23], v[82:83], v[70:71] op_sel_hi:[1,0,1]
    v_pk_fma_f32 v[78:79], v[62:63], v[82:83], v[78:79] op_sel_hi:[1,0,1]
    v_pk_mul_f32 v[92:93], v[64:65], v[64:65]
    v_pk_mul_f32 v[72:73], v[72:73], v[64:65]
    v_pk_fma_f32 v[92:93], v[92:93], v[100:101], v[100:101] op_sel:[0,1,0] op_sel_hi:[1,1,0]
    v_pk_mul_f32 v[92:93], v[92:93], v[64:65]
    v_pk_mul_f32 v[94:95], v[66:67], v[66:67]
    v_pk_mul_f32 v[74:75], v[74:75], v[66:67]
    v_pk_fma_f32 v[94:95], v[94:95], v[100:101], v[100:101] op_sel:[0,1,0] op_sel_hi:[1,1,0]
    v_pk_mul_f32 v[94:95], v[94:95], v[66:67]
    v_pk_mul_f32 v[96:97], v[68:69], v[68:69]
    v_pk_mul_f32 v[76:77], v[76:77], v[68:69]
    v_pk_fma_f32 v[96:97], v[96:97], v[100:101], v[100:101] op_sel:[0,1,0] op_sel_hi:[1,1,0]
    v_pk_mul_f32 v[96:97], v[96:97], v[68:69]
    v_pk_mul_f32 v[98:99], v[70:71], v[70:71]
    v_pk_mul_f32 v[78:79], v[78:79], v[70:71]
    v_pk_fma_f32 v[98:99], v[98:99], v[100:101], v[100:101] op_sel:[0,1,0] op_sel_hi:[1,1,0]
    v_pk_mul_f32 v[98:99], v[98:99], v[70:71]
    v_exp_f32 v92, v92
    v_exp_f32 v93, v93
    v_exp_f32 v94, v94
    v_exp_f32 v95, v95
    v_exp_f32 v96, v96
    v_exp_f32 v97, v97
    v_exp_f32 v98, v98
    v_exp_f32 v99, v99
    s_nop 0
    v_pk_add_f32 v[92:93], v[92:93], v[102:103] op_sel_hi:[1,0]
    v_pk_add_f32 v[94:95], v[94:95], v[102:103] op_sel_hi:[1,0]
    v_pk_add_f32 v[96:97], v[96:97], v[102:103] op_sel_hi:[1,0]
    v_pk_add_f32 v[98:99], v[98:99], v[102:103] op_sel_hi:[1,0]
    v_rcp_f32 v92, v92
    v_rcp_f32 v93, v93
    v_rcp_f32 v94, v94
    v_rcp_f32 v95, v95
    v_rcp_f32 v96, v96
    v_rcp_f32 v97, v97
    v_rcp_f32 v98, v98
    v_rcp_f32 v99, v99
    s_nop 0
    v_pk_mul_f32 v[64:65], v[72:73], v[92:93]
    v_pk_mul_f32 v[66:67], v[74:75], v[94:95]
    v_pk_mul_f32 v[68:69], v[76:77], v[96:97]
    v_pk_mul_f32 v[70:71], v[78:79], v[98:99]
    v_cvt_pk_bf16_f32 v72, v64, v65
    v_cvt_pk_bf16_f32 v73, v66, v67
    v_cvt_pk_bf16_f32 v74, v68, v69
    v_cvt_pk_bf16_f32 v75, v70, v71
    s_movk_i32 s61, 4096
    buffer_store_dwordx4 v[72:75], v89, s[24:27], s61 offen offset:2048
    s_nop 1
end_geglu_kernel_1:
    s_endpgm
.globl qkv0_kernel
.p2align 8
.type qkv0_kernel,@function
qkv0_kernel:
    s_cmp_ge_u32 s2, 240
    s_cbranch_scc1 end_qkv0_kernel_1
    s_load_dwordx16 s[64:79], s[0:1], 0
    s_load_dwordx4 s[80:83], s[0:1], 64
    s_and_b32 s3, s2, 15
    s_lshr_b32 s4, s2, 4
    v_and_b32 v1, 63, v0
    v_lshrrev_b32 v2, 6, v0
    s_nop 0
    v_readfirstlane_b32 s5, v2
    s_lshr_b32 s62, s5, 2
    s_and_b32 s5, s5, 3
    s_mul_i32 s56, s3, 128
    s_mul_i32 s57, s4, 128
    s_lshr_b32 s6, s5, 1
    s_and_b32 s7, s5, 1
    s_mov_b32 s58, 1280
    v_lshrrev_b32 v3, 4, v1
    v_xor_b32 v3, v3, v1
    v_and_b32 v3, 7, v3
    v_lshrrev_b32 v4, 3, v1
    v_add_u32 v4, s56, v4
    v_mul_lo_u32 v5, v4, s58
    v_lshl_add_u32 v5, v3, 4, v5
    v_lshrrev_b32 v3, 4, v1
    v_add_u32 v3, 4, v3
    v_xor_b32 v3, v3, v1
    v_and_b32 v3, 7, v3
    v_lshrrev_b32 v4, 3, v1
    v_add_u32 v4, s56, v4
    v_mul_lo_u32 v6, v4, s58
    v_lshl_add_u32 v6, v3, 4, v6
    v_lshrrev_b32 v3, 4, v1
    v_lshlrev_b32 v4, 2, v3
    v_xor_b32 v4, v4, v1
    v_and_b32 v4, 15, v4
    v_mul_u32_u24 v7, 3840, v3
    v_lshl_add_u32 v7, v4, 4, v7
    s_lshl_b32 s58, s57, 1
    v_add_u32 v7, s58, v7
    s_lshl_b32 s52, s5, 12
    s_mul_i32 s48, s5, 40960
    s_mul_i32 s49, s5, 61440
    s_mov_b32 s50, 2048
    s_mov_b32 s51, 2048
    s_waitcnt lgkmcnt(0)
    s_mov_b32 s8, s64
    s_and_b32 s9, s65, 0xffff
    s_mov_b32 s10, 0x280000
    s_mov_b32 s11, 0x20000
    s_mov_b32 s12, s66
    s_and_b32 s13, s67, 0xffff
    s_mov_b32 s14, 0x258000
    s_mov_b32 s15, 0x20000
    s_cmp_eq_u32 s62, 0
    s_cbranch_scc1 comp_qkv0_kernel_2
    s_add_u32 s53, s50, s52
    s_add_u32 m0, s53, 0
    s_add_u32 s54, s48, 0
    buffer_load_dwordx4 v5, s[8:11], s54 offen lds
    s_add_u32 m0, s53, 16384
    s_add_u32 s54, s49, 0
    buffer_load_dwordx4 v7, s[12:15], s54 offen lds
    s_add_u32 s53, s50, s52
    s_add_u32 m0, s53, 1024
    s_add_u32 s54, s48, 10240
    buffer_load_dwordx4 v6, s[8:11], s54 offen lds
    s_add_u32 m0, s53, 17408
    s_add_u32 s54, s49, 15360
    buffer_load_dwordx4 v7, s[12:15], s54 offen lds
    s_add_u32 s53, s50, s52
    s_add_u32 m0, s53, 2048
    s_add_u32 s54, s48, 20480
    buffer_load_dwordx4 v5, s[8:11], s54 offen lds
    s_add_u32 m0, s53, 18432
    s_add_u32 s54, s49, 30720
    buffer_load_dwordx4 v7, s[12:15], s54 offen lds
    s_add_u32 s53, s50, s52
    s_add_u32 m0, s53, 3072
    s_add_u32 s54, s48, 30720
    buffer_load_dwordx4 v6, s[8:11], s54 offen lds
    s_add_u32 m0, s53, 19456
    s_add_u32 s54, s49, 46080
    buffer_load_dwordx4 v7, s[12:15], s54 offen lds
    s_add_u32 s48, s48, 128
    s_add_u32 s49, s49, 245760
    s_add_u32 s50, s50, 32768
    s_cmp_eq_u32 s50, 133120
    s_cselect_b32 s50, 2048, s50
    s_add_u32 s53, s50, s52
    s_add_u32 m0, s53, 0
    s_add_u32 s54, s48, 0
    buffer_load_dwordx4 v5, s[8:11], s54 offen lds
    s_add_u32 m0, s53, 16384
    s_add_u32 s54, s49, 0
    buffer_load_dwordx4 v7, s[12:15], s54 offen lds
    s_add_u32 s53, s50, s52
    s_add_u32 m0, s53, 1024
    s_add_u32 s54, s48, 10240
    buffer_load_dwordx4 v6, s[8:11], s54 offen lds
    s_add_u32 m0, s53, 17408
    s_add_u32 s54, s49, 15360
    buffer_load_dwordx4 v7, s[12:15], s54 offen lds
    s_add_u32 s53, s50, s52
    s_add_u32 m0, s53, 2048
    s_add_u32 s54, s48, 20480
    buffer_load_dwordx4 v5, s[8:11], s54 offen lds
    s_add_u32 m0, s53, 18432
    s_add_u32 s54, s49, 30720
    buffer_load_dwordx4 v7, s[12:15], s54 offen lds
    s_add_u32 s53, s50, s52
    s_add_u32 m0, s53, 3072
    s_add_u32 s54, s48, 30720
    buffer_load_dwordx4 v6, s[8:11], s54 offen lds
    s_add_u32 m0, s53, 19456
    s_add_u32 s54, s49, 46080
    buffer_load_dwordx4 v7, s[12:15], s54 offen lds
    s_add_u32 s48, s48, 128
    s_add_u32 s49, s49, 245760
    s_add_u32 s50, s50, 32768
    s_cmp_eq_u32 s50, 133120
    s_cselect_b32 s50, 2048, s50
    s_add_u32 s53, s50, s52
    s_add_u32 m0, s53, 0
    s_add_u32 s54, s48, 0
    buffer_load_dwordx4 v5, s[8:11], s54 offen lds
    s_add_u32 m0, s53, 16384
    s_add_u32 s54, s49, 0
    buffer_load_dwordx4 v7, s[12:15], s54 offen lds
    s_add_u32 s53, s50, s52
    s_add_u32 m0, s53, 1024
    s_add_u32 s54, s48, 10240
    buffer_load_dwordx4 v6, s[8:11], s54 offen lds
    s_add_u32 m0, s53, 17408
    s_add_u32 s54, s49, 15360
    buffer_load_dwordx4 v7, s[12:15], s54 offen lds
    s_add_u32 s53, s50, s52
    s_add_u32 m0, s53, 2048
    s_add_u32 s54, s48, 20480
    buffer_load_dwordx4 v5, s[8:11], s54 offen lds
    s_add_u32 m0, s53, 18432
    s_add_u32 s54, s49, 30720
    buffer_load_dwordx4 v7, s[12:15], s54 offen lds
    s_add_u32 s53, s50, s52
    s_add_u32 m0, s53, 3072
    s_add_u32 s54, s48, 30720
    buffer_load_dwordx4 v6, s[8:11], s54 offen lds
    s_add_u32 m0, s53, 19456
    s_add_u32 s54, s49, 46080
    buffer_load_dwordx4 v7, s[12:15], s54 offen lds
    s_add_u32 s48, s48, 128
    s_add_u32 s49, s49, 245760
    s_add_u32 s50, s50, 32768
    s_cmp_eq_u32 s50, 133120
    s_cselect_b32 s50, 2048, s50
    s_waitcnt vmcnt(16)
    s_barrier
    s_mov_b32 s55, 7
ld_qkv0_kernel_3:
    s_waitcnt vmcnt(8)
    s_barrier
    s_add_u32 s53, s50, s52
    s_add_u32 m0, s53, 0
    s_add_u32 s54, s48, 0
    buffer_load_dwordx4 v5, s[8:11], s54 offen lds
    s_add_u32 m0, s53, 16384
    s_add_u32 s54, s49, 0
    buffer_load_dwordx4 v7, s[12:15], s54 offen lds
    s_add_u32 s53, s50, s52
    s_add_u32 m0, s53, 1024
    s_add_u32 s54, s48, 10240
    buffer_load_dwordx4 v6, s[8:11], s54 offen lds
    s_add_u32 m0, s53, 17408
    s_add_u32 s54, s49, 15360
    buffer_load_dwordx4 v7, s[12:15], s54 offen lds
    s_add_u32 s53, s50, s52
    s_add_u32 m0, s53, 2048
    s_add_u32 s54, s48, 20480
    buffer_load_dwordx4 v5, s[8:11], s54 offen lds
    s_add_u32 m0, s53, 18432
    s_add_u32 s54, s49, 30720
    buffer_load_dwordx4 v7, s[12:15], s54 offen lds
    s_add_u32 s53, s50, s52
    s_add_u32 m0, s53, 3072
    s_add_u32 s54, s48, 30720
    buffer_load_dwordx4 v6, s[8:11], s54 offen lds
    s_add_u32 m0, s53, 19456
    s_add_u32 s54, s49, 46080
    buffer_load_dwordx4 v7, s[12:15], s54 offen lds
    s_add_u32 s48, s48, 128
    s_add_u32 s49, s49, 245760
    s_add_u32 s50, s50, 32768
    s_cmp_eq_u32 s50, 133120
    s_cselect_b32 s50, 2048, s50
    s_sub_u32 s55, s55, 1
    s_cmp_lg_u32 s55, 0
    s_cbranch_scc1 ld_qkv0_kernel_3
    s_waitcnt vmcnt(8)
    s_barrier
    s_waitcnt vmcnt(0)
    s_barrier
    s_endpgm
comp_qkv0_kernel_2:
    s_mov_b32 s20, s82
    s_and_b32 s21, s83, 0xffff
    s_mov_b32 s22, 0x100000
    s_mov_b32 s23, 0x20000
    v_add_u32 v25, s56, v0
    v_lshlrev_b32 v25, 6, v25
    v_add_u32 v25, 0x8000, v25
    buffer_load_dwordx4 v[8:11], v25, s[20:23], 0 offen offset:0
    buffer_load_dwordx4 v[12:15], v25, s[20:23], 0 offen offset:16
    buffer_load_dwordx4 v[16:19], v25, s[20:23], 0 offen offset:32
    buffer_load_dwordx4 v[20:23], v25, s[20:23], 0 offen offset:48
    v_add_u32 v26, s57, v0
    v_lshlrev_b32 v26, 2, v26
    v_add_u32 v26, 0x40000, v26
    buffer_load_dword v24, v26, s[20:23], 0 offen
    s_mov_b32 s58, 21504
    buffer_load_dword v27, v26, s[20:23], s58 offen
    s_mov_b32 s58, 43008
    buffer_load_dword v28, v26, s[20:23], s58 offen
    s_mov_b32 s58, 64512
    buffer_load_dword v29, v26, s[20:23], s58 offen
    v_lshrrev_b32 v42, 5, v1
    v_and_b32 v43, 31, v1
    s_lshl_b32 s58, s6, 13
    v_bfe_u32 v3, v43, 1, 3
    v_add_u32 v4, 0, v42
    v_xor_b32 v3, v3, v4
    v_lshlrev_b32 v4, 7, v43
    v_lshl_add_u32 v30, v3, 4, v4
    v_add_u32 v30, s58, v30
    v_bfe_u32 v3, v43, 1, 3
    v_add_u32 v4, 2, v42
    v_xor_b32 v3, v3, v4
    v_lshlrev_b32 v4, 7, v43
    v_lshl_add_u32 v31, v3, 4, v4
    v_add_u32 v31, s58, v31
    v_bfe_u32 v3, v43, 1, 3
    v_add_u32 v4, 4, v42
    v_xor_b32 v3, v3, v4
    v_lshlrev_b32 v4, 7, v43
    v_lshl_add_u32 v32, v3, 4, v4
    v_add_u32 v32, s58, v32
    v_bfe_u32 v3, v43, 1, 3
    v_add_u32 v4, 6, v42
    v_xor_b32 v3, v3, v4
    v_lshlrev_b32 v4, 7, v43
    v_lshl_add_u32 v33, v3, 4, v4
    v_add_u32 v33, s58, v33
    v_bfe_u32 v44, v1, 2, 2
    s_lshl_b32 s58, s7, 1
    s_add_u32 s58, s58, 0
    v_xor_b32 v3, s58, v44
    v_lshlrev_b32 v3, 6, v3
    v_lshl_add_u32 v3, v44, 8, v3
    v_lshl_add_u32 v3, v42, 11, v3
    v_and_b32 v4, 1, v1
    v_lshl_add_u32 v3, v4, 5, v3
    v_bfe_u32 v4, v1, 4, 1
    v_lshl_add_u32 v3, v4, 4, v3
    v_bfe_u32 v4, v1, 1, 1
    v_lshl_add_u32 v3, v4, 3, v3
    v_add_u32 v34, 16384, v3
    s_lshl_b32 s58, s7, 1
    s_add_u32 s58, s58, 1
    v_xor_b32 v3, s58, v44
    v_lshlrev_b32 v3, 6, v3
    v_lshl_add_u32 v3, v44, 8, v3
    v_lshl_add_u32 v3, v42, 11, v3
    v_and_b32 v4, 1, v1
    v_lshl_add_u32 v3, v4, 5, v3
    v_bfe_u32 v4, v1, 4, 1
    v_lshl_add_u32 v3, v4, 4, v3
    v_bfe_u32 v4, v1, 1, 1
    v_lshl_add_u32 v3, v4, 3, v3
    v_add_u32 v35, 16384, v3
    s_add_u32 s24, s82, 0x100000
    s_addc_u32 s25, s83, 0
    s_and_b32 s25, s25, 0xffff
    s_mov_b32 s26, 0xc00000
    s_mov_b32 s27, 0x20000
    s_cmp_ge_u32 s4, 10
    s_cbranch_scc1 vpath_qkv0_kernel_4
    s_lshl_b32 s58, s4, 5
    s_lshl_b32 s60, s7, 4
    s_add_u32 s58, s58, s60
    s_cmp_lt_u32 s4, 5
    s_cselect_b32 s61, 0, 160
    s_cselect_b32 s60, 0, 0x400000
    s_sub_u32 s58, s58, s61
    s_mov_b32 s61, 52429
    v_lshl_add_u32 v217, v42, 2, s58
    v_add_u32 v217, 0, v217
    v_mul_lo_u32 v218, v217, s61
    v_lshrrev_b32 v218, 18, v218
    v_mul_u32_u24 v219, 5, v218
    v_sub_u32 v219, v217, v219
    v_lshlrev_b32 v168, 17, v218
    v_lshrrev_b32 v217, 2, v219
    v_lshl_add_u32 v168, v217, 10, v168
    v_bfe_u32 v217, v219, 1, 1
    v_lshl_add_u32 v168, v217, 9, v168
    v_and_b32 v217, 1, v219
    v_lshl_add_u32 v168, v217, 3, v168
    v_add_u32 v168, s60, v168
    v_lshl_add_u32 v217, v42, 2, s58
    v_add_u32 v217, 1, v217
    v_mul_lo_u32 v218, v217, s61
    v_lshrrev_b32 v218, 18, v218
    v_mul_u32_u24 v219, 5, v218
    v_sub_u32 v219, v217, v219
    v_lshlrev_b32 v169, 17, v218
    v_lshrrev_b32 v217, 2, v219
    v_lshl_add_u32 v169, v217, 10, v169
    v_bfe_u32 v217, v219, 1, 1
    v_lshl_add_u32 v169, v217, 9, v169
    v_and_b32 v217, 1, v219
    v_lshl_add_u32 v169, v217, 3, v169
    v_add_u32 v169, s60, v169
    v_lshl_add_u32 v217, v42, 2, s58
    v_add_u32 v217, 2, v217
    v_mul_lo_u32 v218, v217, s61
    v_lshrrev_b32 v218, 18, v218
    v_mul_u32_u24 v219, 5, v218
    v_sub_u32 v219, v217, v219
    v_lshlrev_b32 v170, 17, v218
    v_lshrrev_b32 v217, 2, v219
    v_lshl_add_u32 v170, v217, 10, v170
    v_bfe_u32 v217, v219, 1, 1
    v_lshl_add_u32 v170, v217, 9, v170
    v_and_b32 v217, 1, v219
    v_lshl_add_u32 v170, v217, 3, v170
    v_add_u32 v170, s60, v170
    v_lshl_add_u32 v217, v42, 2, s58
    v_add_u32 v217, 3, v217
    v_mul_lo_u32 v218, v217, s61
    v_lshrrev_b32 v218, 18, v218
    v_mul_u32_u24 v219, 5, v218
    v_sub_u32 v219, v217, v219
    v_lshlrev_b32 v171, 17, v218
    v_lshrrev_b32 v217, 2, v219
    v_lshl_add_u32 v171, v217, 10, v171
    v_bfe_u32 v217, v219, 1, 1
    v_lshl_add_u32 v171, v217, 9, v171
    v_and_b32 v217, 1, v219
    v_lshl_add_u32 v171, v217, 3, v171
    v_add_u32 v171, s60, v171
    v_lshl_add_u32 v217, v42, 2, s58
    v_add_u32 v217, 8, v217
    v_mul_lo_u32 v218, v217, s61
    v_lshrrev_b32 v218, 18, v218
    v_mul_u32_u24 v219, 5, v218
    v_sub_u32 v219, v217, v219
    v_lshlrev_b32 v172, 17, v218
    v_lshrrev_b32 v217, 2, v219
    v_lshl_add_u32 v172, v217, 10, v172
    v_bfe_u32 v217, v219, 1, 1
    v_lshl_add_u32 v172, v217, 9, v172
    v_and_b32 v217, 1, v219
    v_lshl_add_u32 v172, v217, 3, v172
    v_add_u32 v172, s60, v172
    v_lshl_add_u32 v217, v42, 2, s58
    v_add_u32 v217, 9, v217
    v_mul_lo_u32 v218, v217, s61
    v_lshrrev_b32 v218, 18, v218
    v_mul_u32_u24 v219, 5, v218
    v_sub_u32 v219, v217, v219
    v_lshlrev_b32 v173, 17, v218
    v_lshrrev_b32 v217, 2, v219
    v_lshl_add_u32 v173, v217, 10, v173
    v_bfe_u32 v217, v219, 1, 1
    v_lshl_add_u32 v173, v217, 9, v173
    v_and_b32 v217, 1, v219
    v_lshl_add_u32 v173, v217, 3, v173
    v_add_u32 v173, s60, v173
    v_lshl_add_u32 v217, v42, 2, s58
    v_add_u32 v217, 10, v217
    v_mul_lo_u32 v218, v217, s61
    v_lshrrev_b32 v218, 18, v218
    v_mul_u32_u24 v219, 5, v218
    v_sub_u32 v219, v217, v219
    v_lshlrev_b32 v174, 17, v218
    v_lshrrev_b32 v217, 2, v219
    v_lshl_add_u32 v174, v217, 10, v174
    v_bfe_u32 v217, v219, 1, 1
    v_lshl_add_u32 v174, v217, 9, v174
    v_and_b32 v217, 1, v219
    v_lshl_add_u32 v174, v217, 3, v174
    v_add_u32 v174, s60, v174
    v_lshl_add_u32 v217, v42, 2, s58
    v_add_u32 v217, 11, v217
    v_mul_lo_u32 v218, v217, s61
    v_lshrrev_b32 v218, 18, v218
    v_mul_u32_u24 v219, 5, v218
    v_sub_u32 v219, v217, v219
    v_lshlrev_b32 v175, 17, v218
    v_lshrrev_b32 v217, 2, v219
    v_lshl_add_u32 v175, v217, 10, v175
    v_bfe_u32 v217, v219, 1, 1
    v_lshl_add_u32 v175, v217, 9, v175
    v_and_b32 v217, 1, v219
    v_lshl_add_u32 v175, v217, 3, v175
    v_add_u32 v175, s60, v175
    s_lshl_b32 s58, s3, 2
    s_lshl_b32 s60, s6, 1
    s_add_u32 s58, s58, s60
    s_lshl_b32 s58, s58, 11
    v_lshlrev_b32 v164, 4, v43
    v_add_u32 v164, s58, v164
    v_add_u32 v168, v168, v164
    v_add_u32 v169, v169, v164
    v_add_u32 v170, v170, v164
    v_add_u32 v171, v171, v164
    v_add_u32 v172, v172, v164
    v_add_u32 v173, v173, v164
    v_add_u32 v174, v174, v164
    v_add_u32 v175, v175, v164
    s_waitcnt lgkmcnt(0)
    s_barrier
    v_add_u32 v36, s51, v30
    v_add_u32 v37, s51, v31
    v_add_u32 v38, s51, v32
    v_add_u32 v39, s51, v33
    v_add_u32 v40, s51, v34
    v_add_u32 v41, s51, v35
    s_add_u32 s51, s51, 32768
    s_cmp_eq_u32 s51, 133120
    s_cselect_b32 s51, 2048, s51
    ds_read_b128 v[48:51], v36 offset:0
    ds_read_b128 v[52:55], v36 offset:4096
    ds_read_b64_tr_b16 v[72:73], v40 offset:0
    ds_read_b64_tr_b16 v[74:75], v40 offset:1024
    ds_read_b64_tr_b16 v[76:77], v41 offset:0
    ds_read_b64_tr_b16 v[78:79], v41 offset:1024
    ds_read_b128 v[56:59], v37 offset:0
    ds_read_b128 v[60:63], v37 offset:4096
    ds_read_b64_tr_b16 v[80:81], v40 offset:4096
    ds_read_b64_tr_b16 v[82:83], v40 offset:5120
    ds_read_b64_tr_b16 v[84:85], v41 offset:4096
    ds_read_b64_tr_b16 v[86:87], v41 offset:5120
    s_waitcnt lgkmcnt(6)
    ds_read_b128 v[64:67], v38 offset:0
    ds_read_b128 v[68:71], v38 offset:4096
    v_mfma_f32_32x32x16_bf16 v[96:111], v[72:75], v[48:51], 0
    ds_read_b64_tr_b16 v[88:89], v40 offset:8192
    v_mfma_f32_32x32x16_bf16 v[112:127], v[72:75], v[52:55], 0
    ds_read_b64_tr_b16 v[90:91], v40 offset:9216
    v_mfma_f32_32x32x16_bf16 v[128:143], v[76:79], v[48:51], 0
    ds_read_b64_tr_b16 v[92:93], v41 offset:8192
    v_mfma_f32_32x32x16_bf16 v[144:159], v[76:79], v[52:55], 0
    ds_read_b64_tr_b16 v[94:95], v41 offset:9216
    s_waitcnt lgkmcnt(6)
    ds_read_b128 v[48:51], v39 offset:0
    ds_read_b128 v[52:55], v39 offset:4096
    v_mfma_f32_32x32x16_bf16 v[96:111], v[80:83], v[56:59], v[96:111]
    ds_read_b64_tr_b16 v[72:73], v40 offset:12288
    v_mfma_f32_32x32x16_bf16 v[112:127], v[80:83], v[60:63], v[112:127]
    ds_read_b64_tr_b16 v[74:75], v40 offset:13312
    v_mfma_f32_32x32x16_bf16 v[128:143], v[84:87], v[56:59], v[128:143]
    ds_read_b64_tr_b16 v[76:77], v41 offset:12288
    v_mfma_f32_32x32x16_bf16 v[144:159], v[84:87], v[60:63], v[144:159]
    ds_read_b64_tr_b16 v[78:79], v41 offset:13312
    s_waitcnt lgkmcnt(6)
    s_barrier
    v_add_u32 v36, s51, v30
    v_add_u32 v37, s51, v31
    v_add_u32 v38, s51, v32
    v_add_u32 v39, s51, v33
    v_add_u32 v40, s51, v34
    v_add_u32 v41, s51, v35
    s_add_u32 s51, s51, 32768
    s_cmp_eq_u32 s51, 133120
    s_cselect_b32 s51, 2048, s51
    ds_read_b128 v[56:59], v36 offset:0
    ds_read_b128 v[60:63], v36 offset:4096
    v_mfma_f32_32x32x16_bf16 v[96:111], v[88:91], v[64:67], v[96:111]
    ds_read_b64_tr_b16 v[80:81], v40 offset:0
    v_mfma_f32_32x32x16_bf16 v[112:127], v[88:91], v[68:71], v[112:127]
    ds_read_b64_tr_b16 v[82:83], v40 offset:1024
    v_mfma_f32_32x32x16_bf16 v[128:143], v[92:95], v[64:67], v[128:143]
    ds_read_b64_tr_b16 v[84:85], v41 offset:0
    v_mfma_f32_32x32x16_bf16 v[144:159], v[92:95], v[68:71], v[144:159]
    ds_read_b64_tr_b16 v[86:87], v41 offset:1024
    s_waitcnt lgkmcnt(6)
    ds_read_b128 v[64:67], v37 offset:0
    ds_read_b128 v[68:71], v37 offset:4096
    v_mfma_f32_32x32x16_bf16 v[96:111], v[72:75], v[48:51], v[96:111]
    ds_read_b64_tr_b16 v[88:89], v40 offset:4096
    v_mfma_f32_32x32x16_bf16 v[112:127], v[72:75], v[52:55], v[112:127]
    ds_read_b64_tr_b16 v[90:91], v40 offset:5120
    v_mfma_f32_32x32x16_bf16 v[128:143], v[76:79], v[48:51], v[128:143]
    ds_read_b64_tr_b16 v[92:93], v41 offset:4096
    v_mfma_f32_32x32x16_bf16 v[144:159], v[76:79], v[52:55], v[144:159]
    ds_read_b64_tr_b16 v[94:95], v41 offset:5120
    s_waitcnt lgkmcnt(6)
    s_waitcnt vmcnt(0)
    v_add_f32 v24, v24, v27
    v_add_f32 v24, v24, v28
    v_add_f32 v24, v24, v29
    v_add_f32 v8, v8, v10
    v_add_f32 v9, v9, v11
    v_add_f32 v8, v8, v12
    v_add_f32 v9, v9, v13
    v_add_f32 v8, v8, v14
    v_add_f32 v9, v9, v15
    v_add_f32 v8, v8, v16
    v_add_f32 v9, v9, v17
    v_add_f32 v8, v8, v18
    v_add_f32 v9, v9, v19
    v_add_f32 v8, v8, v20
    v_add_f32 v9, v9, v21
    v_add_f32 v8, v8, v22
    v_add_f32 v9, v9, v23
    v_mul_f32 v8, 0x3acccccd, v8
    v_mul_f32 v9, 0x3acccccd, v9
    v_fma_f32 v9, -v8, v8, v9
    v_max_f32 v9, 0, v9
    v_add_f32 v9, 0x3727c5ac, v9
    v_rsq_f32 v9, v9
    s_nop 0
    v_mul_f32 v8, v8, v9
    v_sub_f32 v8, 0, v8
    v_lshlrev_b32 v3, 3, v0
    v_cmp_gt_u32 vcc, 128, v0
    s_and_saveexec_b64 s[60:61], vcc
    s_cbranch_execz aux_qkv0_kernel_6
    ds_write_b64 v3, v[8:9] offset:0
aux_qkv0_kernel_6:
    s_mov_b64 exec, s[60:61]
    v_lshlrev_b32 v3, 2, v0
    v_cmp_gt_u32 vcc, 128, v0
    s_and_saveexec_b64 s[60:61], vcc
    s_cbranch_execz aux_qkv0_kernel_7
    ds_write_b32 v3, v24 offset:1024
aux_qkv0_kernel_7:
    s_mov_b64 exec, s[60:61]
    s_mov_b32 s55, 2
loop_qkv0_kernel_8:
    ds_read_b128 v[48:51], v38 offset:0
    ds_read_b128 v[52:55], v38 offset:4096
    v_mfma_f32_32x32x16_bf16 v[96:111], v[80:83], v[56:59], v[96:111]
    ds_read_b64_tr_b16 v[72:73], v40 offset:8192
    v_mfma_f32_32x32x16_bf16 v[112:127], v[80:83], v[60:63], v[112:127]
    ds_read_b64_tr_b16 v[74:75], v40 offset:9216
    v_mfma_f32_32x32x16_bf16 v[128:143], v[84:87], v[56:59], v[128:143]
    ds_read_b64_tr_b16 v[76:77], v41 offset:8192
    v_mfma_f32_32x32x16_bf16 v[144:159], v[84:87], v[60:63], v[144:159]
    ds_read_b64_tr_b16 v[78:79], v41 offset:9216
    s_waitcnt lgkmcnt(6)
    ds_read_b128 v[56:59], v39 offset:0
    ds_read_b128 v[60:63], v39 offset:4096
    v_mfma_f32_32x32x16_bf16 v[96:111], v[88:91], v[64:67], v[96:111]
    ds_read_b64_tr_b16 v[80:81], v40 offset:12288
    v_mfma_f32_32x32x16_bf16 v[112:127], v[88:91], v[68:71], v[112:127]
    ds_read_b64_tr_b16 v[82:83], v40 offset:13312
    v_mfma_f32_32x32x16_bf16 v[128:143], v[92:95], v[64:67], v[128:143]
    ds_read_b64_tr_b16 v[84:85], v41 offset:12288
    v_mfma_f32_32x32x16_bf16 v[144:159], v[92:95], v[68:71], v[144:159]
    ds_read_b64_tr_b16 v[86:87], v41 offset:13312
    s_waitcnt lgkmcnt(6)
    s_barrier
    v_add_u32 v36, s51, v30
    v_add_u32 v37, s51, v31
    v_add_u32 v38, s51, v32
    v_add_u32 v39, s51, v33
    v_add_u32 v40, s51, v34
    v_add_u32 v41, s51, v35
    s_add_u32 s51, s51, 32768
    s_cmp_eq_u32 s51, 133120
    s_cselect_b32 s51, 2048, s51
    ds_read_b128 v[64:67], v36 offset:0
    ds_read_b128 v[68:71], v36 offset:4096
    v_mfma_f32_32x32x16_bf16 v[96:111], v[72:75], v[48:51], v[96:111]
    ds_read_b64_tr_b16 v[88:89], v40 offset:0
    v_mfma_f32_32x32x16_bf16 v[112:127], v[72:75], v[52:55], v[112:127]
    ds_read_b64_tr_b16 v[90:91], v40 offset:1024
    v_mfma_f32_32x32x16_bf16 v[128:143], v[76:79], v[48:51], v[128:143]
    ds_read_b64_tr_b16 v[92:93], v41 offset:0
    v_mfma_f32_32x32x16_bf16 v[144:159], v[76:79], v[52:55], v[144:159]
    ds_read_b64_tr_b16 v[94:95], v41 offset:1024
    s_waitcnt lgkmcnt(6)
    ds_read_b128 v[48:51], v37 offset:0
    ds_read_b128 v[52:55], v37 offset:4096
    v_mfma_f32_32x32x16_bf16 v[96:111], v[80:83], v[56:59], v[96:111]
    ds_read_b64_tr_b16 v[72:73], v40 offset:4096
    v_mfma_f32_32x32x16_bf16 v[112:127], v[80:83], v[60:63], v[112:127]
    ds_read_b64_tr_b16 v[74:75], v40 offset:5120
    v_mfma_f32_32x32x16_bf16 v[128:143], v[84:87], v[56:59], v[128:143]
    ds_read_b64_tr_b16 v[76:77], v41 offset:4096
    v_mfma_f32_32x32x16_bf16 v[144:159], v[84:87], v[60:63], v[144:159]
    ds_read_b64_tr_b16 v[78:79], v41 offset:5120
    s_waitcnt lgkmcnt(6)
    ds_read_b128 v[56:59], v38 offset:0
    ds_read_b128 v[60:63], v38 offset:4096
    v_mfma_f32_32x32x16_bf16 v[96:111], v[88:91], v[64:67], v[96:111]
    ds_read_b64_tr_b16 v[80:81], v40 offset:8192
    v_mfma_f32_32x32x16_bf16 v[112:127], v[88:91], v[68:71], v[112:127]
    ds_read_b64_tr_b16 v[82:83], v40 offset:9216
    v_mfma_f32_32x32x16_bf16 v[128:143], v[92:95], v[64:67], v[128:143]
    ds_read_b64_tr_b16 v[84:85], v41 offset:8192
    v_mfma_f32_32x32x16_bf16 v[144:159], v[92:95], v[68:71], v[144:159]
    ds_read_b64_tr_b16 v[86:87], v41 offset:9216
    s_waitcnt lgkmcnt(6)
    ds_read_b128 v[64:67], v39 offset:0
    ds_read_b128 v[68:71], v39 offset:4096
    v_mfma_f32_32x32x16_bf16 v[96:111], v[72:75], v[48:51], v[96:111]
    ds_read_b64_tr_b16 v[88:89], v40 offset:12288
    v_mfma_f32_32x32x16_bf16 v[112:127], v[72:75], v[52:55], v[112:127]
    ds_read_b64_tr_b16 v[90:91], v40 offset:13312
    v_mfma_f32_32x32x16_bf16 v[128:143], v[76:79], v[48:51], v[128:143]
    ds_read_b64_tr_b16 v[92:93], v41 offset:12288
    v_mfma_f32_32x32x16_bf16 v[144:159], v[76:79], v[52:55], v[144:159]
    ds_read_b64_tr_b16 v[94:95], v41 offset:13312
    s_waitcnt lgkmcnt(6)
    s_barrier
    v_add_u32 v36, s51, v30
    v_add_u32 v37, s51, v31
    v_add_u32 v38, s51, v32
    v_add_u32 v39, s51, v33
    v_add_u32 v40, s51, v34
    v_add_u32 v41, s51, v35
    s_add_u32 s51, s51, 32768
    s_cmp_eq_u32 s51, 133120
    s_cselect_b32 s51, 2048, s51
    ds_read_b128 v[48:51], v36 offset:0
    ds_read_b128 v[52:55], v36 offset:4096
    v_mfma_f32_32x32x16_bf16 v[96:111], v[80:83], v[56:59], v[96:111]
    ds_read_b64_tr_b16 v[72:73], v40 offset:0
    v_mfma_f32_32x32x16_bf16 v[112:127], v[80:83], v[60:63], v[112:127]
    ds_read_b64_tr_b16 v[74:75], v40 offset:1024
    v_mfma_f32_32x32x16_bf16 v[128:143], v[84:87], v[56:59], v[128:143]
    ds_read_b64_tr_b16 v[76:77], v41 offset:0
    v_mfma_f32_32x32x16_bf16 v[144:159], v[84:87], v[60:63], v[144:159]
    ds_read_b64_tr_b16 v[78:79], v41 offset:1024
    s_waitcnt lgkmcnt(6)
    ds_read_b128 v[56:59], v37 offset:0
    ds_read_b128 v[60:63], v37 offset:4096
    v_mfma_f32_32x32x16_bf16 v[96:111], v[88:91], v[64:67], v[96:111]
    ds_read_b64_tr_b16 v[80:81], v40 offset:4096
    v_mfma_f32_32x32x16_bf16 v[112:127], v[88:91], v[68:71], v[112:127]
    ds_read_b64_tr_b16 v[82:83], v40 offset:5120
    v_mfma_f32_32x32x16_bf16 v[128:143], v[92:95], v[64:67], v[128:143]
    ds_read_b64_tr_b16 v[84:85], v41 offset:4096
    v_mfma_f32_32x32x16_bf16 v[144:159], v[92:95], v[68:71], v[144:159]
    ds_read_b64_tr_b16 v[86:87], v41 offset:5120
    s_waitcnt lgkmcnt(6)
    ds_read_b128 v[64:67], v38 offset:0
    ds_read_b128 v[68:71], v38 offset:4096
    v_mfma_f32_32x32x16_bf16 v[96:111], v[72:75], v[48:51], v[96:111]
    ds_read_b64_tr_b16 v[88:89], v40 offset:8192
    v_mfma_f32_32x32x16_bf16 v[112:127], v[72:75], v[52:55], v[112:127]
    ds_read_b64_tr_b16 v[90:91], v40 offset:9216
    v_mfma_f32_32x32x16_bf16 v[128:143], v[76:79], v[48:51], v[128:143]
    ds_read_b64_tr_b16 v[92:93], v41 offset:8192
    v_mfma_f32_32x32x16_bf16 v[144:159], v[76:79], v[52:55], v[144:159]
    ds_read_b64_tr_b16 v[94:95], v41 offset:9216
    s_waitcnt lgkmcnt(6)
    ds_read_b128 v[48:51], v39 offset:0
    ds_read_b128 v[52:55], v39 offset:4096
    v_mfma_f32_32x32x16_bf16 v[96:111], v[80:83], v[56:59], v[96:111]
    ds_read_b64_tr_b16 v[72:73], v40 offset:12288
    v_mfma_f32_32x32x16_bf16 v[112:127], v[80:83], v[60:63], v[112:127]
    ds_read_b64_tr_b16 v[74:75], v40 offset:13312
    v_mfma_f32_32x32x16_bf16 v[128:143], v[84:87], v[56:59], v[128:143]
    ds_read_b64_tr_b16 v[76:77], v41 offset:12288
    v_mfma_f32_32x32x16_bf16 v[144:159], v[84:87], v[60:63], v[144:159]
    ds_read_b64_tr_b16 v[78:79], v41 offset:13312
    s_waitcnt lgkmcnt(6)
    s_barrier
    v_add_u32 v36, s51, v30
    v_add_u32 v37, s51, v31
    v_add_u32 v38, s51, v32
    v_add_u32 v39, s51, v33
    v_add_u32 v40, s51, v34
    v_add_u32 v41, s51, v35
    s_add_u32 s51, s51, 32768
    s_cmp_eq_u32 s51, 133120
    s_cselect_b32 s51, 2048, s51
    ds_read_b128 v[56:59], v36 offset:0
    ds_read_b128 v[60:63], v36 offset:4096
    v_mfma_f32_32x32x16_bf16 v[96:111], v[88:91], v[64:67], v[96:111]
    ds_read_b64_tr_b16 v[80:81], v40 offset:0
    v_mfma_f32_32x32x16_bf16 v[112:127], v[88:91], v[68:71], v[112:127]
    ds_read_b64_tr_b16 v[82:83], v40 offset:1024
    v_mfma_f32_32x32x16_bf16 v[128:143], v[92:95], v[64:67], v[128:143]
    ds_read_b64_tr_b16 v[84:85], v41 offset:0
    v_mfma_f32_32x32x16_bf16 v[144:159], v[92:95], v[68:71], v[144:159]
    ds_read_b64_tr_b16 v[86:87], v41 offset:1024
    s_waitcnt lgkmcnt(6)
    ds_read_b128 v[64:67], v37 offset:0
    ds_read_b128 v[68:71], v37 offset:4096
    v_mfma_f32_32x32x16_bf16 v[96:111], v[72:75], v[48:51], v[96:111]
    ds_read_b64_tr_b16 v[88:89], v40 offset:4096
    v_mfma_f32_32x32x16_bf16 v[112:127], v[72:75], v[52:55], v[112:127]
    ds_read_b64_tr_b16 v[90:91], v40 offset:5120
    v_mfma_f32_32x32x16_bf16 v[128:143], v[76:79], v[48:51], v[128:143]
    ds_read_b64_tr_b16 v[92:93], v41 offset:4096
    v_mfma_f32_32x32x16_bf16 v[144:159], v[76:79], v[52:55], v[144:159]
    ds_read_b64_tr_b16 v[94:95], v41 offset:5120
    s_waitcnt lgkmcnt(6)
    s_sub_u32 s55, s55, 1
    s_cmp_lg_u32 s55, 0
    s_cbranch_scc1 loop_qkv0_kernel_8
    ds_read_b128 v[48:51], v38 offset:0
    ds_read_b128 v[52:55], v38 offset:4096
    v_mfma_f32_32x32x16_bf16 v[96:111], v[80:83], v[56:59], v[96:111]
    ds_read_b64_tr_b16 v[72:73], v40 offset:8192
    v_mfma_f32_32x32x16_bf16 v[112:127], v[80:83], v[60:63], v[112:127]
    ds_read_b64_tr_b16 v[74:75], v40 offset:9216
    v_mfma_f32_32x32x16_bf16 v[128:143], v[84:87], v[56:59], v[128:143]
    ds_read_b64_tr_b16 v[76:77], v41 offset:8192
    v_mfma_f32_32x32x16_bf16 v[144:159], v[84:87], v[60:63], v[144:159]
    ds_read_b64_tr_b16 v[78:79], v41 offset:9216
    s_waitcnt lgkmcnt(6)
    ds_read_b128 v[56:59], v39 offset:0
    ds_read_b128 v[60:63], v39 offset:4096
    v_mfma_f32_32x32x16_bf16 v[96:111], v[88:91], v[64:67], v[96:111]
    ds_read_b64_tr_b16 v[80:81], v40 offset:12288
    v_mfma_f32_32x32x16_bf16 v[112:127], v[88:91], v[68:71], v[112:127]
    ds_read_b64_tr_b16 v[82:83], v40 offset:13312
    v_mfma_f32_32x32x16_bf16 v[128:143], v[92:95], v[64:67], v[128:143]
    ds_read_b64_tr_b16 v[84:85], v41 offset:12288
    v_mfma_f32_32x32x16_bf16 v[144:159], v[92:95], v[68:71], v[144:159]
    ds_read_b64_tr_b16 v[86:87], v41 offset:13312
    s_waitcnt lgkmcnt(6)
    s_barrier
    v_add_u32 v36, s51, v30
    v_add_u32 v37, s51, v31
    v_add_u32 v38, s51, v32
    v_add_u32 v39, s51, v33
    v_add_u32 v40, s51, v34
    v_add_u32 v41, s51, v35
    s_add_u32 s51, s51, 32768
    s_cmp_eq_u32 s51, 133120
    s_cselect_b32 s51, 2048, s51
    ds_read_b128 v[64:67], v36 offset:0
    ds_read_b128 v[68:71], v36 offset:4096
    v_mfma_f32_32x32x16_bf16 v[96:111], v[72:75], v[48:51], v[96:111]
    ds_read_b64_tr_b16 v[88:89], v40 offset:0
    v_mfma_f32_32x32x16_bf16 v[112:127], v[72:75], v[52:55], v[112:127]
    ds_read_b64_tr_b16 v[90:91], v40 offset:1024
    v_mfma_f32_32x32x16_bf16 v[128:143], v[76:79], v[48:51], v[128:143]
    ds_read_b64_tr_b16 v[92:93], v41 offset:0
    v_mfma_f32_32x32x16_bf16 v[144:159], v[76:79], v[52:55], v[144:159]
    ds_read_b64_tr_b16 v[94:95], v41 offset:1024
    s_waitcnt lgkmcnt(6)
    ds_read_b128 v[48:51], v37 offset:0
    ds_read_b128 v[52:55], v37 offset:4096
    v_mfma_f32_32x32x16_bf16 v[96:111], v[80:83], v[56:59], v[96:111]
    ds_read_b64_tr_b16 v[72:73], v40 offset:4096
    v_mfma_f32_32x32x16_bf16 v[112:127], v[80:83], v[60:63], v[112:127]
    ds_read_b64_tr_b16 v[74:75], v40 offset:5120
    v_mfma_f32_32x32x16_bf16 v[128:143], v[84:87], v[56:59], v[128:143]
    ds_read_b64_tr_b16 v[76:77], v41 offset:4096
    v_mfma_f32_32x32x16_bf16 v[144:159], v[84:87], v[60:63], v[144:159]
    ds_read_b64_tr_b16 v[78:79], v41 offset:5120
    s_waitcnt lgkmcnt(6)
    ds_read_b128 v[56:59], v38 offset:0
    ds_read_b128 v[60:63], v38 offset:4096
    v_mfma_f32_32x32x16_bf16 v[96:111], v[88:91], v[64:67], v[96:111]
    ds_read_b64_tr_b16 v[80:81], v40 offset:8192
    v_mfma_f32_32x32x16_bf16 v[112:127], v[88:91], v[68:71], v[112:127]
    ds_read_b64_tr_b16 v[82:83], v40 offset:9216
    v_mfma_f32_32x32x16_bf16 v[128:143], v[92:95], v[64:67], v[128:143]
    ds_read_b64_tr_b16 v[84:85], v41 offset:8192
    v_mfma_f32_32x32x16_bf16 v[144:159], v[92:95], v[68:71], v[144:159]
    ds_read_b64_tr_b16 v[86:87], v41 offset:9216
    s_waitcnt lgkmcnt(6)
    ds_read_b128 v[64:67], v39 offset:0
    ds_read_b128 v[68:71], v39 offset:4096
    v_mfma_f32_32x32x16_bf16 v[96:111], v[72:75], v[48:51], v[96:111]
    ds_read_b64_tr_b16 v[88:89], v40 offset:12288
    v_mfma_f32_32x32x16_bf16 v[112:127], v[72:75], v[52:55], v[112:127]
    ds_read_b64_tr_b16 v[90:91], v40 offset:13312
    v_mfma_f32_32x32x16_bf16 v[128:143], v[76:79], v[48:51], v[128:143]
    ds_read_b64_tr_b16 v[92:93], v41 offset:12288
    v_mfma_f32_32x32x16_bf16 v[144:159], v[76:79], v[52:55], v[144:159]
    ds_read_b64_tr_b16 v[94:95], v41 offset:13312
    s_waitcnt lgkmcnt(6)
    s_barrier
    v_add_u32 v36, s51, v30
    v_add_u32 v37, s51, v31
    v_add_u32 v38, s51, v32
    v_add_u32 v39, s51, v33
    v_add_u32 v40, s51, v34
    v_add_u32 v41, s51, v35
    s_add_u32 s51, s51, 32768
    s_cmp_eq_u32 s51, 133120
    s_cselect_b32 s51, 2048, s51
    ds_read_b128 v[48:51], v36 offset:0
    ds_read_b128 v[52:55], v36 offset:4096
    v_mfma_f32_32x32x16_bf16 v[96:111], v[80:83], v[56:59], v[96:111]
    ds_read_b64_tr_b16 v[72:73], v40 offset:0
    v_mfma_f32_32x32x16_bf16 v[112:127], v[80:83], v[60:63], v[112:127]
    ds_read_b64_tr_b16 v[74:75], v40 offset:1024
    v_mfma_f32_32x32x16_bf16 v[128:143], v[84:87], v[56:59], v[128:143]
    ds_read_b64_tr_b16 v[76:77], v41 offset:0
    v_mfma_f32_32x32x16_bf16 v[144:159], v[84:87], v[60:63], v[144:159]
    ds_read_b64_tr_b16 v[78:79], v41 offset:1024
    s_waitcnt lgkmcnt(6)
    ds_read_b128 v[56:59], v37 offset:0
    ds_read_b128 v[60:63], v37 offset:4096
    v_mfma_f32_32x32x16_bf16 v[96:111], v[88:91], v[64:67], v[96:111]
    ds_read_b64_tr_b16 v[80:81], v40 offset:4096
    v_mfma_f32_32x32x16_bf16 v[112:127], v[88:91], v[68:71], v[112:127]
    ds_read_b64_tr_b16 v[82:83], v40 offset:5120
    v_mfma_f32_32x32x16_bf16 v[128:143], v[92:95], v[64:67], v[128:143]
    ds_read_b64_tr_b16 v[84:85], v41 offset:4096
    v_mfma_f32_32x32x16_bf16 v[144:159], v[92:95], v[68:71], v[144:159]
    ds_read_b64_tr_b16 v[86:87], v41 offset:5120
    s_waitcnt lgkmcnt(6)
    ds_read_b128 v[64:67], v38 offset:0
    ds_read_b128 v[68:71], v38 offset:4096
    v_mfma_f32_32x32x16_bf16 v[96:111], v[72:75], v[48:51], v[96:111]
    ds_read_b64_tr_b16 v[88:89], v40 offset:8192
    v_mfma_f32_32x32x16_bf16 v[112:127], v[72:75], v[52:55], v[112:127]
    ds_read_b64_tr_b16 v[90:91], v40 offset:9216
    v_mfma_f32_32x32x16_bf16 v[128:143], v[76:79], v[48:51], v[128:143]
    ds_read_b64_tr_b16 v[92:93], v41 offset:8192
    v_mfma_f32_32x32x16_bf16 v[144:159], v[76:79], v[52:55], v[144:159]
    ds_read_b64_tr_b16 v[94:95], v41 offset:9216
    s_waitcnt lgkmcnt(6)
    ds_read_b128 v[48:51], v39 offset:0
    ds_read_b128 v[52:55], v39 offset:4096
    v_mfma_f32_32x32x16_bf16 v[96:111], v[80:83], v[56:59], v[96:111]
    ds_read_b64_tr_b16 v[72:73], v40 offset:12288
    v_mfma_f32_32x32x16_bf16 v[112:127], v[80:83], v[60:63], v[112:127]
    ds_read_b64_tr_b16 v[74:75], v40 offset:13312
    v_mfma_f32_32x32x16_bf16 v[128:143], v[84:87], v[56:59], v[128:143]
    ds_read_b64_tr_b16 v[76:77], v41 offset:12288
    v_mfma_f32_32x32x16_bf16 v[144:159], v[84:87], v[60:63], v[144:159]
    ds_read_b64_tr_b16 v[78:79], v41 offset:13312
    s_waitcnt lgkmcnt(6)
    v_mfma_f32_32x32x16_bf16 v[96:111], v[88:91], v[64:67], v[96:111]
    v_mfma_f32_32x32x16_bf16 v[112:127], v[88:91], v[68:71], v[112:127]
    v_mfma_f32_32x32x16_bf16 v[128:143], v[92:95], v[64:67], v[128:143]
    v_mfma_f32_32x32x16_bf16 v[144:159], v[92:95], v[68:71], v[144:159]
    s_waitcnt lgkmcnt(0)
    v_mfma_f32_32x32x16_bf16 v[96:111], v[72:75], v[48:51], v[96:111]
    v_mfma_f32_32x32x16_bf16 v[112:127], v[72:75], v[52:55], v[112:127]
    v_mfma_f32_32x32x16_bf16 v[128:143], v[76:79], v[48:51], v[128:143]
    v_mfma_f32_32x32x16_bf16 v[144:159], v[76:79], v[52:55], v[144:159]
    s_nop 7
    s_nop 7
    s_cmp_lt_u32 s4, 5
    s_cselect_b32 s59, 0x3ea52b5c, 1.0
    s_lshl_b32 s58, s6, 9
    v_lshlrev_b32 v216, 3, v43
    v_add_u32 v216, s58, v216
    ds_read_b64 v[160:161], v216 offset:0
    ds_read_b64 v[162:163], v216 offset:256
    s_lshl_b32 s58, s7, 8
    v_lshlrev_b32 v217, 6, v42
    v_add_u32 v217, s58, v217
    ds_read_b128 v[176:179], v217 offset:1024
    ds_read_b128 v[180:183], v217 offset:1040
    ds_read_b128 v[184:187], v217 offset:1056
    ds_read_b128 v[188:191], v217 offset:1072
    ds_read_b128 v[192:195], v217 offset:1152
    ds_read_b128 v[196:199], v217 offset:1168
    ds_read_b128 v[200:203], v217 offset:1184
    ds_read_b128 v[204:207], v217 offset:1200
    s_waitcnt lgkmcnt(0)
    v_mul_f32 v160, s59, v160
    v_mul_f32 v161, s59, v161
    v_mul_f32 v162, s59, v162
    v_mul_f32 v163, s59, v163
    v_mov_b32 v219, 0
    v_pk_mul_f32 v[208:209], v[96:97], v[160:161] op_sel:[0,1] op_sel_hi:[1,1]
    v_pk_mul_f32 v[210:211], v[98:99], v[160:161] op_sel:[0,1] op_sel_hi:[1,1]
    v_pk_fma_f32 v[208:209], v[176:177], v[160:161], v[208:209] op_sel_hi:[1,0,1]
    v_pk_fma_f32 v[210:211], v[178:179], v[160:161], v[210:211] op_sel_hi:[1,0,1]
    v_max3_f32 v219, abs(v208), abs(v209), v219
    v_max3_f32 v219, abs(v210), abs(v211), v219
    v_cvt_pk_bf16_f32 v208, v208, v209
    v_cvt_pk_bf16_f32 v209, v210, v211
    buffer_store_dwordx2 v[208:209], v168, s[24:27], 0 offen offset:0
    v_pk_mul_f32 v[212:213], v[100:101], v[160:161] op_sel:[0,1] op_sel_hi:[1,1]
    v_pk_mul_f32 v[214:215], v[102:103], v[160:161] op_sel:[0,1] op_sel_hi:[1,1]
    v_pk_fma_f32 v[212:213], v[180:181], v[160:161], v[212:213] op_sel_hi:[1,0,1]
    v_pk_fma_f32 v[214:215], v[182:183], v[160:161], v[214:215] op_sel_hi:[1,0,1]
    v_max3_f32 v219, abs(v212), abs(v213), v219
    v_max3_f32 v219, abs(v214), abs(v215), v219
    v_cvt_pk_bf16_f32 v212, v212, v213
    v_cvt_pk_bf16_f32 v213, v214, v215
    buffer_store_dwordx2 v[212:213], v169, s[24:27], 0 offen offset:0
    v_pk_mul_f32 v[208:209], v[104:105], v[160:161] op_sel:[0,1] op_sel_hi:[1,1]
    v_pk_mul_f32 v[210:211], v[106:107], v[160:161] op_sel:[0,1] op_sel_hi:[1,1]
    v_pk_fma_f32 v[208:209], v[184:185], v[160:161], v[208:209] op_sel_hi:[1,0,1]
    v_pk_fma_f32 v[210:211], v[186:187], v[160:161], v[210:211] op_sel_hi:[1,0,1]
    v_max3_f32 v219, abs(v208), abs(v209), v219
    v_max3_f32 v219, abs(v210), abs(v211), v219
    v_cvt_pk_bf16_f32 v208, v208, v209
    v_cvt_pk_bf16_f32 v209, v210, v211
    buffer_store_dwordx2 v[208:209], v170, s[24:27], 0 offen offset:0
    v_pk_mul_f32 v[212:213], v[108:109], v[160:161] op_sel:[0,1] op_sel_hi:[1,1]
    v_pk_mul_f32 v[214:215], v[110:111], v[160:161] op_sel:[0,1] op_sel_hi:[1,1]
    v_pk_fma_f32 v[212:213], v[188:189], v[160:161], v[212:213] op_sel_hi:[1,0,1]
    v_pk_fma_f32 v[214:215], v[190:191], v[160:161], v[214:215] op_sel_hi:[1,0,1]
    v_max3_f32 v219, abs(v212), abs(v213), v219
    v_max3_f32 v219, abs(v214), abs(v215), v219
    v_cvt_pk_bf16_f32 v212, v212, v213
    v_cvt_pk_bf16_f32 v213, v214, v215
    buffer_store_dwordx2 v[212:213], v171, s[24:27], 0 offen offset:0
    v_pk_mul_f32 v[208:209], v[128:129], v[160:161] op_sel:[0,1] op_sel_hi:[1,1]
    v_pk_mul_f32 v[210:211], v[130:131], v[160:161] op_sel:[0,1] op_sel_hi:[1,1]
    v_pk_fma_f32 v[208:209], v[192:193], v[160:161], v[208:209] op_sel_hi:[1,0,1]
    v_pk_fma_f32 v[210:211], v[194:195], v[160:161], v[210:211] op_sel_hi:[1,0,1]
    v_max3_f32 v219, abs(v208), abs(v209), v219
    v_max3_f32 v219, abs(v210), abs(v211), v219
    v_cvt_pk_bf16_f32 v208, v208, v209
    v_cvt_pk_bf16_f32 v209, v210, v211
    buffer_store_dwordx2 v[208:209], v172, s[24:27], 0 offen offset:0
    v_pk_mul_f32 v[212:213], v[132:133], v[160:161] op_sel:[0,1] op_sel_hi:[1,1]
    v_pk_mul_f32 v[214:215], v[134:135], v[160:161] op_sel:[0,1] op_sel_hi:[1,1]
    v_pk_fma_f32 v[212:213], v[196:197], v[160:161], v[212:213] op_sel_hi:[1,0,1]
    v_pk_fma_f32 v[214:215], v[198:199], v[160:161], v[214:215] op_sel_hi:[1,0,1]
    v_max3_f32 v219, abs(v212), abs(v213), v219
    v_max3_f32 v219, abs(v214), abs(v215), v219
    v_cvt_pk_bf16_f32 v212, v212, v213
    v_cvt_pk_bf16_f32 v213, v214, v215
    buffer_store_dwordx2 v[212:213], v173, s[24:27], 0 offen offset:0
    v_pk_mul_f32 v[208:209], v[136:137], v[160:161] op_sel:[0,1] op_sel_hi:[1,1]
    v_pk_mul_f32 v[210:211], v[138:139], v[160:161] op_sel:[0,1] op_sel_hi:[1,1]
    v_pk_fma_f32 v[208:209], v[200:201], v[160:161], v[208:209] op_sel_hi:[1,0,1]
    v_pk_fma_f32 v[210:211], v[202:203], v[160:161], v[210:211] op_sel_hi:[1,0,1]
    v_max3_f32 v219, abs(v208), abs(v209), v219
    v_max3_f32 v219, abs(v210), abs(v211), v219
    v_cvt_pk_bf16_f32 v208, v208, v209
    v_cvt_pk_bf16_f32 v209, v210, v211
    buffer_store_dwordx2 v[208:209], v174, s[24:27], 0 offen offset:0
    v_pk_mul_f32 v[212:213], v[140:141], v[160:161] op_sel:[0,1] op_sel_hi:[1,1]
    v_pk_mul_f32 v[214:215], v[142:143], v[160:161] op_sel:[0,1] op_sel_hi:[1,1]
    v_pk_fma_f32 v[212:213], v[204:205], v[160:161], v[212:213] op_sel_hi:[1,0,1]
    v_pk_fma_f32 v[214:215], v[206:207], v[160:161], v[214:215] op_sel_hi:[1,0,1]
    v_max3_f32 v219, abs(v212), abs(v213), v219
    v_max3_f32 v219, abs(v214), abs(v215), v219
    v_cvt_pk_bf16_f32 v212, v212, v213
    v_cvt_pk_bf16_f32 v213, v214, v215
    buffer_store_dwordx2 v[212:213], v175, s[24:27], 0 offen offset:0
    v_pk_mul_f32 v[208:209], v[112:113], v[162:163] op_sel:[0,1] op_sel_hi:[1,1]
    v_pk_mul_f32 v[210:211], v[114:115], v[162:163] op_sel:[0,1] op_sel_hi:[1,1]
    v_pk_fma_f32 v[208:209], v[176:177], v[162:163], v[208:209] op_sel_hi:[1,0,1]
    v_pk_fma_f32 v[210:211], v[178:179], v[162:163], v[210:211] op_sel_hi:[1,0,1]
    v_max3_f32 v219, abs(v208), abs(v209), v219
    v_max3_f32 v219, abs(v210), abs(v211), v219
    v_cvt_pk_bf16_f32 v208, v208, v209
    v_cvt_pk_bf16_f32 v209, v210, v211
    buffer_store_dwordx2 v[208:209], v168, s[24:27], 0 offen offset:2048
    v_pk_mul_f32 v[212:213], v[116:117], v[162:163] op_sel:[0,1] op_sel_hi:[1,1]
    v_pk_mul_f32 v[214:215], v[118:119], v[162:163] op_sel:[0,1] op_sel_hi:[1,1]
    v_pk_fma_f32 v[212:213], v[180:181], v[162:163], v[212:213] op_sel_hi:[1,0,1]
    v_pk_fma_f32 v[214:215], v[182:183], v[162:163], v[214:215] op_sel_hi:[1,0,1]
    v_max3_f32 v219, abs(v212), abs(v213), v219
    v_max3_f32 v219, abs(v214), abs(v215), v219
    v_cvt_pk_bf16_f32 v212, v212, v213
    v_cvt_pk_bf16_f32 v213, v214, v215
    buffer_store_dwordx2 v[212:213], v169, s[24:27], 0 offen offset:2048
    v_pk_mul_f32 v[208:209], v[120:121], v[162:163] op_sel:[0,1] op_sel_hi:[1,1]
    v_pk_mul_f32 v[210:211], v[122:123], v[162:163] op_sel:[0,1] op_sel_hi:[1,1]
    v_pk_fma_f32 v[208:209], v[184:185], v[162:163], v[208:209] op_sel_hi:[1,0,1]
    v_pk_fma_f32 v[210:211], v[186:187], v[162:163], v[210:211] op_sel_hi:[1,0,1]
    v_max3_f32 v219, abs(v208), abs(v209), v219
    v_max3_f32 v219, abs(v210), abs(v211), v219
    v_cvt_pk_bf16_f32 v208, v208, v209
    v_cvt_pk_bf16_f32 v209, v210, v211
    buffer_store_dwordx2 v[208:209], v170, s[24:27], 0 offen offset:2048
    v_pk_mul_f32 v[212:213], v[124:125], v[162:163] op_sel:[0,1] op_sel_hi:[1,1]
    v_pk_mul_f32 v[214:215], v[126:127], v[162:163] op_sel:[0,1] op_sel_hi:[1,1]
    v_pk_fma_f32 v[212:213], v[188:189], v[162:163], v[212:213] op_sel_hi:[1,0,1]
    v_pk_fma_f32 v[214:215], v[190:191], v[162:163], v[214:215] op_sel_hi:[1,0,1]
    v_max3_f32 v219, abs(v212), abs(v213), v219
    v_max3_f32 v219, abs(v214), abs(v215), v219
    v_cvt_pk_bf16_f32 v212, v212, v213
    v_cvt_pk_bf16_f32 v213, v214, v215
    buffer_store_dwordx2 v[212:213], v171, s[24:27], 0 offen offset:2048
    v_pk_mul_f32 v[208:209], v[144:145], v[162:163] op_sel:[0,1] op_sel_hi:[1,1]
    v_pk_mul_f32 v[210:211], v[146:147], v[162:163] op_sel:[0,1] op_sel_hi:[1,1]
    v_pk_fma_f32 v[208:209], v[192:193], v[162:163], v[208:209] op_sel_hi:[1,0,1]
    v_pk_fma_f32 v[210:211], v[194:195], v[162:163], v[210:211] op_sel_hi:[1,0,1]
    v_max3_f32 v219, abs(v208), abs(v209), v219
    v_max3_f32 v219, abs(v210), abs(v211), v219
    v_cvt_pk_bf16_f32 v208, v208, v209
    v_cvt_pk_bf16_f32 v209, v210, v211
    buffer_store_dwordx2 v[208:209], v172, s[24:27], 0 offen offset:2048
    v_pk_mul_f32 v[212:213], v[148:149], v[162:163] op_sel:[0,1] op_sel_hi:[1,1]
    v_pk_mul_f32 v[214:215], v[150:151], v[162:163] op_sel:[0,1] op_sel_hi:[1,1]
    v_pk_fma_f32 v[212:213], v[196:197], v[162:163], v[212:213] op_sel_hi:[1,0,1]
    v_pk_fma_f32 v[214:215], v[198:199], v[162:163], v[214:215] op_sel_hi:[1,0,1]
    v_max3_f32 v219, abs(v212), abs(v213), v219
    v_max3_f32 v219, abs(v214), abs(v215), v219
    v_cvt_pk_bf16_f32 v212, v212, v213
    v_cvt_pk_bf16_f32 v213, v214, v215
    buffer_store_dwordx2 v[212:213], v173, s[24:27], 0 offen offset:2048
    v_pk_mul_f32 v[208:209], v[152:153], v[162:163] op_sel:[0,1] op_sel_hi:[1,1]
    v_pk_mul_f32 v[210:211], v[154:155], v[162:163] op_sel:[0,1] op_sel_hi:[1,1]
    v_pk_fma_f32 v[208:209], v[200:201], v[162:163], v[208:209] op_sel_hi:[1,0,1]
    v_pk_fma_f32 v[210:211], v[202:203], v[162:163], v[210:211] op_sel_hi:[1,0,1]
    v_max3_f32 v219, abs(v208), abs(v209), v219
    v_max3_f32 v219, abs(v210), abs(v211), v219
    v_cvt_pk_bf16_f32 v208, v208, v209
    v_cvt_pk_bf16_f32 v209, v210, v211
    buffer_store_dwordx2 v[208:209], v174, s[24:27], 0 offen offset:2048
    v_pk_mul_f32 v[212:213], v[156:157], v[162:163] op_sel:[0,1] op_sel_hi:[1,1]
    v_pk_mul_f32 v[214:215], v[158:159], v[162:163] op_sel:[0,1] op_sel_hi:[1,1]
    v_pk_fma_f32 v[212:213], v[204:205], v[162:163], v[212:213] op_sel_hi:[1,0,1]
    v_pk_fma_f32 v[214:215], v[206:207], v[162:163], v[214:215] op_sel_hi:[1,0,1]
    v_max3_f32 v219, abs(v212), abs(v213), v219
    v_max3_f32 v219, abs(v214), abs(v215), v219
    v_cvt_pk_bf16_f32 v212, v212, v213
    v_cvt_pk_bf16_f32 v213, v214, v215
    buffer_store_dwordx2 v[212:213], v175, s[24:27], 0 offen offset:2048
    s_cmp_lt_u32 s4, 5
    s_cbranch_scc1 qkvdone_qkv0_kernel_5
    v_xor_b32 v216, 1, v1
    v_lshlrev_b32 v216, 2, v216
    ds_bpermute_b32 v217, v216, v219
    s_waitcnt lgkmcnt(0)
    v_max_f32 v219, v219, v217
    v_xor_b32 v216, 2, v1
    v_lshlrev_b32 v216, 2, v216
    ds_bpermute_b32 v217, v216, v219
    s_waitcnt lgkmcnt(0)
    v_max_f32 v219, v219, v217
    v_xor_b32 v216, 4, v1
    v_lshlrev_b32 v216, 2, v216
    ds_bpermute_b32 v217, v216, v219
    s_waitcnt lgkmcnt(0)
    v_max_f32 v219, v219, v217
    v_xor_b32 v216, 8, v1
    v_lshlrev_b32 v216, 2, v216
    ds_bpermute_b32 v217, v216, v219
    s_waitcnt lgkmcnt(0)
    v_max_f32 v219, v219, v217
    v_xor_b32 v216, 16, v1
    v_lshlrev_b32 v216, 2, v216
    ds_bpermute_b32 v217, v216, v219
    s_waitcnt lgkmcnt(0)
    v_max_f32 v219, v219, v217
    v_xor_b32 v216, 32, v1
    v_lshlrev_b32 v216, 2, v216
    ds_bpermute_b32 v217, v216, v219
    s_waitcnt lgkmcnt(0)
    v_max_f32 v219, v219, v217
    s_sub_u32 s58, s2, 80
    s_lshl_b32 s58, s58, 2
    s_add_u32 s58, s58, s5
    s_lshl_b32 s58, s58, 2
    s_add_u32 s58, s58, 0x30000
    v_mov_b32 v216, s58
    buffer_store_dword v219, v216, s[20:23], 0 offen
    s_branch qkvdone_qkv0_kernel_5
vpath_qkv0_kernel_4:
    v_bfe_u32 v216, v1, 2, 1
    v_lshlrev_b32 v216, 4, v216
    v_bfe_u32 v217, v1, 3, 2
    v_lshl_add_u32 v216, v217, 2, v216
    v_and_b32 v217, 3, v1
    v_add_u32 v216, v216, v217
    s_lshl_b32 s58, s7, 6
    v_add_u32 v216, s58, v216
    s_sub_u32 s58, s57, 1280
    s_movk_i32 s61, 3277
    v_add_u32 v218, s58, v216
    v_mul_lo_u32 v219, v218, s61
    v_lshrrev_b32 v219, 16, v219
    v_mul_u32_u24 v194, 20, v219
    v_sub_u32 v194, v218, v194
    v_lshlrev_b32 v194, 4, v194
    v_lshl_add_u32 v194, v219, 17, v194
    v_lshl_add_u32 v194, v42, 9, v194
    v_add_u32 v218, s58, v216
    v_add_u32 v218, 32, v218
    v_mul_lo_u32 v219, v218, s61
    v_lshrrev_b32 v219, 16, v219
    v_mul_u32_u24 v195, 20, v219
    v_sub_u32 v195, v218, v195
    v_lshlrev_b32 v195, 4, v195
    v_lshl_add_u32 v195, v219, 17, v195
    v_lshl_add_u32 v195, v42, 9, v195
    s_lshl_b32 s58, s3, 2
    s_lshl_b32 s60, s6, 1
    s_add_u32 s58, s58, s60
    s_lshl_b32 s58, s58, 11
    s_add_u32 s58, s58, 0x800000
    v_add_u32 v194, s58, v194
    v_add_u32 v195, s58, v195
    s_waitcnt lgkmcnt(0)
    s_barrier
    v_add_u32 v36, s51, v30
    v_add_u32 v37, s51, v31
    v_add_u32 v38, s51, v32
    v_add_u32 v39, s51, v33
    v_add_u32 v40, s51, v34
    v_add_u32 v41, s51, v35
    s_add_u32 s51, s51, 32768
    s_cmp_eq_u32 s51, 133120
    s_cselect_b32 s51, 2048, s51
    ds_read_b128 v[48:51], v36 offset:0
    ds_read_b128 v[52:55], v36 offset:4096
    ds_read_b64_tr_b16 v[72:73], v40 offset:0
    ds_read_b64_tr_b16 v[74:75], v40 offset:1024
    ds_read_b64_tr_b16 v[76:77], v41 offset:0
    ds_read_b64_tr_b16 v[78:79], v41 offset:1024
    ds_read_b128 v[56:59], v37 offset:0
    ds_read_b128 v[60:63], v37 offset:4096
    ds_read_b64_tr_b16 v[80:81], v40 offset:4096
    ds_read_b64_tr_b16 v[82:83], v40 offset:5120
    ds_read_b64_tr_b16 v[84:85], v41 offset:4096
    ds_read_b64_tr_b16 v[86:87], v41 offset:5120
    s_waitcnt lgkmcnt(6)
    ds_read_b128 v[64:67], v38 offset:0
    ds_read_b128 v[68:71], v38 offset:4096
    v_mfma_f32_32x32x16_bf16 v[96:111], v[48:51], v[72:75], 0
    ds_read_b64_tr_b16 v[88:89], v40 offset:8192
    v_mfma_f32_32x32x16_bf16 v[112:127], v[52:55], v[72:75], 0
    ds_read_b64_tr_b16 v[90:91], v40 offset:9216
    v_mfma_f32_32x32x16_bf16 v[128:143], v[48:51], v[76:79], 0
    ds_read_b64_tr_b16 v[92:93], v41 offset:8192
    v_mfma_f32_32x32x16_bf16 v[144:159], v[52:55], v[76:79], 0
    ds_read_b64_tr_b16 v[94:95], v41 offset:9216
    s_waitcnt lgkmcnt(6)
    ds_read_b128 v[48:51], v39 offset:0
    ds_read_b128 v[52:55], v39 offset:4096
    v_mfma_f32_32x32x16_bf16 v[96:111], v[56:59], v[80:83], v[96:111]
    ds_read_b64_tr_b16 v[72:73], v40 offset:12288
    v_mfma_f32_32x32x16_bf16 v[112:127], v[60:63], v[80:83], v[112:127]
    ds_read_b64_tr_b16 v[74:75], v40 offset:13312
    v_mfma_f32_32x32x16_bf16 v[128:143], v[56:59], v[84:87], v[128:143]
    ds_read_b64_tr_b16 v[76:77], v41 offset:12288
    v_mfma_f32_32x32x16_bf16 v[144:159], v[60:63], v[84:87], v[144:159]
    ds_read_b64_tr_b16 v[78:79], v41 offset:13312
    s_waitcnt lgkmcnt(6)
    s_barrier
    v_add_u32 v36, s51, v30
    v_add_u32 v37, s51, v31
    v_add_u32 v38, s51, v32
    v_add_u32 v39, s51, v33
    v_add_u32 v40, s51, v34
    v_add_u32 v41, s51, v35
    s_add_u32 s51, s51, 32768
    s_cmp_eq_u32 s51, 133120
    s_cselect_b32 s51, 2048, s51
    ds_read_b128 v[56:59], v36 offset:0
    ds_read_b128 v[60:63], v36 offset:4096
    v_mfma_f32_32x32x16_bf16 v[96:111], v[64:67], v[88:91], v[96:111]
    ds_read_b64_tr_b16 v[80:81], v40 offset:0
    v_mfma_f32_32x32x16_bf16 v[112:127], v[68:71], v[88:91], v[112:127]
    ds_read_b64_tr_b16 v[82:83], v40 offset:1024
    v_mfma_f32_32x32x16_bf16 v[128:143], v[64:67], v[92:95], v[128:143]
    ds_read_b64_tr_b16 v[84:85], v41 offset:0
    v_mfma_f32_32x32x16_bf16 v[144:159], v[68:71], v[92:95], v[144:159]
    ds_read_b64_tr_b16 v[86:87], v41 offset:1024
    s_waitcnt lgkmcnt(6)
    ds_read_b128 v[64:67], v37 offset:0
    ds_read_b128 v[68:71], v37 offset:4096
    v_mfma_f32_32x32x16_bf16 v[96:111], v[48:51], v[72:75], v[96:111]
    ds_read_b64_tr_b16 v[88:89], v40 offset:4096
    v_mfma_f32_32x32x16_bf16 v[112:127], v[52:55], v[72:75], v[112:127]
    ds_read_b64_tr_b16 v[90:91], v40 offset:5120
    v_mfma_f32_32x32x16_bf16 v[128:143], v[48:51], v[76:79], v[128:143]
    ds_read_b64_tr_b16 v[92:93], v41 offset:4096
    v_mfma_f32_32x32x16_bf16 v[144:159], v[52:55], v[76:79], v[144:159]
    ds_read_b64_tr_b16 v[94:95], v41 offset:5120
    s_waitcnt lgkmcnt(6)
    s_waitcnt vmcnt(0)
    v_add_f32 v24, v24, v27
    v_add_f32 v24, v24, v28
    v_add_f32 v24, v24, v29
    v_add_f32 v8, v8, v10
    v_add_f32 v9, v9, v11
    v_add_f32 v8, v8, v12
    v_add_f32 v9, v9, v13
    v_add_f32 v8, v8, v14
    v_add_f32 v9, v9, v15
    v_add_f32 v8, v8, v16
    v_add_f32 v9, v9, v17
    v_add_f32 v8, v8, v18
    v_add_f32 v9, v9, v19
    v_add_f32 v8, v8, v20
    v_add_f32 v9, v9, v21
    v_add_f32 v8, v8, v22
    v_add_f32 v9, v9, v23
    v_mul_f32 v8, 0x3acccccd, v8
    v_mul_f32 v9, 0x3acccccd, v9
    v_fma_f32 v9, -v8, v8, v9
    v_max_f32 v9, 0, v9
    v_add_f32 v9, 0x3727c5ac, v9
    v_rsq_f32 v9, v9
    s_nop 0
    v_mul_f32 v8, v8, v9
    v_sub_f32 v8, 0, v8
    v_lshlrev_b32 v3, 3, v0
    v_cmp_gt_u32 vcc, 128, v0
    s_and_saveexec_b64 s[60:61], vcc
    s_cbranch_execz aux_qkv0_kernel_9
    ds_write_b64 v3, v[8:9] offset:0
aux_qkv0_kernel_9:
    s_mov_b64 exec, s[60:61]
    v_lshlrev_b32 v3, 2, v0
    v_cmp_gt_u32 vcc, 128, v0
    s_and_saveexec_b64 s[60:61], vcc
    s_cbranch_execz aux_qkv0_kernel_10
    ds_write_b32 v3, v24 offset:1024
aux_qkv0_kernel_10:
    s_mov_b64 exec, s[60:61]
    s_mov_b32 s55, 2
loop_qkv0_kernel_11:
    ds_read_b128 v[48:51], v38 offset:0
    ds_read_b128 v[52:55], v38 offset:4096
    v_mfma_f32_32x32x16_bf16 v[96:111], v[56:59], v[80:83], v[96:111]
    ds_read_b64_tr_b16 v[72:73], v40 offset:8192
    v_mfma_f32_32x32x16_bf16 v[112:127], v[60:63], v[80:83], v[112:127]
    ds_read_b64_tr_b16 v[74:75], v40 offset:9216
    v_mfma_f32_32x32x16_bf16 v[128:143], v[56:59], v[84:87], v[128:143]
    ds_read_b64_tr_b16 v[76:77], v41 offset:8192
    v_mfma_f32_32x32x16_bf16 v[144:159], v[60:63], v[84:87], v[144:159]
    ds_read_b64_tr_b16 v[78:79], v41 offset:9216
    s_waitcnt lgkmcnt(6)
    ds_read_b128 v[56:59], v39 offset:0
    ds_read_b128 v[60:63], v39 offset:4096
    v_mfma_f32_32x32x16_bf16 v[96:111], v[64:67], v[88:91], v[96:111]
    ds_read_b64_tr_b16 v[80:81], v40 offset:12288
    v_mfma_f32_32x32x16_bf16 v[112:127], v[68:71], v[88:91], v[112:127]
    ds_read_b64_tr_b16 v[82:83], v40 offset:13312
    v_mfma_f32_32x32x16_bf16 v[128:143], v[64:67], v[92:95], v[128:143]
    ds_read_b64_tr_b16 v[84:85], v41 offset:12288
    v_mfma_f32_32x32x16_bf16 v[144:159], v[68:71], v[92:95], v[144:159]
    ds_read_b64_tr_b16 v[86:87], v41 offset:13312
    s_waitcnt lgkmcnt(6)
    s_barrier
    v_add_u32 v36, s51, v30
    v_add_u32 v37, s51, v31
    v_add_u32 v38, s51, v32
    v_add_u32 v39, s51, v33
    v_add_u32 v40, s51, v34
    v_add_u32 v41, s51, v35
    s_add_u32 s51, s51, 32768
    s_cmp_eq_u32 s51, 133120
    s_cselect_b32 s51, 2048, s51
    ds_read_b128 v[64:67], v36 offset:0
    ds_read_b128 v[68:71], v36 offset:4096
    v_mfma_f32_32x32x16_bf16 v[96:111], v[48:51], v[72:75], v[96:111]
    ds_read_b64_tr_b16 v[88:89], v40 offset:0
    v_mfma_f32_32x32x16_bf16 v[112:127], v[52:55], v[72:75], v[112:127]
    ds_read_b64_tr_b16 v[90:91], v40 offset:1024
    v_mfma_f32_32x32x16_bf16 v[128:143], v[48:51], v[76:79], v[128:143]
    ds_read_b64_tr_b16 v[92:93], v41 offset:0
    v_mfma_f32_32x32x16_bf16 v[144:159], v[52:55], v[76:79], v[144:159]
    ds_read_b64_tr_b16 v[94:95], v41 offset:1024
    s_waitcnt lgkmcnt(6)
    ds_read_b128 v[48:51], v37 offset:0
    ds_read_b128 v[52:55], v37 offset:4096
    v_mfma_f32_32x32x16_bf16 v[96:111], v[56:59], v[80:83], v[96:111]
    ds_read_b64_tr_b16 v[72:73], v40 offset:4096
    v_mfma_f32_32x32x16_bf16 v[112:127], v[60:63], v[80:83], v[112:127]
    ds_read_b64_tr_b16 v[74:75], v40 offset:5120
    v_mfma_f32_32x32x16_bf16 v[128:143], v[56:59], v[84:87], v[128:143]
    ds_read_b64_tr_b16 v[76:77], v41 offset:4096
    v_mfma_f32_32x32x16_bf16 v[144:159], v[60:63], v[84:87], v[144:159]
    ds_read_b64_tr_b16 v[78:79], v41 offset:5120
    s_waitcnt lgkmcnt(6)
    ds_read_b128 v[56:59], v38 offset:0
    ds_read_b128 v[60:63], v38 offset:4096
    v_mfma_f32_32x32x16_bf16 v[96:111], v[64:67], v[88:91], v[96:111]
    ds_read_b64_tr_b16 v[80:81], v40 offset:8192
    v_mfma_f32_32x32x16_bf16 v[112:127], v[68:71], v[88:91], v[112:127]
    ds_read_b64_tr_b16 v[82:83], v40 offset:9216
    v_mfma_f32_32x32x16_bf16 v[128:143], v[64:67], v[92:95], v[128:143]
    ds_read_b64_tr_b16 v[84:85], v41 offset:8192
    v_mfma_f32_32x32x16_bf16 v[144:159], v[68:71], v[92:95], v[144:159]
    ds_read_b64_tr_b16 v[86:87], v41 offset:9216
    s_waitcnt lgkmcnt(6)
    ds_read_b128 v[64:67], v39 offset:0
    ds_read_b128 v[68:71], v39 offset:4096
    v_mfma_f32_32x32x16_bf16 v[96:111], v[48:51], v[72:75], v[96:111]
    ds_read_b64_tr_b16 v[88:89], v40 offset:12288
    v_mfma_f32_32x32x16_bf16 v[112:127], v[52:55], v[72:75], v[112:127]
    ds_read_b64_tr_b16 v[90:91], v40 offset:13312
    v_mfma_f32_32x32x16_bf16 v[128:143], v[48:51], v[76:79], v[128:143]
    ds_read_b64_tr_b16 v[92:93], v41 offset:12288
    v_mfma_f32_32x32x16_bf16 v[144:159], v[52:55], v[76:79], v[144:159]
    ds_read_b64_tr_b16 v[94:95], v41 offset:13312
    s_waitcnt lgkmcnt(6)
    s_barrier
    v_add_u32 v36, s51, v30
    v_add_u32 v37, s51, v31
    v_add_u32 v38, s51, v32
    v_add_u32 v39, s51, v33
    v_add_u32 v40, s51, v34
    v_add_u32 v41, s51, v35
    s_add_u32 s51, s51, 32768
    s_cmp_eq_u32 s51, 133120
    s_cselect_b32 s51, 2048, s51
    ds_read_b128 v[48:51], v36 offset:0
    ds_read_b128 v[52:55], v36 offset:4096
    v_mfma_f32_32x32x16_bf16 v[96:111], v[56:59], v[80:83], v[96:111]
    ds_read_b64_tr_b16 v[72:73], v40 offset:0
    v_mfma_f32_32x32x16_bf16 v[112:127], v[60:63], v[80:83], v[112:127]
    ds_read_b64_tr_b16 v[74:75], v40 offset:1024
    v_mfma_f32_32x32x16_bf16 v[128:143], v[56:59], v[84:87], v[128:143]
    ds_read_b64_tr_b16 v[76:77], v41 offset:0
    v_mfma_f32_32x32x16_bf16 v[144:159], v[60:63], v[84:87], v[144:159]
    ds_read_b64_tr_b16 v[78:79], v41 offset:1024
    s_waitcnt lgkmcnt(6)
    ds_read_b128 v[56:59], v37 offset:0
    ds_read_b128 v[60:63], v37 offset:4096
    v_mfma_f32_32x32x16_bf16 v[96:111], v[64:67], v[88:91], v[96:111]
    ds_read_b64_tr_b16 v[80:81], v40 offset:4096
    v_mfma_f32_32x32x16_bf16 v[112:127], v[68:71], v[88:91], v[112:127]
    ds_read_b64_tr_b16 v[82:83], v40 offset:5120
    v_mfma_f32_32x32x16_bf16 v[128:143], v[64:67], v[92:95], v[128:143]
    ds_read_b64_tr_b16 v[84:85], v41 offset:4096
    v_mfma_f32_32x32x16_bf16 v[144:159], v[68:71], v[92:95], v[144:159]
    ds_read_b64_tr_b16 v[86:87], v41 offset:5120
    s_waitcnt lgkmcnt(6)
    ds_read_b128 v[64:67], v38 offset:0
    ds_read_b128 v[68:71], v38 offset:4096
    v_mfma_f32_32x32x16_bf16 v[96:111], v[48:51], v[72:75], v[96:111]
    ds_read_b64_tr_b16 v[88:89], v40 offset:8192
    v_mfma_f32_32x32x16_bf16 v[112:127], v[52:55], v[72:75], v[112:127]
    ds_read_b64_tr_b16 v[90:91], v40 offset:9216
    v_mfma_f32_32x32x16_bf16 v[128:143], v[48:51], v[76:79], v[128:143]
    ds_read_b64_tr_b16 v[92:93], v41 offset:8192
    v_mfma_f32_32x32x16_bf16 v[144:159], v[52:55], v[76:79], v[144:159]
    ds_read_b64_tr_b16 v[94:95], v41 offset:9216
    s_waitcnt lgkmcnt(6)
    ds_read_b128 v[48:51], v39 offset:0
    ds_read_b128 v[52:55], v39 offset:4096
    v_mfma_f32_32x32x16_bf16 v[96:111], v[56:59], v[80:83], v[96:111]
    ds_read_b64_tr_b16 v[72:73], v40 offset:12288
    v_mfma_f32_32x32x16_bf16 v[112:127], v[60:63], v[80:83], v[112:127]
    ds_read_b64_tr_b16 v[74:75], v40 offset:13312
    v_mfma_f32_32x32x16_bf16 v[128:143], v[56:59], v[84:87], v[128:143]
    ds_read_b64_tr_b16 v[76:77], v41 offset:12288
    v_mfma_f32_32x32x16_bf16 v[144:159], v[60:63], v[84:87], v[144:159]
    ds_read_b64_tr_b16 v[78:79], v41 offset:13312
    s_waitcnt lgkmcnt(6)
    s_barrier
    v_add_u32 v36, s51, v30
    v_add_u32 v37, s51, v31
    v_add_u32 v38, s51, v32
    v_add_u32 v39, s51, v33
    v_add_u32 v40, s51, v34
    v_add_u32 v41, s51, v35
    s_add_u32 s51, s51, 32768
    s_cmp_eq_u32 s51, 133120
    s_cselect_b32 s51, 2048, s51
    ds_read_b128 v[56:59], v36 offset:0
    ds_read_b128 v[60:63], v36 offset:4096
    v_mfma_f32_32x32x16_bf16 v[96:111], v[64:67], v[88:91], v[96:111]
    ds_read_b64_tr_b16 v[80:81], v40 offset:0
    v_mfma_f32_32x32x16_bf16 v[112:127], v[68:71], v[88:91], v[112:127]
    ds_read_b64_tr_b16 v[82:83], v40 offset:1024
    v_mfma_f32_32x32x16_bf16 v[128:143], v[64:67], v[92:95], v[128:143]
    ds_read_b64_tr_b16 v[84:85], v41 offset:0
    v_mfma_f32_32x32x16_bf16 v[144:159], v[68:71], v[92:95], v[144:159]
    ds_read_b64_tr_b16 v[86:87], v41 offset:1024
    s_waitcnt lgkmcnt(6)
    ds_read_b128 v[64:67], v37 offset:0
    ds_read_b128 v[68:71], v37 offset:4096
    v_mfma_f32_32x32x16_bf16 v[96:111], v[48:51], v[72:75], v[96:111]
    ds_read_b64_tr_b16 v[88:89], v40 offset:4096
    v_mfma_f32_32x32x16_bf16 v[112:127], v[52:55], v[72:75], v[112:127]
    ds_read_b64_tr_b16 v[90:91], v40 offset:5120
    v_mfma_f32_32x32x16_bf16 v[128:143], v[48:51], v[76:79], v[128:143]
    ds_read_b64_tr_b16 v[92:93], v41 offset:4096
    v_mfma_f32_32x32x16_bf16 v[144:159], v[52:55], v[76:79], v[144:159]
    ds_read_b64_tr_b16 v[94:95], v41 offset:5120
    s_waitcnt lgkmcnt(6)
    s_sub_u32 s55, s55, 1
    s_cmp_lg_u32 s55, 0
    s_cbranch_scc1 loop_qkv0_kernel_11
    ds_read_b128 v[48:51], v38 offset:0
    ds_read_b128 v[52:55], v38 offset:4096
    v_mfma_f32_32x32x16_bf16 v[96:111], v[56:59], v[80:83], v[96:111]
    ds_read_b64_tr_b16 v[72:73], v40 offset:8192
    v_mfma_f32_32x32x16_bf16 v[112:127], v[60:63], v[80:83], v[112:127]
    ds_read_b64_tr_b16 v[74:75], v40 offset:9216
    v_mfma_f32_32x32x16_bf16 v[128:143], v[56:59], v[84:87], v[128:143]
    ds_read_b64_tr_b16 v[76:77], v41 offset:8192
    v_mfma_f32_32x32x16_bf16 v[144:159], v[60:63], v[84:87], v[144:159]
    ds_read_b64_tr_b16 v[78:79], v41 offset:9216
    s_waitcnt lgkmcnt(6)
    ds_read_b128 v[56:59], v39 offset:0
    ds_read_b128 v[60:63], v39 offset:4096
    v_mfma_f32_32x32x16_bf16 v[96:111], v[64:67], v[88:91], v[96:111]
    ds_read_b64_tr_b16 v[80:81], v40 offset:12288
    v_mfma_f32_32x32x16_bf16 v[112:127], v[68:71], v[88:91], v[112:127]
    ds_read_b64_tr_b16 v[82:83], v40 offset:13312
    v_mfma_f32_32x32x16_bf16 v[128:143], v[64:67], v[92:95], v[128:143]
    ds_read_b64_tr_b16 v[84:85], v41 offset:12288
    v_mfma_f32_32x32x16_bf16 v[144:159], v[68:71], v[92:95], v[144:159]
    ds_read_b64_tr_b16 v[86:87], v41 offset:13312
    s_waitcnt lgkmcnt(6)
    s_barrier
    v_add_u32 v36, s51, v30
    v_add_u32 v37, s51, v31
    v_add_u32 v38, s51, v32
    v_add_u32 v39, s51, v33
    v_add_u32 v40, s51, v34
    v_add_u32 v41, s51, v35
    s_add_u32 s51, s51, 32768
    s_cmp_eq_u32 s51, 133120
    s_cselect_b32 s51, 2048, s51
    ds_read_b128 v[64:67], v36 offset:0
    ds_read_b128 v[68:71], v36 offset:4096
    v_mfma_f32_32x32x16_bf16 v[96:111], v[48:51], v[72:75], v[96:111]
    ds_read_b64_tr_b16 v[88:89], v40 offset:0
    v_mfma_f32_32x32x16_bf16 v[112:127], v[52:55], v[72:75], v[112:127]
    ds_read_b64_tr_b16 v[90:91], v40 offset:1024
    v_mfma_f32_32x32x16_bf16 v[128:143], v[48:51], v[76:79], v[128:143]
    ds_read_b64_tr_b16 v[92:93], v41 offset:0
    v_mfma_f32_32x32x16_bf16 v[144:159], v[52:55], v[76:79], v[144:159]
    ds_read_b64_tr_b16 v[94:95], v41 offset:1024
    s_waitcnt lgkmcnt(6)
    ds_read_b128 v[48:51], v37 offset:0
    ds_read_b128 v[52:55], v37 offset:4096
    v_mfma_f32_32x32x16_bf16 v[96:111], v[56:59], v[80:83], v[96:111]
    ds_read_b64_tr_b16 v[72:73], v40 offset:4096
    v_mfma_f32_32x32x16_bf16 v[112:127], v[60:63], v[80:83], v[112:127]
    ds_read_b64_tr_b16 v[74:75], v40 offset:5120
    v_mfma_f32_32x32x16_bf16 v[128:143], v[56:59], v[84:87], v[128:143]
    ds_read_b64_tr_b16 v[76:77], v41 offset:4096
    v_mfma_f32_32x32x16_bf16 v[144:159], v[60:63], v[84:87], v[144:159]
    ds_read_b64_tr_b16 v[78:79], v41 offset:5120
    s_waitcnt lgkmcnt(6)
    ds_read_b128 v[56:59], v38 offset:0
    ds_read_b128 v[60:63], v38 offset:4096
    v_mfma_f32_32x32x16_bf16 v[96:111], v[64:67], v[88:91], v[96:111]
    ds_read_b64_tr_b16 v[80:81], v40 offset:8192
    v_mfma_f32_32x32x16_bf16 v[112:127], v[68:71], v[88:91], v[112:127]
    ds_read_b64_tr_b16 v[82:83], v40 offset:9216
    v_mfma_f32_32x32x16_bf16 v[128:143], v[64:67], v[92:95], v[128:143]
    ds_read_b64_tr_b16 v[84:85], v41 offset:8192
    v_mfma_f32_32x32x16_bf16 v[144:159], v[68:71], v[92:95], v[144:159]
    ds_read_b64_tr_b16 v[86:87], v41 offset:9216
    s_waitcnt lgkmcnt(6)
    ds_read_b128 v[64:67], v39 offset:0
    ds_read_b128 v[68:71], v39 offset:4096
    v_mfma_f32_32x32x16_bf16 v[96:111], v[48:51], v[72:75], v[96:111]
    ds_read_b64_tr_b16 v[88:89], v40 offset:12288
    v_mfma_f32_32x32x16_bf16 v[112:127], v[52:55], v[72:75], v[112:127]
    ds_read_b64_tr_b16 v[90:91], v40 offset:13312
    v_mfma_f32_32x32x16_bf16 v[128:143], v[48:51], v[76:79], v[128:143]
    ds_read_b64_tr_b16 v[92:93], v41 offset:12288
    v_mfma_f32_32x32x16_bf16 v[144:159], v[52:55], v[76:79], v[144:159]
    ds_read_b64_tr_b16 v[94:95], v41 offset:13312
    s_waitcnt lgkmcnt(6)
    s_barrier
    v_add_u32 v36, s51, v30
    v_add_u32 v37, s51, v31
    v_add_u32 v38, s51, v32
    v_add_u32 v39, s51, v33
    v_add_u32 v40, s51, v34
    v_add_u32 v41, s51, v35
    s_add_u32 s51, s51, 32768
    s_cmp_eq_u32 s51, 133120
    s_cselect_b32 s51, 2048, s51
    ds_read_b128 v[48:51], v36 offset:0
    ds_read_b128 v[52:55], v36 offset:4096
    v_mfma_f32_32x32x16_bf16 v[96:111], v[56:59], v[80:83], v[96:111]
    ds_read_b64_tr_b16 v[72:73], v40 offset:0
    v_mfma_f32_32x32x16_bf16 v[112:127], v[60:63], v[80:83], v[112:127]
    ds_read_b64_tr_b16 v[74:75], v40 offset:1024
    v_mfma_f32_32x32x16_bf16 v[128:143], v[56:59], v[84:87], v[128:143]
    ds_read_b64_tr_b16 v[76:77], v41 offset:0
    v_mfma_f32_32x32x16_bf16 v[144:159], v[60:63], v[84:87], v[144:159]
    ds_read_b64_tr_b16 v[78:79], v41 offset:1024
    s_waitcnt lgkmcnt(6)
    ds_read_b128 v[56:59], v37 offset:0
    ds_read_b128 v[60:63], v37 offset:4096
    v_mfma_f32_32x32x16_bf16 v[96:111], v[64:67], v[88:91], v[96:111]
    ds_read_b64_tr_b16 v[80:81], v40 offset:4096
    v_mfma_f32_32x32x16_bf16 v[112:127], v[68:71], v[88:91], v[112:127]
    ds_read_b64_tr_b16 v[82:83], v40 offset:5120
    v_mfma_f32_32x32x16_bf16 v[128:143], v[64:67], v[92:95], v[128:143]
    ds_read_b64_tr_b16 v[84:85], v41 offset:4096
    v_mfma_f32_32x32x16_bf16 v[144:159], v[68:71], v[92:95], v[144:159]
    ds_read_b64_tr_b16 v[86:87], v41 offset:5120
    s_waitcnt lgkmcnt(6)
    ds_read_b128 v[64:67], v38 offset:0
    ds_read_b128 v[68:71], v38 offset:4096
    v_mfma_f32_32x32x16_bf16 v[96:111], v[48:51], v[72:75], v[96:111]
    ds_read_b64_tr_b16 v[88:89], v40 offset:8192
    v_mfma_f32_32x32x16_bf16 v[112:127], v[52:55], v[72:75], v[112:127]
    ds_read_b64_tr_b16 v[90:91], v40 offset:9216
    v_mfma_f32_32x32x16_bf16 v[128:143], v[48:51], v[76:79], v[128:143]
    ds_read_b64_tr_b16 v[92:93], v41 offset:8192
    v_mfma_f32_32x32x16_bf16 v[144:159], v[52:55], v[76:79], v[144:159]
    ds_read_b64_tr_b16 v[94:95], v41 offset:9216
    s_waitcnt lgkmcnt(6)
    ds_read_b128 v[48:51], v39 offset:0
    ds_read_b128 v[52:55], v39 offset:4096
    v_mfma_f32_32x32x16_bf16 v[96:111], v[56:59], v[80:83], v[96:111]
    ds_read_b64_tr_b16 v[72:73], v40 offset:12288
    v_mfma_f32_32x32x16_bf16 v[112:127], v[60:63], v[80:83], v[112:127]
    ds_read_b64_tr_b16 v[74:75], v40 offset:13312
    v_mfma_f32_32x32x16_bf16 v[128:143], v[56:59], v[84:87], v[128:143]
    ds_read_b64_tr_b16 v[76:77], v41 offset:12288
    v_mfma_f32_32x32x16_bf16 v[144:159], v[60:63], v[84:87], v[144:159]
    ds_read_b64_tr_b16 v[78:79], v41 offset:13312
    s_waitcnt lgkmcnt(6)
    v_mfma_f32_32x32x16_bf16 v[96:111], v[64:67], v[88:91], v[96:111]
    v_mfma_f32_32x32x16_bf16 v[112:127], v[68:71], v[88:91], v[112:127]
    v_mfma_f32_32x32x16_bf16 v[128:143], v[64:67], v[92:95], v[128:143]
    v_mfma_f32_32x32x16_bf16 v[144:159], v[68:71], v[92:95], v[144:159]
    s_waitcnt lgkmcnt(0)
    v_mfma_f32_32x32x16_bf16 v[96:111], v[48:51], v[72:75], v[96:111]
    v_mfma_f32_32x32x16_bf16 v[112:127], v[52:55], v[72:75], v[112:127]
    v_mfma_f32_32x32x16_bf16 v[128:143], v[48:51], v[76:79], v[128:143]
    v_mfma_f32_32x32x16_bf16 v[144:159], v[52:55], v[76:79], v[144:159]
    s_nop 7
    s_nop 7
    v_lshlrev_b32 v217, 2, v216
    ds_read_b32 v192, v217 offset:1024
    ds_read_b32 v193, v217 offset:1152
    s_lshl_b32 s58, s6, 9
    v_lshlrev_b32 v217, 5, v42
    v_add_u32 v217, s58, v217
    ds_read_b128 v[160:163], v217 offset:0
    ds_read_b128 v[164:167], v217 offset:16
    ds_read_b128 v[168:171], v217 offset:64
    ds_read_b128 v[172:175], v217 offset:80
    ds_read_b128 v[176:179], v217 offset:128
    ds_read_b128 v[180:183], v217 offset:144
    ds_read_b128 v[184:187], v217 offset:192
    ds_read_b128 v[188:191], v217 offset:208
    s_waitcnt lgkmcnt(0)
    v_mul_f32 v196, v96, v161
    v_fmac_f32 v196, v192, v160
    v_mul_f32 v197, v97, v163
    v_fmac_f32 v197, v192, v162
    v_mul_f32 v198, v98, v165
    v_fmac_f32 v198, v192, v164
    v_mul_f32 v199, v99, v167
    v_fmac_f32 v199, v192, v166
    v_mul_f32 v200, v100, v169
    v_fmac_f32 v200, v192, v168
    v_mul_f32 v201, v101, v171
    v_fmac_f32 v201, v192, v170
    v_mul_f32 v202, v102, v173
    v_fmac_f32 v202, v192, v172
    v_mul_f32 v203, v103, v175
    v_fmac_f32 v203, v192, v174
    v_cvt_pk_bf16_f32 v196, v196, v197
    v_cvt_pk_bf16_f32 v197, v198, v199
    v_cvt_pk_bf16_f32 v198, v200, v201
    v_cvt_pk_bf16_f32 v199, v202, v203
    buffer_store_dwordx4 v[196:199], v194, s[24:27], 0 offen offset:0
    s_nop 1
    v_mul_f32 v196, v104, v177
    v_fmac_f32 v196, v192, v176
    v_mul_f32 v197, v105, v179
    v_fmac_f32 v197, v192, v178
    v_mul_f32 v198, v106, v181
    v_fmac_f32 v198, v192, v180
    v_mul_f32 v199, v107, v183
    v_fmac_f32 v199, v192, v182
    v_mul_f32 v200, v108, v185
    v_fmac_f32 v200, v192, v184
    v_mul_f32 v201, v109, v187
    v_fmac_f32 v201, v192, v186
    v_mul_f32 v202, v110, v189
    v_fmac_f32 v202, v192, v188
    v_mul_f32 v203, v111, v191
    v_fmac_f32 v203, v192, v190
    v_cvt_pk_bf16_f32 v196, v196, v197
    v_cvt_pk_bf16_f32 v197, v198, v199
    v_cvt_pk_bf16_f32 v198, v200, v201
    v_cvt_pk_bf16_f32 v199, v202, v203
    buffer_store_dwordx4 v[196:199], v194, s[24:27], 0 offen offset:1024
    s_nop 1
    v_mul_f32 v196, v128, v161
    v_fmac_f32 v196, v193, v160
    v_mul_f32 v197, v129, v163
    v_fmac_f32 v197, v193, v162
    v_mul_f32 v198, v130, v165
    v_fmac_f32 v198, v193, v164
    v_mul_f32 v199, v131, v167
    v_fmac_f32 v199, v193, v166
    v_mul_f32 v200, v132, v169
    v_fmac_f32 v200, v193, v168
    v_mul_f32 v201, v133, v171
    v_fmac_f32 v201, v193, v170
    v_mul_f32 v202, v134, v173
    v_fmac_f32 v202, v193, v172
    v_mul_f32 v203, v135, v175
    v_fmac_f32 v203, v193, v174
    v_cvt_pk_bf16_f32 v196, v196, v197
    v_cvt_pk_bf16_f32 v197, v198, v199
    v_cvt_pk_bf16_f32 v198, v200, v201
    v_cvt_pk_bf16_f32 v199, v202, v203
    buffer_store_dwordx4 v[196:199], v195, s[24:27], 0 offen offset:0
    s_nop 1
    v_mul_f32 v196, v136, v177
    v_fmac_f32 v196, v193, v176
    v_mul_f32 v197, v137, v179
    v_fmac_f32 v197, v193, v178
    v_mul_f32 v198, v138, v181
    v_fmac_f32 v198, v193, v180
    v_mul_f32 v199, v139, v183
    v_fmac_f32 v199, v193, v182
    v_mul_f32 v200, v140, v185
    v_fmac_f32 v200, v193, v184
    v_mul_f32 v201, v141, v187
    v_fmac_f32 v201, v193, v186
    v_mul_f32 v202, v142, v189
    v_fmac_f32 v202, v193, v188
    v_mul_f32 v203, v143, v191
    v_fmac_f32 v203, v193, v190
    v_cvt_pk_bf16_f32 v196, v196, v197
    v_cvt_pk_bf16_f32 v197, v198, v199
    v_cvt_pk_bf16_f32 v198, v200, v201
    v_cvt_pk_bf16_f32 v199, v202, v203
    buffer_store_dwordx4 v[196:199], v195, s[24:27], 0 offen offset:1024
    s_nop 1
    ds_read_b128 v[160:163], v217 offset:256
    ds_read_b128 v[164:167], v217 offset:272
    ds_read_b128 v[168:171], v217 offset:320
    ds_read_b128 v[172:175], v217 offset:336
    ds_read_b128 v[176:179], v217 offset:384
    ds_read_b128 v[180:183], v217 offset:400
    ds_read_b128 v[184:187], v217 offset:448
    ds_read_b128 v[188:191], v217 offset:464
    s_waitcnt lgkmcnt(0)
    v_mul_f32 v196, v112, v161
    v_fmac_f32 v196, v192, v160
    v_mul_f32 v197, v113, v163
    v_fmac_f32 v197, v192, v162
    v_mul_f32 v198, v114, v165
    v_fmac_f32 v198, v192, v164
    v_mul_f32 v199, v115, v167
    v_fmac_f32 v199, v192, v166
    v_mul_f32 v200, v116, v169
    v_fmac_f32 v200, v192, v168
    v_mul_f32 v201, v117, v171
    v_fmac_f32 v201, v192, v170
    v_mul_f32 v202, v118, v173
    v_fmac_f32 v202, v192, v172
    v_mul_f32 v203, v119, v175
    v_fmac_f32 v203, v192, v174
    v_cvt_pk_bf16_f32 v196, v196, v197
    v_cvt_pk_bf16_f32 v197, v198, v199
    v_cvt_pk_bf16_f32 v198, v200, v201
    v_cvt_pk_bf16_f32 v199, v202, v203
    buffer_store_dwordx4 v[196:199], v194, s[24:27], 0 offen offset:2048
    s_nop 1
    v_mul_f32 v196, v120, v177
    v_fmac_f32 v196, v192, v176
    v_mul_f32 v197, v121, v179
    v_fmac_f32 v197, v192, v178
    v_mul_f32 v198, v122, v181
    v_fmac_f32 v198, v192, v180
    v_mul_f32 v199, v123, v183
    v_fmac_f32 v199, v192, v182
    v_mul_f32 v200, v124, v185
    v_fmac_f32 v200, v192, v184
    v_mul_f32 v201, v125, v187
    v_fmac_f32 v201, v192, v186
    v_mul_f32 v202, v126, v189
    v_fmac_f32 v202, v192, v188
    v_mul_f32 v203, v127, v191
    v_fmac_f32 v203, v192, v190
    v_cvt_pk_bf16_f32 v196, v196, v197
    v_cvt_pk_bf16_f32 v197, v198, v199
    v_cvt_pk_bf16_f32 v198, v200, v201
    v_cvt_pk_bf16_f32 v199, v202, v203
    buffer_store_dwordx4 v[196:199], v194, s[24:27], 0 offen offset:3072
    s_nop 1
    v_mul_f32 v196, v144, v161
    v_fmac_f32 v196, v193, v160
    v_mul_f32 v197, v145, v163
    v_fmac_f32 v197, v193, v162
    v_mul_f32 v198, v146, v165
    v_fmac_f32 v198, v193, v164
    v_mul_f32 v199, v147, v167
    v_fmac_f32 v199, v193, v166
    v_mul_f32 v200, v148, v169
    v_fmac_f32 v200, v193, v168
    v_mul_f32 v201, v149, v171
    v_fmac_f32 v201, v193, v170
    v_mul_f32 v202, v150, v173
    v_fmac_f32 v202, v193, v172
    v_mul_f32 v203, v151, v175
    v_fmac_f32 v203, v193, v174
    v_cvt_pk_bf16_f32 v196, v196, v197
    v_cvt_pk_bf16_f32 v197, v198, v199
    v_cvt_pk_bf16_f32 v198, v200, v201
    v_cvt_pk_bf16_f32 v199, v202, v203
    buffer_store_dwordx4 v[196:199], v195, s[24:27], 0 offen offset:2048
    s_nop 1
    v_mul_f32 v196, v152, v177
    v_fmac_f32 v196, v193, v176
    v_mul_f32 v197, v153, v179
    v_fmac_f32 v197, v193, v178
    v_mul_f32 v198, v154, v181
    v_fmac_f32 v198, v193, v180
    v_mul_f32 v199, v155, v183
    v_fmac_f32 v199, v193, v182
    v_mul_f32 v200, v156, v185
    v_fmac_f32 v200, v193, v184
    v_mul_f32 v201, v157, v187
    v_fmac_f32 v201, v193, v186
    v_mul_f32 v202, v158, v189
    v_fmac_f32 v202, v193, v188
    v_mul_f32 v203, v159, v191
    v_fmac_f32 v203, v193, v190
    v_cvt_pk_bf16_f32 v196, v196, v197
    v_cvt_pk_bf16_f32 v197, v198, v199
    v_cvt_pk_bf16_f32 v198, v200, v201
    v_cvt_pk_bf16_f32 v199, v202, v203
    buffer_store_dwordx4 v[196:199], v195, s[24:27], 0 offen offset:3072
    s_nop 1
qkvdone_qkv0_kernel_5:
end_qkv0_kernel_1:
    s_endpgm
.globl oproj0_kernel
.p2align 8
.type oproj0_kernel,@function
oproj0_kernel:
    s_cmp_ge_u32 s2, 256
    s_cbranch_scc1 end_oproj0_kernel_1
    s_load_dwordx16 s[64:79], s[0:1], 0
    s_load_dwordx4 s[80:83], s[0:1], 64
    s_and_b32 s3, s2, 31
    s_lshr_b32 s4, s2, 5
    v_and_b32 v1, 63, v0
    v_lshrrev_b32 v2, 6, v0
    s_nop 0
    v_readfirstlane_b32 s5, v2
    s_lshl_b32 s56, s3, 6
    s_mul_i32 s57, s4, 80
    s_min_u32 s58, s5, 0
    s_mul_i32 s59, s5, 5
    s_add_u32 s59, s59, s58
    s_cmp_lt_u32 s5, 0
    s_cselect_b32 s55, 6, 5
    v_lshlrev_b32 v5, 4, v1
    s_mul_i32 s48, s3, 20
    s_add_u32 s48, s48, s59
    s_lshl_b32 s48, s48, 12
    s_mul_i32 s49, s4, 640
    s_lshl_b32 s58, s59, 5
    s_add_u32 s49, s49, s58
    s_mul_i32 s49, s49, 160
    s_mul_i32 s52, s5, 36864
    s_add_u32 s53, s52, 36864
    s_mov_b32 s50, s52
    s_mov_b32 s51, s52
    s_waitcnt lgkmcnt(0)
    s_add_u32 s8, s82, 0xd00000
    s_addc_u32 s9, s83, 0
    s_and_b32 s9, s9, 0xffff
    s_mov_b32 s10, 0x280000
    s_mov_b32 s11, 0x20000
    s_add_u32 s12, s82, 0x2000000
    s_addc_u32 s13, s83, 0
    s_and_b32 s13, s13, 0xffff
    s_mov_b32 s14, 0xc8000
    s_mov_b32 s15, 0x20000
    s_mov_b32 m0, s50
    s_nop 0
    buffer_load_dwordx4 v5, s[8:11], s48 offen lds
    buffer_load_dwordx4 v5, s[8:11], s48 offen offset:1024 lds
    buffer_load_dwordx4 v5, s[8:11], s48 offen offset:2048 lds
    buffer_load_dwordx4 v5, s[8:11], s48 offen offset:3072 lds
    s_add_u32 m0, s50, 4096
    s_nop 0
    buffer_load_dwordx4 v5, s[12:15], s49 offen lds
    buffer_load_dwordx4 v5, s[12:15], s49 offen offset:1024 lds
    buffer_load_dwordx4 v5, s[12:15], s49 offen offset:2048 lds
    buffer_load_dwordx4 v5, s[12:15], s49 offen offset:3072 lds
    s_add_u32 m0, s50, 8192
    s_add_u32 s54, s49, 4096
    buffer_load_dwordx4 v5, s[12:15], s54 offen lds
    s_add_u32 s48, s48, 4096
    s_add_u32 s49, s49, 5120
    s_add_u32 s50, s50, 9216
    s_cmp_eq_u32 s50, s53
    s_cselect_b32 s50, s52, s50
    s_mov_b32 m0, s50
    s_nop 0
    buffer_load_dwordx4 v5, s[8:11], s48 offen lds
    buffer_load_dwordx4 v5, s[8:11], s48 offen offset:1024 lds
    buffer_load_dwordx4 v5, s[8:11], s48 offen offset:2048 lds
    buffer_load_dwordx4 v5, s[8:11], s48 offen offset:3072 lds
    s_add_u32 m0, s50, 4096
    s_nop 0
    buffer_load_dwordx4 v5, s[12:15], s49 offen lds
    buffer_load_dwordx4 v5, s[12:15], s49 offen offset:1024 lds
    buffer_load_dwordx4 v5, s[12:15], s49 offen offset:2048 lds
    buffer_load_dwordx4 v5, s[12:15], s49 offen offset:3072 lds
    s_add_u32 m0, s50, 8192
    s_add_u32 s54, s49, 4096
    buffer_load_dwordx4 v5, s[12:15], s54 offen lds
    s_add_u32 s48, s48, 4096
    s_add_u32 s49, s49, 5120
    s_add_u32 s50, s50, 9216
    s_cmp_eq_u32 s50, s53
    s_cselect_b32 s50, s52, s50
    s_mov_b32 m0, s50
    s_nop 0
    buffer_load_dwordx4 v5, s[8:11], s48 offen lds
    buffer_load_dwordx4 v5, s[8:11], s48 offen offset:1024 lds
    buffer_load_dwordx4 v5, s[8:11], s48 offen offset:2048 lds
    buffer_load_dwordx4 v5, s[8:11], s48 offen offset:3072 lds
    s_add_u32 m0, s50, 4096
    s_nop 0
    buffer_load_dwordx4 v5, s[12:15], s49 offen lds
    buffer_load_dwordx4 v5, s[12:15], s49 offen offset:1024 lds
    buffer_load_dwordx4 v5, s[12:15], s49 offen offset:2048 lds
    buffer_load_dwordx4 v5, s[12:15], s49 offen offset:3072 lds
    s_add_u32 m0, s50, 8192
    s_add_u32 s54, s49, 4096
    buffer_load_dwordx4 v5, s[12:15], s54 offen lds
    s_add_u32 s48, s48, 4096
    s_add_u32 s49, s49, 5120
    s_add_u32 s50, s50, 9216
    s_cmp_eq_u32 s50, s53
    s_cselect_b32 s50, s52, s50
    s_mov_b32 m0, s50
    s_nop 0
    buffer_load_dwordx4 v5, s[8:11], s48 offen lds
    buffer_load_dwordx4 v5, s[8:11], s48 offen offset:1024 lds
    buffer_load_dwordx4 v5, s[8:11], s48 offen offset:2048 lds
    buffer_load_dwordx4 v5, s[8:11], s48 offen offset:3072 lds
    s_add_u32 m0, s50, 4096
    s_nop 0
    buffer_load_dwordx4 v5, s[12:15], s49 offen lds
    buffer_load_dwordx4 v5, s[12:15], s49 offen offset:1024 lds
    buffer_load_dwordx4 v5, s[12:15], s49 offen offset:2048 lds
    buffer_load_dwordx4 v5, s[12:15], s49 offen offset:3072 lds
    s_add_u32 m0, s50, 8192
    s_add_u32 s54, s49, 4096
    buffer_load_dwordx4 v5, s[12:15], s54 offen lds
    s_add_u32 s48, s48, 4096
    s_add_u32 s49, s49, 5120
    s_add_u32 s50, s50, 9216
    s_cmp_eq_u32 s50, s53
    s_cselect_b32 s50, s52, s50
    s_add_u32 s24, s82, 0x1000000
    s_addc_u32 s25, s83, 0
    s_and_b32 s25, s25, 0xffff
    s_mov_b32 s26, 0x280000
    s_mov_b32 s27, 0x20000
    s_mov_b32 s28, s64
    s_and_b32 s29, s65, 0xffff
    s_mov_b32 s30, 0x280000
    s_mov_b32 s31, 0x20000
    s_mov_b32 s20, s82
    s_and_b32 s21, s83, 0xffff
    s_mov_b32 s22, 0x100000
    s_mov_b32 s23, 0x20000
    v_lshrrev_b32 v7, 4, v1
    s_lshl_b32 s58, s5, 4
    s_add_u32 s58, s58, s56
    v_and_b32 v20, 15, v1
    v_add_u32 v20, s58, v20
    v_mul_u32_u24 v20, 1280, v20
    v_lshl_add_u32 v20, v7, 4, v20
    s_lshl_b32 s58, s57, 1
    v_add_u32 v20, s58, v20
    v_lshlrev_b32 v21, 3, v7
    v_sub_u32 v21, v20, v21
    buffer_load_dwordx4 v[8:11], v20, s[28:31], 0 offen
    buffer_load_dwordx4 v[12:15], v20, s[28:31], 0 offen offset:64
    buffer_load_dwordx2 v[16:17], v21, s[28:31], 0 offen offset:128
    v_and_b32 v3, 15, v1
    v_lshrrev_b32 v4, 2, v3
    v_sub_u32 v4, 0, v4
    v_xor_b32 v4, v4, v7
    v_and_b32 v4, 3, v4
    v_lshlrev_b32 v22, 6, v3
    v_lshl_add_u32 v22, v4, 4, v22
    v_bfe_u32 v30, v1, 2, 2
    v_lshl_add_u32 v3, v7, 3, v30
    v_mul_u32_u24 v3, 160, v3
    v_and_b32 v4, 3, v1
    v_lshl_add_u32 v3, v4, 4, v3
    v_add_u32 v23, 4096, v3
    v_lshl_add_u32 v3, v7, 3, v30
    v_mul_u32_u24 v3, 160, v3
    v_and_b32 v4, 3, v1
    v_lshl_add_u32 v3, v4, 4, v3
    v_add_u32 v24, 4160, v3
    v_lshl_add_u32 v3, v7, 3, v30
    v_mul_u32_u24 v3, 160, v3
    v_and_b32 v4, 3, v1
    v_lshl_add_u32 v3, v4, 3, v3
    v_add_u32 v25, 4224, v3
    v_mov_b32 v104, 0
    v_mov_b32 v105, 0
    v_mov_b32 v106, 0
    v_mov_b32 v107, 0
    v_mov_b32 v108, 0
    v_mov_b32 v109, 0
    v_mov_b32 v110, 0
    v_mov_b32 v111, 0
    v_mov_b32 v112, 0
    v_mov_b32 v113, 0
    v_mov_b32 v114, 0
    v_mov_b32 v115, 0
    v_mov_b32 v116, 0
    v_mov_b32 v117, 0
    v_mov_b32 v118, 0
    v_mov_b32 v119, 0
    v_mov_b32 v120, 0
    v_mov_b32 v121, 0
    v_mov_b32 v122, 0
    v_mov_b32 v123, 0
    v_mov_b32 v124, 0
    v_mov_b32 v125, 0
    v_mov_b32 v126, 0
    v_mov_b32 v127, 0
    v_mov_b32 v128, 0
    v_mov_b32 v129, 0
    v_mov_b32 v130, 0
    v_mov_b32 v131, 0
    v_mov_b32 v132, 0
    v_mov_b32 v133, 0
    v_mov_b32 v134, 0
    v_mov_b32 v135, 0
    v_mov_b32 v136, 0
    v_mov_b32 v137, 0
    v_mov_b32 v138, 0
    v_mov_b32 v139, 0
    v_mov_b32 v140, 0
    v_mov_b32 v141, 0
    v_mov_b32 v142, 0
    v_mov_b32 v143, 0
    v_mov_b32 v144, 0
    v_mov_b32 v145, 0
    v_mov_b32 v146, 0
    v_mov_b32 v147, 0
    v_mov_b32 v148, 0
    v_mov_b32 v149, 0
    v_mov_b32 v150, 0
    v_mov_b32 v151, 0
    v_mov_b32 v152, 0
    v_mov_b32 v153, 0
    v_mov_b32 v154, 0
    v_mov_b32 v155, 0
    v_mov_b32 v156, 0
    v_mov_b32 v157, 0
    v_mov_b32 v158, 0
    v_mov_b32 v159, 0
    v_mov_b32 v160, 0
    v_mov_b32 v161, 0
    v_mov_b32 v162, 0
    v_mov_b32 v163, 0
    v_mov_b32 v164, 0
    v_mov_b32 v165, 0
    v_mov_b32 v166, 0
    v_mov_b32 v167, 0
    v_mov_b32 v168, 0
    v_mov_b32 v169, 0
    v_mov_b32 v170, 0
    v_mov_b32 v171, 0
    v_mov_b32 v172, 0
    v_mov_b32 v173, 0
    v_mov_b32 v174, 0
    v_mov_b32 v175, 0
    v_mov_b32 v176, 0
    v_mov_b32 v177, 0
    v_mov_b32 v178, 0
    v_mov_b32 v179, 0
    v_mov_b32 v180, 0
    v_mov_b32 v181, 0
    v_mov_b32 v182, 0
    v_mov_b32 v183, 0
    s_waitcnt vmcnt(30)
    v_add_u32 v26, s51, v22
    v_add_u32 v27, s51, v23
    v_add_u32 v28, s51, v24
    v_add_u32 v29, s51, v25
    s_add_u32 s51, s51, 9216
    s_cmp_eq_u32 s51, s53
    s_cselect_b32 s51, s52, s51
    ds_read_b128 v[32:35], v26 offset:0
    ds_read_b128 v[36:39], v26 offset:1024
    ds_read_b128 v[40:43], v26 offset:2048
    ds_read_b128 v[44:47], v26 offset:3072
    ds_read_b64_tr_b16 v[64:65], v27 offset:0
    ds_read_b64_tr_b16 v[66:67], v27 offset:640
    ds_read_b64_tr_b16 v[68:69], v27 offset:8
    ds_read_b64_tr_b16 v[70:71], v27 offset:648
    ds_read_b64_tr_b16 v[72:73], v28 offset:0
    ds_read_b64_tr_b16 v[74:75], v28 offset:640
    ds_read_b64_tr_b16 v[76:77], v28 offset:8
    ds_read_b64_tr_b16 v[78:79], v28 offset:648
    ds_read_b64_tr_b16 v[80:81], v29 offset:0
    ds_read_b64_tr_b16 v[82:83], v29 offset:640
    s_waitcnt lgkmcnt(0)
loop_oproj0_kernel_2:
    s_cmp_le_u32 s55, 4
    s_cbranch_scc1 tail_oproj0_kernel_5
    s_waitcnt vmcnt(18)
    v_add_u32 v26, s51, v22
    v_add_u32 v27, s51, v23
    v_add_u32 v28, s51, v24
    v_add_u32 v29, s51, v25
    s_add_u32 s51, s51, 9216
    s_cmp_eq_u32 s51, s53
    s_cselect_b32 s51, s52, s51
    ds_read_b128 v[48:51], v26 offset:0
    ds_read_b128 v[52:55], v26 offset:1024
    v_mfma_f32_16x16x32_bf16 v[104:107], v[64:67], v[32:35], v[104:107]
    ds_read_b128 v[56:59], v26 offset:2048
    v_mfma_f32_16x16x32_bf16 v[124:127], v[64:67], v[36:39], v[124:127]
    ds_read_b128 v[60:63], v26 offset:3072
    v_mfma_f32_16x16x32_bf16 v[144:147], v[64:67], v[40:43], v[144:147]
    ds_read_b64_tr_b16 v[84:85], v27 offset:0
    v_mfma_f32_16x16x32_bf16 v[164:167], v[64:67], v[44:47], v[164:167]
    ds_read_b64_tr_b16 v[86:87], v27 offset:640
    v_mfma_f32_16x16x32_bf16 v[108:111], v[68:71], v[32:35], v[108:111]
    ds_read_b64_tr_b16 v[88:89], v27 offset:8
    ds_read_b64_tr_b16 v[90:91], v27 offset:648
    v_mfma_f32_16x16x32_bf16 v[128:131], v[68:71], v[36:39], v[128:131]
    ds_read_b64_tr_b16 v[92:93], v28 offset:0
    v_mfma_f32_16x16x32_bf16 v[148:151], v[68:71], v[40:43], v[148:151]
    ds_read_b64_tr_b16 v[94:95], v28 offset:640
    v_mfma_f32_16x16x32_bf16 v[168:171], v[68:71], v[44:47], v[168:171]
    ds_read_b64_tr_b16 v[96:97], v28 offset:8
    v_mfma_f32_16x16x32_bf16 v[112:115], v[72:75], v[32:35], v[112:115]
    ds_read_b64_tr_b16 v[98:99], v28 offset:648
    v_mfma_f32_16x16x32_bf16 v[132:135], v[72:75], v[36:39], v[132:135]
    ds_read_b64_tr_b16 v[100:101], v29 offset:0
    ds_read_b64_tr_b16 v[102:103], v29 offset:640
    v_mfma_f32_16x16x32_bf16 v[152:155], v[72:75], v[40:43], v[152:155]
    s_mov_b32 m0, s50
    s_nop 0
    buffer_load_dwordx4 v5, s[8:11], s48 offen lds
    v_mfma_f32_16x16x32_bf16 v[172:175], v[72:75], v[44:47], v[172:175]
    buffer_load_dwordx4 v5, s[8:11], s48 offen offset:1024 lds
    v_mfma_f32_16x16x32_bf16 v[116:119], v[76:79], v[32:35], v[116:119]
    buffer_load_dwordx4 v5, s[8:11], s48 offen offset:2048 lds
    v_mfma_f32_16x16x32_bf16 v[136:139], v[76:79], v[36:39], v[136:139]
    buffer_load_dwordx4 v5, s[8:11], s48 offen offset:3072 lds
    v_mfma_f32_16x16x32_bf16 v[156:159], v[76:79], v[40:43], v[156:159]
    s_add_u32 m0, s50, 4096
    s_nop 0
    buffer_load_dwordx4 v5, s[12:15], s49 offen lds
    buffer_load_dwordx4 v5, s[12:15], s49 offen offset:1024 lds
    v_mfma_f32_16x16x32_bf16 v[176:179], v[76:79], v[44:47], v[176:179]
    buffer_load_dwordx4 v5, s[12:15], s49 offen offset:2048 lds
    v_mfma_f32_16x16x32_bf16 v[120:123], v[80:83], v[32:35], v[120:123]
    buffer_load_dwordx4 v5, s[12:15], s49 offen offset:3072 lds
    v_mfma_f32_16x16x32_bf16 v[140:143], v[80:83], v[36:39], v[140:143]
    s_add_u32 m0, s50, 8192
    s_add_u32 s54, s49, 4096
    buffer_load_dwordx4 v5, s[12:15], s54 offen lds
    v_mfma_f32_16x16x32_bf16 v[160:163], v[80:83], v[40:43], v[160:163]
    s_add_u32 s48, s48, 4096
    s_add_u32 s49, s49, 5120
    s_add_u32 s50, s50, 9216
    s_cmp_eq_u32 s50, s53
    s_cselect_b32 s50, s52, s50
    v_mfma_f32_16x16x32_bf16 v[180:183], v[80:83], v[44:47], v[180:183]
    s_nop 0
    s_nop 0
    s_branch join_oproj0_kernel_6
tail_oproj0_kernel_5:
    s_waitcnt vmcnt(0)
    v_add_u32 v26, s51, v22
    v_add_u32 v27, s51, v23
    v_add_u32 v28, s51, v24
    v_add_u32 v29, s51, v25
    s_add_u32 s51, s51, 9216
    s_cmp_eq_u32 s51, s53
    s_cselect_b32 s51, s52, s51
    ds_read_b128 v[48:51], v26 offset:0
    ds_read_b128 v[52:55], v26 offset:1024
    v_mfma_f32_16x16x32_bf16 v[104:107], v[64:67], v[32:35], v[104:107]
    v_mfma_f32_16x16x32_bf16 v[124:127], v[64:67], v[36:39], v[124:127]
    ds_read_b128 v[56:59], v26 offset:2048
    v_mfma_f32_16x16x32_bf16 v[144:147], v[64:67], v[40:43], v[144:147]
    v_mfma_f32_16x16x32_bf16 v[164:167], v[64:67], v[44:47], v[164:167]
    ds_read_b128 v[60:63], v26 offset:3072
    v_mfma_f32_16x16x32_bf16 v[108:111], v[68:71], v[32:35], v[108:111]
    ds_read_b64_tr_b16 v[84:85], v27 offset:0
    v_mfma_f32_16x16x32_bf16 v[128:131], v[68:71], v[36:39], v[128:131]
    v_mfma_f32_16x16x32_bf16 v[148:151], v[68:71], v[40:43], v[148:151]
    ds_read_b64_tr_b16 v[86:87], v27 offset:640
    v_mfma_f32_16x16x32_bf16 v[168:171], v[68:71], v[44:47], v[168:171]
    v_mfma_f32_16x16x32_bf16 v[112:115], v[72:75], v[32:35], v[112:115]
    ds_read_b64_tr_b16 v[88:89], v27 offset:8
    v_mfma_f32_16x16x32_bf16 v[132:135], v[72:75], v[36:39], v[132:135]
    ds_read_b64_tr_b16 v[90:91], v27 offset:648
    v_mfma_f32_16x16x32_bf16 v[152:155], v[72:75], v[40:43], v[152:155]
    v_mfma_f32_16x16x32_bf16 v[172:175], v[72:75], v[44:47], v[172:175]
    ds_read_b64_tr_b16 v[92:93], v28 offset:0
    v_mfma_f32_16x16x32_bf16 v[116:119], v[76:79], v[32:35], v[116:119]
    v_mfma_f32_16x16x32_bf16 v[136:139], v[76:79], v[36:39], v[136:139]
    ds_read_b64_tr_b16 v[94:95], v28 offset:640
    v_mfma_f32_16x16x32_bf16 v[156:159], v[76:79], v[40:43], v[156:159]
    ds_read_b64_tr_b16 v[96:97], v28 offset:8
    v_mfma_f32_16x16x32_bf16 v[176:179], v[76:79], v[44:47], v[176:179]
    v_mfma_f32_16x16x32_bf16 v[120:123], v[80:83], v[32:35], v[120:123]
    ds_read_b64_tr_b16 v[98:99], v28 offset:648
    v_mfma_f32_16x16x32_bf16 v[140:143], v[80:83], v[36:39], v[140:143]
    v_mfma_f32_16x16x32_bf16 v[160:163], v[80:83], v[40:43], v[160:163]
    ds_read_b64_tr_b16 v[100:101], v29 offset:0
    v_mfma_f32_16x16x32_bf16 v[180:183], v[80:83], v[44:47], v[180:183]
    ds_read_b64_tr_b16 v[102:103], v29 offset:640
join_oproj0_kernel_6:
    s_waitcnt lgkmcnt(0)
    s_sub_u32 s55, s55, 1
    s_cmp_eq_u32 s55, 1
    s_cbranch_scc1 lastB_oproj0_kernel_3
    s_cmp_le_u32 s55, 4
    s_cbranch_scc1 tail_oproj0_kernel_7
    s_waitcnt vmcnt(18)
    v_add_u32 v26, s51, v22
    v_add_u32 v27, s51, v23
    v_add_u32 v28, s51, v24
    v_add_u32 v29, s51, v25
    s_add_u32 s51, s51, 9216
    s_cmp_eq_u32 s51, s53
    s_cselect_b32 s51, s52, s51
    ds_read_b128 v[32:35], v26 offset:0
    ds_read_b128 v[36:39], v26 offset:1024
    v_mfma_f32_16x16x32_bf16 v[104:107], v[84:87], v[48:51], v[104:107]
    ds_read_b128 v[40:43], v26 offset:2048
    v_mfma_f32_16x16x32_bf16 v[124:127], v[84:87], v[52:55], v[124:127]
    ds_read_b128 v[44:47], v26 offset:3072
    v_mfma_f32_16x16x32_bf16 v[144:147], v[84:87], v[56:59], v[144:147]
    ds_read_b64_tr_b16 v[64:65], v27 offset:0
    v_mfma_f32_16x16x32_bf16 v[164:167], v[84:87], v[60:63], v[164:167]
    ds_read_b64_tr_b16 v[66:67], v27 offset:640
    v_mfma_f32_16x16x32_bf16 v[108:111], v[88:91], v[48:51], v[108:111]
    ds_read_b64_tr_b16 v[68:69], v27 offset:8
    ds_read_b64_tr_b16 v[70:71], v27 offset:648
    v_mfma_f32_16x16x32_bf16 v[128:131], v[88:91], v[52:55], v[128:131]
    ds_read_b64_tr_b16 v[72:73], v28 offset:0
    v_mfma_f32_16x16x32_bf16 v[148:151], v[88:91], v[56:59], v[148:151]
    ds_read_b64_tr_b16 v[74:75], v28 offset:640
    v_mfma_f32_16x16x32_bf16 v[168:171], v[88:91], v[60:63], v[168:171]
    ds_read_b64_tr_b16 v[76:77], v28 offset:8
    v_mfma_f32_16x16x32_bf16 v[112:115], v[92:95], v[48:51], v[112:115]
    ds_read_b64_tr_b16 v[78:79], v28 offset:648
    v_mfma_f32_16x16x32_bf16 v[132:135], v[92:95], v[52:55], v[132:135]
    ds_read_b64_tr_b16 v[80:81], v29 offset:0
    ds_read_b64_tr_b16 v[82:83], v29 offset:640
    v_mfma_f32_16x16x32_bf16 v[152:155], v[92:95], v[56:59], v[152:155]
    s_mov_b32 m0, s50
    s_nop 0
    buffer_load_dwordx4 v5, s[8:11], s48 offen lds
    v_mfma_f32_16x16x32_bf16 v[172:175], v[92:95], v[60:63], v[172:175]
    buffer_load_dwordx4 v5, s[8:11], s48 offen offset:1024 lds
    v_mfma_f32_16x16x32_bf16 v[116:119], v[96:99], v[48:51], v[116:119]
    buffer_load_dwordx4 v5, s[8:11], s48 offen offset:2048 lds
    v_mfma_f32_16x16x32_bf16 v[136:139], v[96:99], v[52:55], v[136:139]
    buffer_load_dwordx4 v5, s[8:11], s48 offen offset:3072 lds
    v_mfma_f32_16x16x32_bf16 v[156:159], v[96:99], v[56:59], v[156:159]
    s_add_u32 m0, s50, 4096
    s_nop 0
    buffer_load_dwordx4 v5, s[12:15], s49 offen lds
    buffer_load_dwordx4 v5, s[12:15], s49 offen offset:1024 lds
    v_mfma_f32_16x16x32_bf16 v[176:179], v[96:99], v[60:63], v[176:179]
    buffer_load_dwordx4 v5, s[12:15], s49 offen offset:2048 lds
    v_mfma_f32_16x16x32_bf16 v[120:123], v[100:103], v[48:51], v[120:123]
    buffer_load_dwordx4 v5, s[12:15], s49 offen offset:3072 lds
    v_mfma_f32_16x16x32_bf16 v[140:143], v[100:103], v[52:55], v[140:143]
    s_add_u32 m0, s50, 8192
    s_add_u32 s54, s49, 4096
    buffer_load_dwordx4 v5, s[12:15], s54 offen lds
    v_mfma_f32_16x16x32_bf16 v[160:163], v[100:103], v[56:59], v[160:163]
    s_add_u32 s48, s48, 4096
    s_add_u32 s49, s49, 5120
    s_add_u32 s50, s50, 9216
    s_cmp_eq_u32 s50, s53
    s_cselect_b32 s50, s52, s50
    v_mfma_f32_16x16x32_bf16 v[180:183], v[100:103], v[60:63], v[180:183]
    s_nop 0
    s_nop 0
    s_branch join_oproj0_kernel_8
tail_oproj0_kernel_7:
    s_waitcnt vmcnt(0)
    v_add_u32 v26, s51, v22
    v_add_u32 v27, s51, v23
    v_add_u32 v28, s51, v24
    v_add_u32 v29, s51, v25
    s_add_u32 s51, s51, 9216
    s_cmp_eq_u32 s51, s53
    s_cselect_b32 s51, s52, s51
    ds_read_b128 v[32:35], v26 offset:0
    ds_read_b128 v[36:39], v26 offset:1024
    v_mfma_f32_16x16x32_bf16 v[104:107], v[84:87], v[48:51], v[104:107]
    v_mfma_f32_16x16x32_bf16 v[124:127], v[84:87], v[52:55], v[124:127]
    ds_read_b128 v[40:43], v26 offset:2048
    v_mfma_f32_16x16x32_bf16 v[144:147], v[84:87], v[56:59], v[144:147]
    v_mfma_f32_16x16x32_bf16 v[164:167], v[84:87], v[60:63], v[164:167]
    ds_read_b128 v[44:47], v26 offset:3072
    v_mfma_f32_16x16x32_bf16 v[108:111], v[88:91], v[48:51], v[108:111]
    ds_read_b64_tr_b16 v[64:65], v27 offset:0
    v_mfma_f32_16x16x32_bf16 v[128:131], v[88:91], v[52:55], v[128:131]
    v_mfma_f32_16x16x32_bf16 v[148:151], v[88:91], v[56:59], v[148:151]
    ds_read_b64_tr_b16 v[66:67], v27 offset:640
    v_mfma_f32_16x16x32_bf16 v[168:171], v[88:91], v[60:63], v[168:171]
    v_mfma_f32_16x16x32_bf16 v[112:115], v[92:95], v[48:51], v[112:115]
    ds_read_b64_tr_b16 v[68:69], v27 offset:8
    v_mfma_f32_16x16x32_bf16 v[132:135], v[92:95], v[52:55], v[132:135]
    ds_read_b64_tr_b16 v[70:71], v27 offset:648
    v_mfma_f32_16x16x32_bf16 v[152:155], v[92:95], v[56:59], v[152:155]
    v_mfma_f32_16x16x32_bf16 v[172:175], v[92:95], v[60:63], v[172:175]
    ds_read_b64_tr_b16 v[72:73], v28 offset:0
    v_mfma_f32_16x16x32_bf16 v[116:119], v[96:99], v[48:51], v[116:119]
    v_mfma_f32_16x16x32_bf16 v[136:139], v[96:99], v[52:55], v[136:139]
    ds_read_b64_tr_b16 v[74:75], v28 offset:640
    v_mfma_f32_16x16x32_bf16 v[156:159], v[96:99], v[56:59], v[156:159]
    ds_read_b64_tr_b16 v[76:77], v28 offset:8
    v_mfma_f32_16x16x32_bf16 v[176:179], v[96:99], v[60:63], v[176:179]
    v_mfma_f32_16x16x32_bf16 v[120:123], v[100:103], v[48:51], v[120:123]
    ds_read_b64_tr_b16 v[78:79], v28 offset:648
    v_mfma_f32_16x16x32_bf16 v[140:143], v[100:103], v[52:55], v[140:143]
    v_mfma_f32_16x16x32_bf16 v[160:163], v[100:103], v[56:59], v[160:163]
    ds_read_b64_tr_b16 v[80:81], v29 offset:0
    v_mfma_f32_16x16x32_bf16 v[180:183], v[100:103], v[60:63], v[180:183]
    ds_read_b64_tr_b16 v[82:83], v29 offset:640
join_oproj0_kernel_8:
    s_waitcnt lgkmcnt(0)
    s_sub_u32 s55, s55, 1
    s_cmp_eq_u32 s55, 1
    s_cbranch_scc0 loop_oproj0_kernel_2
    v_mfma_f32_16x16x32_bf16 v[104:107], v[64:67], v[32:35], v[104:107]
    v_mfma_f32_16x16x32_bf16 v[124:127], v[64:67], v[36:39], v[124:127]
    v_mfma_f32_16x16x32_bf16 v[144:147], v[64:67], v[40:43], v[144:147]
    v_mfma_f32_16x16x32_bf16 v[164:167], v[64:67], v[44:47], v[164:167]
    v_mfma_f32_16x16x32_bf16 v[108:111], v[68:71], v[32:35], v[108:111]
    v_mfma_f32_16x16x32_bf16 v[128:131], v[68:71], v[36:39], v[128:131]
    v_mfma_f32_16x16x32_bf16 v[148:151], v[68:71], v[40:43], v[148:151]
    v_mfma_f32_16x16x32_bf16 v[168:171], v[68:71], v[44:47], v[168:171]
    v_mfma_f32_16x16x32_bf16 v[112:115], v[72:75], v[32:35], v[112:115]
    v_mfma_f32_16x16x32_bf16 v[132:135], v[72:75], v[36:39], v[132:135]
    v_mfma_f32_16x16x32_bf16 v[152:155], v[72:75], v[40:43], v[152:155]
    v_mfma_f32_16x16x32_bf16 v[172:175], v[72:75], v[44:47], v[172:175]
    v_mfma_f32_16x16x32_bf16 v[116:119], v[76:79], v[32:35], v[116:119]
    v_mfma_f32_16x16x32_bf16 v[136:139], v[76:79], v[36:39], v[136:139]
    v_mfma_f32_16x16x32_bf16 v[156:159], v[76:79], v[40:43], v[156:159]
    v_mfma_f32_16x16x32_bf16 v[176:179], v[76:79], v[44:47], v[176:179]
    v_mfma_f32_16x16x32_bf16 v[120:123], v[80:83], v[32:35], v[120:123]
    v_mfma_f32_16x16x32_bf16 v[140:143], v[80:83], v[36:39], v[140:143]
    v_mfma_f32_16x16x32_bf16 v[160:163], v[80:83], v[40:43], v[160:163]
    v_mfma_f32_16x16x32_bf16 v[180:183], v[80:83], v[44:47], v[180:183]
    s_branch done_oproj0_kernel_4
lastB_oproj0_kernel_3:
    v_mfma_f32_16x16x32_bf16 v[104:107], v[84:87], v[48:51], v[104:107]
    v_mfma_f32_16x16x32_bf16 v[124:127], v[84:87], v[52:55], v[124:127]
    v_mfma_f32_16x16x32_bf16 v[144:147], v[84:87], v[56:59], v[144:147]
    v_mfma_f32_16x16x32_bf16 v[164:167], v[84:87], v[60:63], v[164:167]
    v_mfma_f32_16x16x32_bf16 v[108:111], v[88:91], v[48:51], v[108:111]
    v_mfma_f32_16x16x32_bf16 v[128:131], v[88:91], v[52:55], v[128:131]
    v_mfma_f32_16x16x32_bf16 v[148:151], v[88:91], v[56:59], v[148:151]
    v_mfma_f32_16x16x32_bf16 v[168:171], v[88:91], v[60:63], v[168:171]
    v_mfma_f32_16x16x32_bf16 v[112:115], v[92:95], v[48:51], v[112:115]
    v_mfma_f32_16x16x32_bf16 v[132:135], v[92:95], v[52:55], v[132:135]
    v_mfma_f32_16x16x32_bf16 v[152:155], v[92:95], v[56:59], v[152:155]
    v_mfma_f32_16x16x32_bf16 v[172:175], v[92:95], v[60:63], v[172:175]
    v_mfma_f32_16x16x32_bf16 v[116:119], v[96:99], v[48:51], v[116:119]
    v_mfma_f32_16x16x32_bf16 v[136:139], v[96:99], v[52:55], v[136:139]
    v_mfma_f32_16x16x32_bf16 v[156:159], v[96:99], v[56:59], v[156:159]
    v_mfma_f32_16x16x32_bf16 v[176:179], v[96:99], v[60:63], v[176:179]
    v_mfma_f32_16x16x32_bf16 v[120:123], v[100:103], v[48:51], v[120:123]
    v_mfma_f32_16x16x32_bf16 v[140:143], v[100:103], v[52:55], v[140:143]
    v_mfma_f32_16x16x32_bf16 v[160:163], v[100:103], v[56:59], v[160:163]
    v_mfma_f32_16x16x32_bf16 v[180:183], v[100:103], v[60:63], v[180:183]
done_oproj0_kernel_4:
    s_nop 7
    s_barrier
    v_lshlrev_b32 v184, 4, v1
    s_mul_i32 s58, s5, 20480
    v_add_u32 v3, s58, v184
    ds_write_b128 v3, v[104:107] offset:0
    ds_write_b128 v3, v[108:111] offset:1024
    ds_write_b128 v3, v[112:115] offset:2048
    ds_write_b128 v3, v[116:119] offset:3072
    ds_write_b128 v3, v[120:123] offset:4096
    ds_write_b128 v3, v[124:127] offset:5120
    ds_write_b128 v3, v[128:131] offset:6144
    ds_write_b128 v3, v[132:135] offset:7168
    ds_write_b128 v3, v[136:139] offset:8192
    ds_write_b128 v3, v[140:143] offset:9216
    ds_write_b128 v3, v[144:147] offset:10240
    ds_write_b128 v3, v[148:151] offset:11264
    ds_write_b128 v3, v[152:155] offset:12288
    ds_write_b128 v3, v[156:159] offset:13312
    ds_write_b128 v3, v[160:163] offset:14336
    ds_write_b128 v3, v[164:167] offset:15360
    ds_write_b128 v3, v[168:171] offset:16384
    ds_write_b128 v3, v[172:175] offset:17408
    ds_write_b128 v3, v[176:179] offset:18432
    ds_write_b128 v3, v[180:183] offset:19456
    s_waitcnt lgkmcnt(0)
    s_barrier
    s_mul_i32 s58, s5, 5120
    v_add_u32 v3, s58, v184
    v_add_u32 v4, 40960, v3
    ds_read_b128 v[104:107], v3 offset:0
    ds_read_b128 v[108:111], v3 offset:1024
    ds_read_b128 v[112:115], v3 offset:2048
    ds_read_b128 v[116:119], v3 offset:3072
    ds_read_b128 v[120:123], v3 offset:4096
    ds_read_b128 v[32:35], v3 offset:20480
    ds_read_b128 v[36:39], v3 offset:21504
    ds_read_b128 v[40:43], v3 offset:22528
    ds_read_b128 v[44:47], v3 offset:23552
    ds_read_b128 v[48:51], v3 offset:24576
    ds_read_b128 v[52:55], v4 offset:0
    ds_read_b128 v[56:59], v4 offset:1024
    ds_read_b128 v[60:63], v4 offset:2048
    ds_read_b128 v[64:67], v4 offset:3072
    ds_read_b128 v[68:71], v4 offset:4096
    ds_read_b128 v[72:75], v4 offset:20480
    ds_read_b128 v[76:79], v4 offset:21504
    ds_read_b128 v[80:83], v4 offset:22528
    ds_read_b128 v[84:87], v4 offset:23552
    ds_read_b128 v[88:91], v4 offset:24576
    s_waitcnt lgkmcnt(0)
    v_add_f32 v104, v104, v32
    v_add_f32 v104, v104, v52
    v_add_f32 v104, v104, v72
    v_add_f32 v105, v105, v33
    v_add_f32 v105, v105, v53
    v_add_f32 v105, v105, v73
    v_add_f32 v106, v106, v34
    v_add_f32 v106, v106, v54
    v_add_f32 v106, v106, v74
    v_add_f32 v107, v107, v35
    v_add_f32 v107, v107, v55
    v_add_f32 v107, v107, v75
    v_add_f32 v108, v108, v36
    v_add_f32 v108, v108, v56
    v_add_f32 v108, v108, v76
    v_add_f32 v109, v109, v37
    v_add_f32 v109, v109, v57
    v_add_f32 v109, v109, v77
    v_add_f32 v110, v110, v38
    v_add_f32 v110, v110, v58
    v_add_f32 v110, v110, v78
    v_add_f32 v111, v111, v39
    v_add_f32 v111, v111, v59
    v_add_f32 v111, v111, v79
    v_add_f32 v112, v112, v40
    v_add_f32 v112, v112, v60
    v_add_f32 v112, v112, v80
    v_add_f32 v113, v113, v41
    v_add_f32 v113, v113, v61
    v_add_f32 v113, v113, v81
    v_add_f32 v114, v114, v42
    v_add_f32 v114, v114, v62
    v_add_f32 v114, v114, v82
    v_add_f32 v115, v115, v43
    v_add_f32 v115, v115, v63
    v_add_f32 v115, v115, v83
    v_add_f32 v116, v116, v44
    v_add_f32 v116, v116, v64
    v_add_f32 v116, v116, v84
    v_add_f32 v117, v117, v45
    v_add_f32 v117, v117, v65
    v_add_f32 v117, v117, v85
    v_add_f32 v118, v118, v46
    v_add_f32 v118, v118, v66
    v_add_f32 v118, v118, v86
    v_add_f32 v119, v119, v47
    v_add_f32 v119, v119, v67
    v_add_f32 v119, v119, v87
    v_add_f32 v120, v120, v48
    v_add_f32 v120, v120, v68
    v_add_f32 v120, v120, v88
    v_add_f32 v121, v121, v49
    v_add_f32 v121, v121, v69
    v_add_f32 v121, v121, v89
    v_add_f32 v122, v122, v50
    v_add_f32 v122, v122, v70
    v_add_f32 v122, v122, v90
    v_add_f32 v123, v123, v51
    v_add_f32 v123, v123, v71
    v_add_f32 v123, v123, v91
    v_mov_b32 v136, 0
    v_mov_b32 v137, 0
    v_lshlrev_b32 v140, 16, v8
    v_add_f32 v128, v104, v140
    v_and_b32 v140, 0xffff0000, v8
    v_add_f32 v129, v105, v140
    v_lshlrev_b32 v140, 16, v9
    v_add_f32 v130, v106, v140
    v_and_b32 v140, 0xffff0000, v9
    v_add_f32 v131, v107, v140
    v_lshlrev_b32 v140, 16, v10
    v_add_f32 v132, v108, v140
    v_and_b32 v140, 0xffff0000, v10
    v_add_f32 v133, v109, v140
    v_lshlrev_b32 v140, 16, v11
    v_add_f32 v134, v110, v140
    v_and_b32 v140, 0xffff0000, v11
    v_add_f32 v135, v111, v140
    v_cvt_pk_bf16_f32 v8, v128, v129
    v_cvt_pk_bf16_f32 v9, v130, v131
    v_cvt_pk_bf16_f32 v10, v132, v133
    v_cvt_pk_bf16_f32 v11, v134, v135
    buffer_store_dwordx4 v[8:11], v20, s[24:27], 0 offen offset:0
    v_lshlrev_b32 v140, 16, v8
    v_and_b32 v142, 0xffff0000, v8
    v_add_f32 v136, v136, v140
    v_fmac_f32 v137, v140, v140
    v_add_f32 v136, v136, v142
    v_fmac_f32 v137, v142, v142
    v_lshlrev_b32 v140, 16, v9
    v_and_b32 v142, 0xffff0000, v9
    v_add_f32 v136, v136, v140
    v_fmac_f32 v137, v140, v140
    v_add_f32 v136, v136, v142
    v_fmac_f32 v137, v142, v142
    v_lshlrev_b32 v140, 16, v10
    v_and_b32 v142, 0xffff0000, v10
    v_add_f32 v136, v136, v140
    v_fmac_f32 v137, v140, v140
    v_add_f32 v136, v136, v142
    v_fmac_f32 v137, v142, v142
    v_lshlrev_b32 v140, 16, v11
    v_and_b32 v142, 0xffff0000, v11
    v_add_f32 v136, v136, v140
    v_fmac_f32 v137, v140, v140
    v_add_f32 v136, v136, v142
    v_fmac_f32 v137, v142, v142
    v_lshlrev_b32 v140, 16, v12
    v_add_f32 v128, v112, v140
    v_and_b32 v140, 0xffff0000, v12
    v_add_f32 v129, v113, v140
    v_lshlrev_b32 v140, 16, v13
    v_add_f32 v130, v114, v140
    v_and_b32 v140, 0xffff0000, v13
    v_add_f32 v131, v115, v140
    v_lshlrev_b32 v140, 16, v14
    v_add_f32 v132, v116, v140
    v_and_b32 v140, 0xffff0000, v14
    v_add_f32 v133, v117, v140
    v_lshlrev_b32 v140, 16, v15
    v_add_f32 v134, v118, v140
    v_and_b32 v140, 0xffff0000, v15
    v_add_f32 v135, v119, v140
    v_cvt_pk_bf16_f32 v12, v128, v129
    v_cvt_pk_bf16_f32 v13, v130, v131
    v_cvt_pk_bf16_f32 v14, v132, v133
    v_cvt_pk_bf16_f32 v15, v134, v135
    buffer_store_dwordx4 v[12:15], v20, s[24:27], 0 offen offset:64
    v_lshlrev_b32 v140, 16, v12
    v_and_b32 v142, 0xffff0000, v12
    v_add_f32 v136, v136, v140
    v_fmac_f32 v137, v140, v140
    v_add_f32 v136, v136, v142
    v_fmac_f32 v137, v142, v142
    v_lshlrev_b32 v140, 16, v13
    v_and_b32 v142, 0xffff0000, v13
    v_add_f32 v136, v136, v140
    v_fmac_f32 v137, v140, v140
    v_add_f32 v136, v136, v142
    v_fmac_f32 v137, v142, v142
    v_lshlrev_b32 v140, 16, v14
    v_and_b32 v142, 0xffff0000, v14
    v_add_f32 v136, v136, v140
    v_fmac_f32 v137, v140, v140
    v_add_f32 v136, v136, v142
    v_fmac_f32 v137, v142, v142
    v_lshlrev_b32 v140, 16, v15
    v_and_b32 v142, 0xffff0000, v15
    v_add_f32 v136, v136, v140
    v_fmac_f32 v137, v140, v140
    v_add_f32 v136, v136, v142
    v_fmac_f32 v137, v142, v142
    v_lshlrev_b32 v140, 16, v16
    v_add_f32 v128, v120, v140
    v_and_b32 v140, 0xffff0000, v16
    v_add_f32 v129, v121, v140
    v_lshlrev_b32 v140, 16, v17
    v_add_f32 v130, v122, v140
    v_and_b32 v140, 0xffff0000, v17
    v_add_f32 v131, v123, v140
    v_cvt_pk_bf16_f32 v16, v128, v129
    v_cvt_pk_bf16_f32 v17, v130, v131
    buffer_store_dwordx2 v[16:17], v21, s[24:27], 0 offen offset:128
    v_lshlrev_b32 v140, 16, v16
    v_and_b32 v142, 0xffff0000, v16
    v_add_f32 v136, v136, v140
    v_fmac_f32 v137, v140, v140
    v_add_f32 v136, v136, v142
    v_fmac_f32 v137, v142, v142
    v_lshlrev_b32 v140, 16, v17
    v_and_b32 v142, 0xffff0000, v17
    v_add_f32 v136, v136, v140
    v_fmac_f32 v137, v140, v140
    v_add_f32 v136, v136, v142
    v_fmac_f32 v137, v142, v142
    v_mov_b32 v140, v136
    v_mov_b32 v141, v137
    s_nop 1
    v_permlane16_swap_b32 v136, v140
    v_permlane16_swap_b32 v137, v141
    v_add_f32 v136, v136, v140
    v_add_f32 v137, v137, v141
    v_mov_b32 v140, v136
    v_mov_b32 v141, v137
    s_nop 1
    v_permlane32_swap_b32 v136, v140
    v_permlane32_swap_b32 v137, v141
    v_add_f32 v136, v136, v140
    v_add_f32 v137, v137, v141
    s_lshl_b32 s58, s5, 4
    s_add_u32 s58, s58, s56
    v_add_u32 v140, s58, v1
    v_lshlrev_b32 v140, 6, v140
    s_lshl_b32 s58, s4, 3
    s_add_u32 s58, s58, 0x8000
    v_add_u32 v140, s58, v140
    v_cmp_gt_u32 vcc, 16, v1
    s_and_saveexec_b64 s[60:61], vcc
    s_cbranch_execz st_oproj0_kernel_9
    buffer_store_dwordx2 v[136:137], v140, s[20:23], 0 offen
st_oproj0_kernel_9:
    s_mov_b64 exec, s[60:61]
end_oproj0_kernel_1:
    s_endpgm
.globl down0_kernel
.p2align 8
.type down0_kernel,@function
down0_kernel:
    s_cmp_ge_u32 s2, 256
    s_cbranch_scc1 end_down0_kernel_1
    s_load_dwordx16 s[64:79], s[0:1], 0
    s_load_dwordx4 s[80:83], s[0:1], 64
    s_and_b32 s3, s2, 31
    s_lshr_b32 s4, s2, 5
    v_and_b32 v1, 63, v0
    v_lshrrev_b32 v2, 6, v0
    s_nop 0
    v_readfirstlane_b32 s5, v2
    s_lshl_b32 s56, s3, 6
    s_mul_i32 s57, s4, 80
    s_min_u32 s58, s5, 2
    s_mul_i32 s59, s5, 13
    s_add_u32 s59, s59, s58
    s_cmp_lt_u32 s5, 2
    s_cselect_b32 s55, 14, 13
    v_lshlrev_b32 v5, 4, v1
    s_mul_i32 s48, s3, 54
    s_add_u32 s48, s48, s59
    s_lshl_b32 s48, s48, 12
    s_mul_i32 s49, s4, 1728
    s_lshl_b32 s58, s59, 5
    s_add_u32 s49, s49, s58
    s_mul_i32 s49, s49, 160
    s_mul_i32 s52, s5, 36864
    s_add_u32 s53, s52, 36864
    s_mov_b32 s50, s52
    s_mov_b32 s51, s52
    s_waitcnt lgkmcnt(0)
    s_add_u32 s8, s82, 0x1600000
    s_addc_u32 s9, s83, 0
    s_and_b32 s9, s9, 0xffff
    s_mov_b32 s10, 0x6c0000
    s_mov_b32 s11, 0x20000
    s_add_u32 s12, s82, 0x2100000
    s_addc_u32 s13, s83, 0
    s_and_b32 s13, s13, 0xffff
    s_mov_b32 s14, 0x21c000
    s_mov_b32 s15, 0x20000
    s_mov_b32 m0, s50
    s_nop 0
    buffer_load_dwordx4 v5, s[8:11], s48 offen lds
    buffer_load_dwordx4 v5, s[8:11], s48 offen offset:1024 lds
    buffer_load_dwordx4 v5, s[8:11], s48 offen offset:2048 lds
    buffer_load_dwordx4 v5, s[8:11], s48 offen offset:3072 lds
    s_add_u32 m0, s50, 4096
    s_nop 0
    buffer_load_dwordx4 v5, s[12:15], s49 offen lds
    buffer_load_dwordx4 v5, s[12:15], s49 offen offset:1024 lds
    buffer_load_dwordx4 v5, s[12:15], s49 offen offset:2048 lds
    buffer_load_dwordx4 v5, s[12:15], s49 offen offset:3072 lds
    s_add_u32 m0, s50, 8192
    s_add_u32 s54, s49, 4096
    buffer_load_dwordx4 v5, s[12:15], s54 offen lds
    s_add_u32 s48, s48, 4096
    s_add_u32 s49, s49, 5120
    s_add_u32 s50, s50, 9216
    s_cmp_eq_u32 s50, s53
    s_cselect_b32 s50, s52, s50
    s_mov_b32 m0, s50
    s_nop 0
    buffer_load_dwordx4 v5, s[8:11], s48 offen lds
    buffer_load_dwordx4 v5, s[8:11], s48 offen offset:1024 lds
    buffer_load_dwordx4 v5, s[8:11], s48 offen offset:2048 lds
    buffer_load_dwordx4 v5, s[8:11], s48 offen offset:3072 lds
    s_add_u32 m0, s50, 4096
    s_nop 0
    buffer_load_dwordx4 v5, s[12:15], s49 offen lds
    buffer_load_dwordx4 v5, s[12:15], s49 offen offset:1024 lds
    buffer_load_dwordx4 v5, s[12:15], s49 offen offset:2048 lds
    buffer_load_dwordx4 v5, s[12:15], s49 offen offset:3072 lds
    s_add_u32 m0, s50, 8192
    s_add_u32 s54, s49, 4096
    buffer_load_dwordx4 v5, s[12:15], s54 offen lds
    s_add_u32 s48, s48, 4096
    s_add_u32 s49, s49, 5120
    s_add_u32 s50, s50, 9216
    s_cmp_eq_u32 s50, s53
    s_cselect_b32 s50, s52, s50
    s_mov_b32 m0, s50
    s_nop 0
    buffer_load_dwordx4 v5, s[8:11], s48 offen lds
    buffer_load_dwordx4 v5, s[8:11], s48 offen offset:1024 lds
    buffer_load_dwordx4 v5, s[8:11], s48 offen offset:2048 lds
    buffer_load_dwordx4 v5, s[8:11], s48 offen offset:3072 lds
    s_add_u32 m0, s50, 4096
    s_nop 0
    buffer_load_dwordx4 v5, s[12:15], s49 offen lds
    buffer_load_dwordx4 v5, s[12:15], s49 offen offset:1024 lds
    buffer_load_dwordx4 v5, s[12:15], s49 offen offset:2048 lds
    buffer_load_dwordx4 v5, s[12:15], s49 offen offset:3072 lds
    s_add_u32 m0, s50, 8192
    s_add_u32 s54, s49, 4096
    buffer_load_dwordx4 v5, s[12:15], s54 offen lds
    s_add_u32 s48, s48, 4096
    s_add_u32 s49, s49, 5120
    s_add_u32 s50, s50, 9216
    s_cmp_eq_u32 s50, s53
    s_cselect_b32 s50, s52, s50
    s_mov_b32 m0, s50
    s_nop 0
    buffer_load_dwordx4 v5, s[8:11], s48 offen lds
    buffer_load_dwordx4 v5, s[8:11], s48 offen offset:1024 lds
    buffer_load_dwordx4 v5, s[8:11], s48 offen offset:2048 lds
    buffer_load_dwordx4 v5, s[8:11], s48 offen offset:3072 lds
    s_add_u32 m0, s50, 4096
    s_nop 0
    buffer_load_dwordx4 v5, s[12:15], s49 offen lds
    buffer_load_dwordx4 v5, s[12:15], s49 offen offset:1024 lds
    buffer_load_dwordx4 v5, s[12:15], s49 offen offset:2048 lds
    buffer_load_dwordx4 v5, s[12:15], s49 offen offset:3072 lds
    s_add_u32 m0, s50, 8192
    s_add_u32 s54, s49, 4096
    buffer_load_dwordx4 v5, s[12:15], s54 offen lds
    s_add_u32 s48, s48, 4096
    s_add_u32 s49, s49, 5120
    s_add_u32 s50, s50, 9216
    s_cmp_eq_u32 s50, s53
    s_cselect_b32 s50, s52, s50
    s_add_u32 s24, s82, 0x1300000
    s_addc_u32 s25, s83, 0
    s_and_b32 s25, s25, 0xffff
    s_mov_b32 s26, 0x280000
    s_mov_b32 s27, 0x20000
    s_add_u32 s28, s82, 0x1000000
    s_addc_u32 s29, s83, 0
    s_and_b32 s29, s29, 0xffff
    s_mov_b32 s30, 0x280000
    s_mov_b32 s31, 0x20000
    s_mov_b32 s20, s82
    s_and_b32 s21, s83, 0xffff
    s_mov_b32 s22, 0x100000
    s_mov_b32 s23, 0x20000
    v_lshrrev_b32 v7, 4, v1
    s_lshl_b32 s58, s5, 4
    s_add_u32 s58, s58, s56
    v_and_b32 v20, 15, v1
    v_add_u32 v20, s58, v20
    v_mul_u32_u24 v20, 1280, v20
    v_lshl_add_u32 v20, v7, 4, v20
    s_lshl_b32 s58, s57, 1
    v_add_u32 v20, s58, v20
    v_lshlrev_b32 v21, 3, v7
    v_sub_u32 v21, v20, v21
    buffer_load_dwordx4 v[8:11], v20, s[28:31], 0 offen
    buffer_load_dwordx4 v[12:15], v20, s[28:31], 0 offen offset:64
    buffer_load_dwordx2 v[16:17], v21, s[28:31], 0 offen offset:128
    v_and_b32 v3, 15, v1
    v_lshrrev_b32 v4, 2, v3
    v_sub_u32 v4, 0, v4
    v_xor_b32 v4, v4, v7
    v_and_b32 v4, 3, v4
    v_lshlrev_b32 v22, 6, v3
    v_lshl_add_u32 v22, v4, 4, v22
    v_bfe_u32 v30, v1, 2, 2
    v_lshl_add_u32 v3, v7, 3, v30
    v_mul_u32_u24 v3, 160, v3
    v_and_b32 v4, 3, v1
    v_lshl_add_u32 v3, v4, 4, v3
    v_add_u32 v23, 4096, v3
    v_lshl_add_u32 v3, v7, 3, v30
    v_mul_u32_u24 v3, 160, v3
    v_and_b32 v4, 3, v1
    v_lshl_add_u32 v3, v4, 4, v3
    v_add_u32 v24, 4160, v3
    v_lshl_add_u32 v3, v7, 3, v30
    v_mul_u32_u24 v3, 160, v3
    v_and_b32 v4, 3, v1
    v_lshl_add_u32 v3, v4, 3, v3
    v_add_u32 v25, 4224, v3
    v_mov_b32 v104, 0
    v_mov_b32 v105, 0
    v_mov_b32 v106, 0
    v_mov_b32 v107, 0
    v_mov_b32 v108, 0
    v_mov_b32 v109, 0
    v_mov_b32 v110, 0
    v_mov_b32 v111, 0
    v_mov_b32 v112, 0
    v_mov_b32 v113, 0
    v_mov_b32 v114, 0
    v_mov_b32 v115, 0
    v_mov_b32 v116, 0
    v_mov_b32 v117, 0
    v_mov_b32 v118, 0
    v_mov_b32 v119, 0
    v_mov_b32 v120, 0
    v_mov_b32 v121, 0
    v_mov_b32 v122, 0
    v_mov_b32 v123, 0
    v_mov_b32 v124, 0
    v_mov_b32 v125, 0
    v_mov_b32 v126, 0
    v_mov_b32 v127, 0
    v_mov_b32 v128, 0
    v_mov_b32 v129, 0
    v_mov_b32 v130, 0
    v_mov_b32 v131, 0
    v_mov_b32 v132, 0
    v_mov_b32 v133, 0
    v_mov_b32 v134, 0
    v_mov_b32 v135, 0
    v_mov_b32 v136, 0
    v_mov_b32 v137, 0
    v_mov_b32 v138, 0
    v_mov_b32 v139, 0
    v_mov_b32 v140, 0
    v_mov_b32 v141, 0
    v_mov_b32 v142, 0
    v_mov_b32 v143, 0
    v_mov_b32 v144, 0
    v_mov_b32 v145, 0
    v_mov_b32 v146, 0
    v_mov_b32 v147, 0
    v_mov_b32 v148, 0
    v_mov_b32 v149, 0
    v_mov_b32 v150, 0
    v_mov_b32 v151, 0
    v_mov_b32 v152, 0
    v_mov_b32 v153, 0
    v_mov_b32 v154, 0
    v_mov_b32 v155, 0
    v_mov_b32 v156, 0
    v_mov_b32 v157, 0
    v_mov_b32 v158, 0
    v_mov_b32 v159, 0
    v_mov_b32 v160, 0
    v_mov_b32 v161, 0
    v_mov_b32 v162, 0
    v_mov_b32 v163, 0
    v_mov_b32 v164, 0
    v_mov_b32 v165, 0
    v_mov_b32 v166, 0
    v_mov_b32 v167, 0
    v_mov_b32 v168, 0
    v_mov_b32 v169, 0
    v_mov_b32 v170, 0
    v_mov_b32 v171, 0
    v_mov_b32 v172, 0
    v_mov_b32 v173, 0
    v_mov_b32 v174, 0
    v_mov_b32 v175, 0
    v_mov_b32 v176, 0
    v_mov_b32 v177, 0
    v_mov_b32 v178, 0
    v_mov_b32 v179, 0
    v_mov_b32 v180, 0
    v_mov_b32 v181, 0
    v_mov_b32 v182, 0
    v_mov_b32 v183, 0
    s_waitcnt vmcnt(30)
    v_add_u32 v26, s51, v22
    v_add_u32 v27, s51, v23
    v_add_u32 v28, s51, v24
    v_add_u32 v29, s51, v25
    s_add_u32 s51, s51, 9216
    s_cmp_eq_u32 s51, s53
    s_cselect_b32 s51, s52, s51
    ds_read_b128 v[32:35], v26 offset:0
    ds_read_b128 v[36:39], v26 offset:1024
    ds_read_b128 v[40:43], v26 offset:2048
    ds_read_b128 v[44:47], v26 offset:3072
    ds_read_b64_tr_b16 v[64:65], v27 offset:0
    ds_read_b64_tr_b16 v[66:67], v27 offset:640
    ds_read_b64_tr_b16 v[68:69], v27 offset:8
    ds_read_b64_tr_b16 v[70:71], v27 offset:648
    ds_read_b64_tr_b16 v[72:73], v28 offset:0
    ds_read_b64_tr_b16 v[74:75], v28 offset:640
    ds_read_b64_tr_b16 v[76:77], v28 offset:8
    ds_read_b64_tr_b16 v[78:79], v28 offset:648
    ds_read_b64_tr_b16 v[80:81], v29 offset:0
    ds_read_b64_tr_b16 v[82:83], v29 offset:640
    s_waitcnt lgkmcnt(0)
loop_down0_kernel_2:
    s_cmp_le_u32 s55, 4
    s_cbranch_scc1 tail_down0_kernel_5
    s_waitcnt vmcnt(18)
    v_add_u32 v26, s51, v22
    v_add_u32 v27, s51, v23
    v_add_u32 v28, s51, v24
    v_add_u32 v29, s51, v25
    s_add_u32 s51, s51, 9216
    s_cmp_eq_u32 s51, s53
    s_cselect_b32 s51, s52, s51
    ds_read_b128 v[48:51], v26 offset:0
    ds_read_b128 v[52:55], v26 offset:1024
    v_mfma_f32_16x16x32_bf16 v[104:107], v[64:67], v[32:35], v[104:107]
    ds_read_b128 v[56:59], v26 offset:2048
    v_mfma_f32_16x16x32_bf16 v[124:127], v[64:67], v[36:39], v[124:127]
    ds_read_b128 v[60:63], v26 offset:3072
    v_mfma_f32_16x16x32_bf16 v[144:147], v[64:67], v[40:43], v[144:147]
    ds_read_b64_tr_b16 v[84:85], v27 offset:0
    v_mfma_f32_16x16x32_bf16 v[164:167], v[64:67], v[44:47], v[164:167]
    ds_read_b64_tr_b16 v[86:87], v27 offset:640
    v_mfma_f32_16x16x32_bf16 v[108:111], v[68:71], v[32:35], v[108:111]
    ds_read_b64_tr_b16 v[88:89], v27 offset:8
    ds_read_b64_tr_b16 v[90:91], v27 offset:648
    v_mfma_f32_16x16x32_bf16 v[128:131], v[68:71], v[36:39], v[128:131]
    ds_read_b64_tr_b16 v[92:93], v28 offset:0
    v_mfma_f32_16x16x32_bf16 v[148:151], v[68:71], v[40:43], v[148:151]
    ds_read_b64_tr_b16 v[94:95], v28 offset:640
    v_mfma_f32_16x16x32_bf16 v[168:171], v[68:71], v[44:47], v[168:171]
    ds_read_b64_tr_b16 v[96:97], v28 offset:8
    v_mfma_f32_16x16x32_bf16 v[112:115], v[72:75], v[32:35], v[112:115]
    ds_read_b64_tr_b16 v[98:99], v28 offset:648
    v_mfma_f32_16x16x32_bf16 v[132:135], v[72:75], v[36:39], v[132:135]
    ds_read_b64_tr_b16 v[100:101], v29 offset:0
    ds_read_b64_tr_b16 v[102:103], v29 offset:640
    v_mfma_f32_16x16x32_bf16 v[152:155], v[72:75], v[40:43], v[152:155]
    s_mov_b32 m0, s50
    s_nop 0
    buffer_load_dwordx4 v5, s[8:11], s48 offen lds
    v_mfma_f32_16x16x32_bf16 v[172:175], v[72:75], v[44:47], v[172:175]
    buffer_load_dwordx4 v5, s[8:11], s48 offen offset:1024 lds
    v_mfma_f32_16x16x32_bf16 v[116:119], v[76:79], v[32:35], v[116:119]
    buffer_load_dwordx4 v5, s[8:11], s48 offen offset:2048 lds
    v_mfma_f32_16x16x32_bf16 v[136:139], v[76:79], v[36:39], v[136:139]
    buffer_load_dwordx4 v5, s[8:11], s48 offen offset:3072 lds
    v_mfma_f32_16x16x32_bf16 v[156:159], v[76:79], v[40:43], v[156:159]
    s_add_u32 m0, s50, 4096
    s_nop 0
    buffer_load_dwordx4 v5, s[12:15], s49 offen lds
    buffer_load_dwordx4 v5, s[12:15], s49 offen offset:1024 lds
    v_mfma_f32_16x16x32_bf16 v[176:179], v[76:79], v[44:47], v[176:179]
    buffer_load_dwordx4 v5, s[12:15], s49 offen offset:2048 lds
    v_mfma_f32_16x16x32_bf16 v[120:123], v[80:83], v[32:35], v[120:123]
    buffer_load_dwordx4 v5, s[12:15], s49 offen offset:3072 lds
    v_mfma_f32_16x16x32_bf16 v[140:143], v[80:83], v[36:39], v[140:143]
    s_add_u32 m0, s50, 8192
    s_add_u32 s54, s49, 4096
    buffer_load_dwordx4 v5, s[12:15], s54 offen lds
    v_mfma_f32_16x16x32_bf16 v[160:163], v[80:83], v[40:43], v[160:163]
    s_add_u32 s48, s48, 4096
    s_add_u32 s49, s49, 5120
    s_add_u32 s50, s50, 9216
    s_cmp_eq_u32 s50, s53
    s_cselect_b32 s50, s52, s50
    v_mfma_f32_16x16x32_bf16 v[180:183], v[80:83], v[44:47], v[180:183]
    s_nop 0
    s_nop 0
    s_branch join_down0_kernel_6
tail_down0_kernel_5:
    s_waitcnt vmcnt(0)
    v_add_u32 v26, s51, v22
    v_add_u32 v27, s51, v23
    v_add_u32 v28, s51, v24
    v_add_u32 v29, s51, v25
    s_add_u32 s51, s51, 9216
    s_cmp_eq_u32 s51, s53
    s_cselect_b32 s51, s52, s51
    ds_read_b128 v[48:51], v26 offset:0
    ds_read_b128 v[52:55], v26 offset:1024
    v_mfma_f32_16x16x32_bf16 v[104:107], v[64:67], v[32:35], v[104:107]
    v_mfma_f32_16x16x32_bf16 v[124:127], v[64:67], v[36:39], v[124:127]
    ds_read_b128 v[56:59], v26 offset:2048
    v_mfma_f32_16x16x32_bf16 v[144:147], v[64:67], v[40:43], v[144:147]
    v_mfma_f32_16x16x32_bf16 v[164:167], v[64:67], v[44:47], v[164:167]
    ds_read_b128 v[60:63], v26 offset:3072
    v_mfma_f32_16x16x32_bf16 v[108:111], v[68:71], v[32:35], v[108:111]
    ds_read_b64_tr_b16 v[84:85], v27 offset:0
    v_mfma_f32_16x16x32_bf16 v[128:131], v[68:71], v[36:39], v[128:131]
    v_mfma_f32_16x16x32_bf16 v[148:151], v[68:71], v[40:43], v[148:151]
    ds_read_b64_tr_b16 v[86:87], v27 offset:640
    v_mfma_f32_16x16x32_bf16 v[168:171], v[68:71], v[44:47], v[168:171]
    v_mfma_f32_16x16x32_bf16 v[112:115], v[72:75], v[32:35], v[112:115]
    ds_read_b64_tr_b16 v[88:89], v27 offset:8
    v_mfma_f32_16x16x32_bf16 v[132:135], v[72:75], v[36:39], v[132:135]
    ds_read_b64_tr_b16 v[90:91], v27 offset:648
    v_mfma_f32_16x16x32_bf16 v[152:155], v[72:75], v[40:43], v[152:155]
    v_mfma_f32_16x16x32_bf16 v[172:175], v[72:75], v[44:47], v[172:175]
    ds_read_b64_tr_b16 v[92:93], v28 offset:0
    v_mfma_f32_16x16x32_bf16 v[116:119], v[76:79], v[32:35], v[116:119]
    v_mfma_f32_16x16x32_bf16 v[136:139], v[76:79], v[36:39], v[136:139]
    ds_read_b64_tr_b16 v[94:95], v28 offset:640
    v_mfma_f32_16x16x32_bf16 v[156:159], v[76:79], v[40:43], v[156:159]
    ds_read_b64_tr_b16 v[96:97], v28 offset:8
    v_mfma_f32_16x16x32_bf16 v[176:179], v[76:79], v[44:47], v[176:179]
    v_mfma_f32_16x16x32_bf16 v[120:123], v[80:83], v[32:35], v[120:123]
    ds_read_b64_tr_b16 v[98:99], v28 offset:648
    v_mfma_f32_16x16x32_bf16 v[140:143], v[80:83], v[36:39], v[140:143]
    v_mfma_f32_16x16x32_bf16 v[160:163], v[80:83], v[40:43], v[160:163]
    ds_read_b64_tr_b16 v[100:101], v29 offset:0
    v_mfma_f32_16x16x32_bf16 v[180:183], v[80:83], v[44:47], v[180:183]
    ds_read_b64_tr_b16 v[102:103], v29 offset:640
join_down0_kernel_6:
    s_waitcnt lgkmcnt(0)
    s_sub_u32 s55, s55, 1
    s_cmp_eq_u32 s55, 1
    s_cbranch_scc1 lastB_down0_kernel_3
    s_cmp_le_u32 s55, 4
    s_cbranch_scc1 tail_down0_kernel_7
    s_waitcnt vmcnt(18)
    v_add_u32 v26, s51, v22
    v_add_u32 v27, s51, v23
    v_add_u32 v28, s51, v24
    v_add_u32 v29, s51, v25
    s_add_u32 s51, s51, 9216
    s_cmp_eq_u32 s51, s53
    s_cselect_b32 s51, s52, s51
    ds_read_b128 v[32:35], v26 offset:0
    ds_read_b128 v[36:39], v26 offset:1024
    v_mfma_f32_16x16x32_bf16 v[104:107], v[84:87], v[48:51], v[104:107]
    ds_read_b128 v[40:43], v26 offset:2048
    v_mfma_f32_16x16x32_bf16 v[124:127], v[84:87], v[52:55], v[124:127]
    ds_read_b128 v[44:47], v26 offset:3072
    v_mfma_f32_16x16x32_bf16 v[144:147], v[84:87], v[56:59], v[144:147]
    ds_read_b64_tr_b16 v[64:65], v27 offset:0
    v_mfma_f32_16x16x32_bf16 v[164:167], v[84:87], v[60:63], v[164:167]
    ds_read_b64_tr_b16 v[66:67], v27 offset:640
    v_mfma_f32_16x16x32_bf16 v[108:111], v[88:91], v[48:51], v[108:111]
    ds_read_b64_tr_b16 v[68:69], v27 offset:8
    ds_read_b64_tr_b16 v[70:71], v27 offset:648
    v_mfma_f32_16x16x32_bf16 v[128:131], v[88:91], v[52:55], v[128:131]
    ds_read_b64_tr_b16 v[72:73], v28 offset:0
    v_mfma_f32_16x16x32_bf16 v[148:151], v[88:91], v[56:59], v[148:151]
    ds_read_b64_tr_b16 v[74:75], v28 offset:640
    v_mfma_f32_16x16x32_bf16 v[168:171], v[88:91], v[60:63], v[168:171]
    ds_read_b64_tr_b16 v[76:77], v28 offset:8
    v_mfma_f32_16x16x32_bf16 v[112:115], v[92:95], v[48:51], v[112:115]
    ds_read_b64_tr_b16 v[78:79], v28 offset:648
    v_mfma_f32_16x16x32_bf16 v[132:135], v[92:95], v[52:55], v[132:135]
    ds_read_b64_tr_b16 v[80:81], v29 offset:0
    ds_read_b64_tr_b16 v[82:83], v29 offset:640
    v_mfma_f32_16x16x32_bf16 v[152:155], v[92:95], v[56:59], v[152:155]
    s_mov_b32 m0, s50
    s_nop 0
    buffer_load_dwordx4 v5, s[8:11], s48 offen lds
    v_mfma_f32_16x16x32_bf16 v[172:175], v[92:95], v[60:63], v[172:175]
    buffer_load_dwordx4 v5, s[8:11], s48 offen offset:1024 lds
    v_mfma_f32_16x16x32_bf16 v[116:119], v[96:99], v[48:51], v[116:119]
    buffer_load_dwordx4 v5, s[8:11], s48 offen offset:2048 lds
    v_mfma_f32_16x16x32_bf16 v[136:139], v[96:99], v[52:55], v[136:139]
    buffer_load_dwordx4 v5, s[8:11], s48 offen offset:3072 lds
    v_mfma_f32_16x16x32_bf16 v[156:159], v[96:99], v[56:59], v[156:159]
    s_add_u32 m0, s50, 4096
    s_nop 0
    buffer_load_dwordx4 v5, s[12:15], s49 offen lds
    buffer_load_dwordx4 v5, s[12:15], s49 offen offset:1024 lds
    v_mfma_f32_16x16x32_bf16 v[176:179], v[96:99], v[60:63], v[176:179]
    buffer_load_dwordx4 v5, s[12:15], s49 offen offset:2048 lds
    v_mfma_f32_16x16x32_bf16 v[120:123], v[100:103], v[48:51], v[120:123]
    buffer_load_dwordx4 v5, s[12:15], s49 offen offset:3072 lds
    v_mfma_f32_16x16x32_bf16 v[140:143], v[100:103], v[52:55], v[140:143]
    s_add_u32 m0, s50, 8192
    s_add_u32 s54, s49, 4096
    buffer_load_dwordx4 v5, s[12:15], s54 offen lds
    v_mfma_f32_16x16x32_bf16 v[160:163], v[100:103], v[56:59], v[160:163]
    s_add_u32 s48, s48, 4096
    s_add_u32 s49, s49, 5120
    s_add_u32 s50, s50, 9216
    s_cmp_eq_u32 s50, s53
    s_cselect_b32 s50, s52, s50
    v_mfma_f32_16x16x32_bf16 v[180:183], v[100:103], v[60:63], v[180:183]
    s_nop 0
    s_nop 0
    s_branch join_down0_kernel_8
tail_down0_kernel_7:
    s_waitcnt vmcnt(0)
    v_add_u32 v26, s51, v22
    v_add_u32 v27, s51, v23
    v_add_u32 v28, s51, v24
    v_add_u32 v29, s51, v25
    s_add_u32 s51, s51, 9216
    s_cmp_eq_u32 s51, s53
    s_cselect_b32 s51, s52, s51
    ds_read_b128 v[32:35], v26 offset:0
    ds_read_b128 v[36:39], v26 offset:1024
    v_mfma_f32_16x16x32_bf16 v[104:107], v[84:87], v[48:51], v[104:107]
    v_mfma_f32_16x16x32_bf16 v[124:127], v[84:87], v[52:55], v[124:127]
    ds_read_b128 v[40:43], v26 offset:2048
    v_mfma_f32_16x16x32_bf16 v[144:147], v[84:87], v[56:59], v[144:147]
    v_mfma_f32_16x16x32_bf16 v[164:167], v[84:87], v[60:63], v[164:167]
    ds_read_b128 v[44:47], v26 offset:3072
    v_mfma_f32_16x16x32_bf16 v[108:111], v[88:91], v[48:51], v[108:111]
    ds_read_b64_tr_b16 v[64:65], v27 offset:0
    v_mfma_f32_16x16x32_bf16 v[128:131], v[88:91], v[52:55], v[128:131]
    v_mfma_f32_16x16x32_bf16 v[148:151], v[88:91], v[56:59], v[148:151]
    ds_read_b64_tr_b16 v[66:67], v27 offset:640
    v_mfma_f32_16x16x32_bf16 v[168:171], v[88:91], v[60:63], v[168:171]
    v_mfma_f32_16x16x32_bf16 v[112:115], v[92:95], v[48:51], v[112:115]
    ds_read_b64_tr_b16 v[68:69], v27 offset:8
    v_mfma_f32_16x16x32_bf16 v[132:135], v[92:95], v[52:55], v[132:135]
    ds_read_b64_tr_b16 v[70:71], v27 offset:648
    v_mfma_f32_16x16x32_bf16 v[152:155], v[92:95], v[56:59], v[152:155]
    v_mfma_f32_16x16x32_bf16 v[172:175], v[92:95], v[60:63], v[172:175]
    ds_read_b64_tr_b16 v[72:73], v28 offset:0
    v_mfma_f32_16x16x32_bf16 v[116:119], v[96:99], v[48:51], v[116:119]
    v_mfma_f32_16x16x32_bf16 v[136:139], v[96:99], v[52:55], v[136:139]
    ds_read_b64_tr_b16 v[74:75], v28 offset:640
    v_mfma_f32_16x16x32_bf16 v[156:159], v[96:99], v[56:59], v[156:159]
    ds_read_b64_tr_b16 v[76:77], v28 offset:8
    v_mfma_f32_16x16x32_bf16 v[176:179], v[96:99], v[60:63], v[176:179]
    v_mfma_f32_16x16x32_bf16 v[120:123], v[100:103], v[48:51], v[120:123]
    ds_read_b64_tr_b16 v[78:79], v28 offset:648
    v_mfma_f32_16x16x32_bf16 v[140:143], v[100:103], v[52:55], v[140:143]
    v_mfma_f32_16x16x32_bf16 v[160:163], v[100:103], v[56:59], v[160:163]
    ds_read_b64_tr_b16 v[80:81], v29 offset:0
    v_mfma_f32_16x16x32_bf16 v[180:183], v[100:103], v[60:63], v[180:183]
    ds_read_b64_tr_b16 v[82:83], v29 offset:640
join_down0_kernel_8:
    s_waitcnt lgkmcnt(0)
    s_sub_u32 s55, s55, 1
    s_cmp_eq_u32 s55, 1
    s_cbranch_scc0 loop_down0_kernel_2
    v_mfma_f32_16x16x32_bf16 v[104:107], v[64:67], v[32:35], v[104:107]
    v_mfma_f32_16x16x32_bf16 v[124:127], v[64:67], v[36:39], v[124:127]
    v_mfma_f32_16x16x32_bf16 v[144:147], v[64:67], v[40:43], v[144:147]
    v_mfma_f32_16x16x32_bf16 v[164:167], v[64:67], v[44:47], v[164:167]
    v_mfma_f32_16x16x32_bf16 v[108:111], v[68:71], v[32:35], v[108:111]
    v_mfma_f32_16x16x32_bf16 v[128:131], v[68:71], v[36:39], v[128:131]
    v_mfma_f32_16x16x32_bf16 v[148:151], v[68:71], v[40:43], v[148:151]
    v_mfma_f32_16x16x32_bf16 v[168:171], v[68:71], v[44:47], v[168:171]
    v_mfma_f32_16x16x32_bf16 v[112:115], v[72:75], v[32:35], v[112:115]
    v_mfma_f32_16x16x32_bf16 v[132:135], v[72:75], v[36:39], v[132:135]
    v_mfma_f32_16x16x32_bf16 v[152:155], v[72:75], v[40:43], v[152:155]
    v_mfma_f32_16x16x32_bf16 v[172:175], v[72:75], v[44:47], v[172:175]
    v_mfma_f32_16x16x32_bf16 v[116:119], v[76:79], v[32:35], v[116:119]
    v_mfma_f32_16x16x32_bf16 v[136:139], v[76:79], v[36:39], v[136:139]
    v_mfma_f32_16x16x32_bf16 v[156:159], v[76:79], v[40:43], v[156:159]
    v_mfma_f32_16x16x32_bf16 v[176:179], v[76:79], v[44:47], v[176:179]
    v_mfma_f32_16x16x32_bf16 v[120:123], v[80:83], v[32:35], v[120:123]
    v_mfma_f32_16x16x32_bf16 v[140:143], v[80:83], v[36:39], v[140:143]
    v_mfma_f32_16x16x32_bf16 v[160:163], v[80:83], v[40:43], v[160:163]
    v_mfma_f32_16x16x32_bf16 v[180:183], v[80:83], v[44:47], v[180:183]
    s_branch done_down0_kernel_4
lastB_down0_kernel_3:
    v_mfma_f32_16x16x32_bf16 v[104:107], v[84:87], v[48:51], v[104:107]
    v_mfma_f32_16x16x32_bf16 v[124:127], v[84:87], v[52:55], v[124:127]
    v_mfma_f32_16x16x32_bf16 v[144:147], v[84:87], v[56:59], v[144:147]
    v_mfma_f32_16x16x32_bf16 v[164:167], v[84:87], v[60:63], v[164:167]
    v_mfma_f32_16x16x32_bf16 v[108:111], v[88:91], v[48:51], v[108:111]
    v_mfma_f32_16x16x32_bf16 v[128:131], v[88:91], v[52:55], v[128:131]
    v_mfma_f32_16x16x32_bf16 v[148:151], v[88:91], v[56:59], v[148:151]
    v_mfma_f32_16x16x32_bf16 v[168:171], v[88:91], v[60:63], v[168:171]
    v_mfma_f32_16x16x32_bf16 v[112:115], v[92:95], v[48:51], v[112:115]
    v_mfma_f32_16x16x32_bf16 v[132:135], v[92:95], v[52:55], v[132:135]
    v_mfma_f32_16x16x32_bf16 v[152:155], v[92:95], v[56:59], v[152:155]
    v_mfma_f32_16x16x32_bf16 v[172:175], v[92:95], v[60:63], v[172:175]
    v_mfma_f32_16x16x32_bf16 v[116:119], v[96:99], v[48:51], v[116:119]
    v_mfma_f32_16x16x32_bf16 v[136:139], v[96:99], v[52:55], v[136:139]
    v_mfma_f32_16x16x32_bf16 v[156:159], v[96:99], v[56:59], v[156:159]
    v_mfma_f32_16x16x32_bf16 v[176:179], v[96:99], v[60:63], v[176:179]
    v_mfma_f32_16x16x32_bf16 v[120:123], v[100:103], v[48:51], v[120:123]
    v_mfma_f32_16x16x32_bf16 v[140:143], v[100:103], v[52:55], v[140:143]
    v_mfma_f32_16x16x32_bf16 v[160:163], v[100:103], v[56:59], v[160:163]
    v_mfma_f32_16x16x32_bf16 v[180:183], v[100:103], v[60:63], v[180:183]
done_down0_kernel_4:
    s_nop 7
    s_barrier
    v_lshlrev_b32 v184, 4, v1
    s_mul_i32 s58, s5, 20480
    v_add_u32 v3, s58, v184
    ds_write_b128 v3, v[104:107] offset:0
    ds_write_b128 v3, v[108:111] offset:1024
    ds_write_b128 v3, v[112:115] offset:2048
    ds_write_b128 v3, v[116:119] offset:3072
    ds_write_b128 v3, v[120:123] offset:4096
    ds_write_b128 v3, v[124:127] offset:5120
    ds_write_b128 v3, v[128:131] offset:6144
    ds_write_b128 v3, v[132:135] offset:7168
    ds_write_b128 v3, v[136:139] offset:8192
    ds_write_b128 v3, v[140:143] offset:9216
    ds_write_b128 v3, v[144:147] offset:10240
    ds_write_b128 v3, v[148:151] offset:11264
    ds_write_b128 v3, v[152:155] offset:12288
    ds_write_b128 v3, v[156:159] offset:13312
    ds_write_b128 v3, v[160:163] offset:14336
    ds_write_b128 v3, v[164:167] offset:15360
    ds_write_b128 v3, v[168:171] offset:16384
    ds_write_b128 v3, v[172:175] offset:17408
    ds_write_b128 v3, v[176:179] offset:18432
    ds_write_b128 v3, v[180:183] offset:19456
    s_waitcnt lgkmcnt(0)
    s_barrier
    s_mul_i32 s58, s5, 5120
    v_add_u32 v3, s58, v184
    v_add_u32 v4, 40960, v3
    ds_read_b128 v[104:107], v3 offset:0
    ds_read_b128 v[108:111], v3 offset:1024
    ds_read_b128 v[112:115], v3 offset:2048
    ds_read_b128 v[116:119], v3 offset:3072
    ds_read_b128 v[120:123], v3 offset:4096
    ds_read_b128 v[32:35], v3 offset:20480
    ds_read_b128 v[36:39], v3 offset:21504
    ds_read_b128 v[40:43], v3 offset:22528
    ds_read_b128 v[44:47], v3 offset:23552
    ds_read_b128 v[48:51], v3 offset:24576
    ds_read_b128 v[52:55], v4 offset:0
    ds_read_b128 v[56:59], v4 offset:1024
    ds_read_b128 v[60:63], v4 offset:2048
    ds_read_b128 v[64:67], v4 offset:3072
    ds_read_b128 v[68:71], v4 offset:4096
    ds_read_b128 v[72:75], v4 offset:20480
    ds_read_b128 v[76:79], v4 offset:21504
    ds_read_b128 v[80:83], v4 offset:22528
    ds_read_b128 v[84:87], v4 offset:23552
    ds_read_b128 v[88:91], v4 offset:24576
    s_waitcnt lgkmcnt(0)
    v_add_f32 v104, v104, v32
    v_add_f32 v104, v104, v52
    v_add_f32 v104, v104, v72
    v_add_f32 v105, v105, v33
    v_add_f32 v105, v105, v53
    v_add_f32 v105, v105, v73
    v_add_f32 v106, v106, v34
    v_add_f32 v106, v106, v54
    v_add_f32 v106, v106, v74
    v_add_f32 v107, v107, v35
    v_add_f32 v107, v107, v55
    v_add_f32 v107, v107, v75
    v_add_f32 v108, v108, v36
    v_add_f32 v108, v108, v56
    v_add_f32 v108, v108, v76
    v_add_f32 v109, v109, v37
    v_add_f32 v109, v109, v57
    v_add_f32 v109, v109, v77
    v_add_f32 v110, v110, v38
    v_add_f32 v110, v110, v58
    v_add_f32 v110, v110, v78
    v_add_f32 v111, v111, v39
    v_add_f32 v111, v111, v59
    v_add_f32 v111, v111, v79
    v_add_f32 v112, v112, v40
    v_add_f32 v112, v112, v60
    v_add_f32 v112, v112, v80
    v_add_f32 v113, v113, v41
    v_add_f32 v113, v113, v61
    v_add_f32 v113, v113, v81
    v_add_f32 v114, v114, v42
    v_add_f32 v114, v114, v62
    v_add_f32 v114, v114, v82
    v_add_f32 v115, v115, v43
    v_add_f32 v115, v115, v63
    v_add_f32 v115, v115, v83
    v_add_f32 v116, v116, v44
    v_add_f32 v116, v116, v64
    v_add_f32 v116, v116, v84
    v_add_f32 v117, v117, v45
    v_add_f32 v117, v117, v65
    v_add_f32 v117, v117, v85
    v_add_f32 v118, v118, v46
    v_add_f32 v118, v118, v66
    v_add_f32 v118, v118, v86
    v_add_f32 v119, v119, v47
    v_add_f32 v119, v119, v67
    v_add_f32 v119, v119, v87
    v_add_f32 v120, v120, v48
    v_add_f32 v120, v120, v68
    v_add_f32 v120, v120, v88
    v_add_f32 v121, v121, v49
    v_add_f32 v121, v121, v69
    v_add_f32 v121, v121, v89
    v_add_f32 v122, v122, v50
    v_add_f32 v122, v122, v70
    v_add_f32 v122, v122, v90
    v_add_f32 v123, v123, v51
    v_add_f32 v123, v123, v71
    v_add_f32 v123, v123, v91
    v_mov_b32 v136, 0
    v_mov_b32 v137, 0
    v_lshlrev_b32 v140, 16, v8
    v_add_f32 v128, v104, v140
    v_and_b32 v140, 0xffff0000, v8
    v_add_f32 v129, v105, v140
    v_lshlrev_b32 v140, 16, v9
    v_add_f32 v130, v106, v140
    v_and_b32 v140, 0xffff0000, v9
    v_add_f32 v131, v107, v140
    v_lshlrev_b32 v140, 16, v10
    v_add_f32 v132, v108, v140
    v_and_b32 v140, 0xffff0000, v10
    v_add_f32 v133, v109, v140
    v_lshlrev_b32 v140, 16, v11
    v_add_f32 v134, v110, v140
    v_and_b32 v140, 0xffff0000, v11
    v_add_f32 v135, v111, v140
    v_cvt_pk_bf16_f32 v8, v128, v129
    v_cvt_pk_bf16_f32 v9, v130, v131
    v_cvt_pk_bf16_f32 v10, v132, v133
    v_cvt_pk_bf16_f32 v11, v134, v135
    buffer_store_dwordx4 v[8:11], v20, s[24:27], 0 offen offset:0
    v_lshlrev_b32 v140, 16, v8
    v_and_b32 v142, 0xffff0000, v8
    v_add_f32 v136, v136, v140
    v_fmac_f32 v137, v140, v140
    v_add_f32 v136, v136, v142
    v_fmac_f32 v137, v142, v142
    v_lshlrev_b32 v140, 16, v9
    v_and_b32 v142, 0xffff0000, v9
    v_add_f32 v136, v136, v140
    v_fmac_f32 v137, v140, v140
    v_add_f32 v136, v136, v142
    v_fmac_f32 v137, v142, v142
    v_lshlrev_b32 v140, 16, v10
    v_and_b32 v142, 0xffff0000, v10
    v_add_f32 v136, v136, v140
    v_fmac_f32 v137, v140, v140
    v_add_f32 v136, v136, v142
    v_fmac_f32 v137, v142, v142
    v_lshlrev_b32 v140, 16, v11
    v_and_b32 v142, 0xffff0000, v11
    v_add_f32 v136, v136, v140
    v_fmac_f32 v137, v140, v140
    v_add_f32 v136, v136, v142
    v_fmac_f32 v137, v142, v142
    v_lshlrev_b32 v140, 16, v12
    v_add_f32 v128, v112, v140
    v_and_b32 v140, 0xffff0000, v12
    v_add_f32 v129, v113, v140
    v_lshlrev_b32 v140, 16, v13
    v_add_f32 v130, v114, v140
    v_and_b32 v140, 0xffff0000, v13
    v_add_f32 v131, v115, v140
    v_lshlrev_b32 v140, 16, v14
    v_add_f32 v132, v116, v140
    v_and_b32 v140, 0xffff0000, v14
    v_add_f32 v133, v117, v140
    v_lshlrev_b32 v140, 16, v15
    v_add_f32 v134, v118, v140
    v_and_b32 v140, 0xffff0000, v15
    v_add_f32 v135, v119, v140
    v_cvt_pk_bf16_f32 v12, v128, v129
    v_cvt_pk_bf16_f32 v13, v130, v131
    v_cvt_pk_bf16_f32 v14, v132, v133
    v_cvt_pk_bf16_f32 v15, v134, v135
    buffer_store_dwordx4 v[12:15], v20, s[24:27], 0 offen offset:64
    v_lshlrev_b32 v140, 16, v12
    v_and_b32 v142, 0xffff0000, v12
    v_add_f32 v136, v136, v140
    v_fmac_f32 v137, v140, v140
    v_add_f32 v136, v136, v142
    v_fmac_f32 v137, v142, v142
    v_lshlrev_b32 v140, 16, v13
    v_and_b32 v142, 0xffff0000, v13
    v_add_f32 v136, v136, v140
    v_fmac_f32 v137, v140, v140
    v_add_f32 v136, v136, v142
    v_fmac_f32 v137, v142, v142
    v_lshlrev_b32 v140, 16, v14
    v_and_b32 v142, 0xffff0000, v14
    v_add_f32 v136, v136, v140
    v_fmac_f32 v137, v140, v140
    v_add_f32 v136, v136, v142
    v_fmac_f32 v137, v142, v142
    v_lshlrev_b32 v140, 16, v15
    v_and_b32 v142, 0xffff0000, v15
    v_add_f32 v136, v136, v140
    v_fmac_f32 v137, v140, v140
    v_add_f32 v136, v136, v142
    v_fmac_f32 v137, v142, v142
    v_lshlrev_b32 v140, 16, v16
    v_add_f32 v128, v120, v140
    v_and_b32 v140, 0xffff0000, v16
    v_add_f32 v129, v121, v140
    v_lshlrev_b32 v140, 16, v17
    v_add_f32 v130, v122, v140
    v_and_b32 v140, 0xffff0000, v17
    v_add_f32 v131, v123, v140
    v_cvt_pk_bf16_f32 v16, v128, v129
    v_cvt_pk_bf16_f32 v17, v130, v131
    buffer_store_dwordx2 v[16:17], v21, s[24:27], 0 offen offset:128
    v_lshlrev_b32 v140, 16, v16
    v_and_b32 v142, 0xffff0000, v16
    v_add_f32 v136, v136, v140
    v_fmac_f32 v137, v140, v140
    v_add_f32 v136, v136, v142
    v_fmac_f32 v137, v142, v142
    v_lshlrev_b32 v140, 16, v17
    v_and_b32 v142, 0xffff0000, v17
    v_add_f32 v136, v136, v140
    v_fmac_f32 v137, v140, v140
    v_add_f32 v136, v136, v142
    v_fmac_f32 v137, v142, v142
    v_mov_b32 v140, v136
    v_mov_b32 v141, v137
    s_nop 1
    v_permlane16_swap_b32 v136, v140
    v_permlane16_swap_b32 v137, v141
    v_add_f32 v136, v136, v140
    v_add_f32 v137, v137, v141
    v_mov_b32 v140, v136
    v_mov_b32 v141, v137
    s_nop 1
    v_permlane32_swap_b32 v136, v140
    v_permlane32_swap_b32 v137, v141
    v_add_f32 v136, v136, v140
    v_add_f32 v137, v137, v141
    s_lshl_b32 s58, s5, 4
    s_add_u32 s58, s58, s56
    v_add_u32 v140, s58, v1
    v_lshlrev_b32 v140, 6, v140
    s_lshl_b32 s58, s4, 3
    s_add_u32 s58, s58, 0x8000
    v_add_u32 v140, s58, v140
    v_cmp_gt_u32 vcc, 16, v1
    s_and_saveexec_b64 s[60:61], vcc
    s_cbranch_execz st_down0_kernel_9
    buffer_store_dwordx2 v[136:137], v140, s[20:23], 0 offen
st_down0_kernel_9:
    s_mov_b64 exec, s[60:61]
end_down0_kernel_1:
    s_endpgm
.globl qkv1_kernel
.p2align 8
.type qkv1_kernel,@function
qkv1_kernel:
    s_cmp_ge_u32 s2, 240
    s_cbranch_scc1 end_qkv1_kernel_1
    s_load_dwordx16 s[64:79], s[0:1], 0
    s_load_dwordx4 s[80:83], s[0:1], 64
    s_and_b32 s3, s2, 15
    s_lshr_b32 s4, s2, 4
    v_and_b32 v1, 63, v0
    v_lshrrev_b32 v2, 6, v0
    s_nop 0
    v_readfirstlane_b32 s5, v2
    s_lshr_b32 s62, s5, 2
    s_and_b32 s5, s5, 3
    s_mul_i32 s56, s3, 128
    s_mul_i32 s57, s4, 128
    s_lshr_b32 s6, s5, 1
    s_and_b32 s7, s5, 1
    s_mov_b32 s58, 1280
    v_lshrrev_b32 v3, 4, v1
    v_xor_b32 v3, v3, v1
    v_and_b32 v3, 7, v3
    v_lshrrev_b32 v4, 3, v1
    v_add_u32 v4, s56, v4
    v_mul_lo_u32 v5, v4, s58
    v_lshl_add_u32 v5, v3, 4, v5
    v_lshrrev_b32 v3, 4, v1
    v_add_u32 v3, 4, v3
    v_xor_b32 v3, v3, v1
    v_and_b32 v3, 7, v3
    v_lshrrev_b32 v4, 3, v1
    v_add_u32 v4, s56, v4
    v_mul_lo_u32 v6, v4, s58
    v_lshl_add_u32 v6, v3, 4, v6
    v_lshrrev_b32 v3, 4, v1
    v_lshlrev_b32 v4, 2, v3
    v_xor_b32 v4, v4, v1
    v_and_b32 v4, 15, v4
    v_mul_u32_u24 v7, 3840, v3
    v_lshl_add_u32 v7, v4, 4, v7
    s_lshl_b32 s58, s57, 1
    v_add_u32 v7, s58, v7
    s_lshl_b32 s52, s5, 12
    s_mul_i32 s48, s5, 40960
    s_mul_i32 s49, s5, 61440
    s_mov_b32 s50, 2048
    s_mov_b32 s51, 2048
    s_waitcnt lgkmcnt(0)
    s_add_u32 s8, s82, 0x1300000
    s_addc_u32 s9, s83, 0
    s_and_b32 s9, s9, 0xffff
    s_mov_b32 s10, 0x280000
    s_mov_b32 s11, 0x20000
    s_mov_b32 s12, s66
    s_and_b32 s13, s67, 0xffff
    s_mov_b32 s14, 0x258000
    s_mov_b32 s15, 0x20000
    s_cmp_eq_u32 s62, 0
    s_cbranch_scc1 comp_qkv1_kernel_2
    s_add_u32 s53, s50, s52
    s_add_u32 m0, s53, 0
    s_add_u32 s54, s48, 0
    buffer_load_dwordx4 v5, s[8:11], s54 offen lds
    s_add_u32 m0, s53, 16384
    s_add_u32 s54, s49, 0
    buffer_load_dwordx4 v7, s[12:15], s54 offen lds
    s_add_u32 s53, s50, s52
    s_add_u32 m0, s53, 1024
    s_add_u32 s54, s48, 10240
    buffer_load_dwordx4 v6, s[8:11], s54 offen lds
    s_add_u32 m0, s53, 17408
    s_add_u32 s54, s49, 15360
    buffer_load_dwordx4 v7, s[12:15], s54 offen lds
    s_add_u32 s53, s50, s52
    s_add_u32 m0, s53, 2048
    s_add_u32 s54, s48, 20480
    buffer_load_dwordx4 v5, s[8:11], s54 offen lds
    s_add_u32 m0, s53, 18432
    s_add_u32 s54, s49, 30720
    buffer_load_dwordx4 v7, s[12:15], s54 offen lds
    s_add_u32 s53, s50, s52
    s_add_u32 m0, s53, 3072
    s_add_u32 s54, s48, 30720
    buffer_load_dwordx4 v6, s[8:11], s54 offen lds
    s_add_u32 m0, s53, 19456
    s_add_u32 s54, s49, 46080
    buffer_load_dwordx4 v7, s[12:15], s54 offen lds
    s_add_u32 s48, s48, 128
    s_add_u32 s49, s49, 245760
    s_add_u32 s50, s50, 32768
    s_cmp_eq_u32 s50, 133120
    s_cselect_b32 s50, 2048, s50
    s_add_u32 s53, s50, s52
    s_add_u32 m0, s53, 0
    s_add_u32 s54, s48, 0
    buffer_load_dwordx4 v5, s[8:11], s54 offen lds
    s_add_u32 m0, s53, 16384
    s_add_u32 s54, s49, 0
    buffer_load_dwordx4 v7, s[12:15], s54 offen lds
    s_add_u32 s53, s50, s52
    s_add_u32 m0, s53, 1024
    s_add_u32 s54, s48, 10240
    buffer_load_dwordx4 v6, s[8:11], s54 offen lds
    s_add_u32 m0, s53, 17408
    s_add_u32 s54, s49, 15360
    buffer_load_dwordx4 v7, s[12:15], s54 offen lds
    s_add_u32 s53, s50, s52
    s_add_u32 m0, s53, 2048
    s_add_u32 s54, s48, 20480
    buffer_load_dwordx4 v5, s[8:11], s54 offen lds
    s_add_u32 m0, s53, 18432
    s_add_u32 s54, s49, 30720
    buffer_load_dwordx4 v7, s[12:15], s54 offen lds
    s_add_u32 s53, s50, s52
    s_add_u32 m0, s53, 3072
    s_add_u32 s54, s48, 30720
    buffer_load_dwordx4 v6, s[8:11], s54 offen lds
    s_add_u32 m0, s53, 19456
    s_add_u32 s54, s49, 46080
    buffer_load_dwordx4 v7, s[12:15], s54 offen lds
    s_add_u32 s48, s48, 128
    s_add_u32 s49, s49, 245760
    s_add_u32 s50, s50, 32768
    s_cmp_eq_u32 s50, 133120
    s_cselect_b32 s50, 2048, s50
    s_add_u32 s53, s50, s52
    s_add_u32 m0, s53, 0
    s_add_u32 s54, s48, 0
    buffer_load_dwordx4 v5, s[8:11], s54 offen lds
    s_add_u32 m0, s53, 16384
    s_add_u32 s54, s49, 0
    buffer_load_dwordx4 v7, s[12:15], s54 offen lds
    s_add_u32 s53, s50, s52
    s_add_u32 m0, s53, 1024
    s_add_u32 s54, s48, 10240
    buffer_load_dwordx4 v6, s[8:11], s54 offen lds
    s_add_u32 m0, s53, 17408
    s_add_u32 s54, s49, 15360
    buffer_load_dwordx4 v7, s[12:15], s54 offen lds
    s_add_u32 s53, s50, s52
    s_add_u32 m0, s53, 2048
    s_add_u32 s54, s48, 20480
    buffer_load_dwordx4 v5, s[8:11], s54 offen lds
    s_add_u32 m0, s53, 18432
    s_add_u32 s54, s49, 30720
    buffer_load_dwordx4 v7, s[12:15], s54 offen lds
    s_add_u32 s53, s50, s52
    s_add_u32 m0, s53, 3072
    s_add_u32 s54, s48, 30720
    buffer_load_dwordx4 v6, s[8:11], s54 offen lds
    s_add_u32 m0, s53, 19456
    s_add_u32 s54, s49, 46080
    buffer_load_dwordx4 v7, s[12:15], s54 offen lds
    s_add_u32 s48, s48, 128
    s_add_u32 s49, s49, 245760
    s_add_u32 s50, s50, 32768
    s_cmp_eq_u32 s50, 133120
    s_cselect_b32 s50, 2048, s50
    s_waitcnt vmcnt(16)
    s_barrier
    s_mov_b32 s55, 7
ld_qkv1_kernel_3:
    s_waitcnt vmcnt(8)
    s_barrier
    s_add_u32 s53, s50, s52
    s_add_u32 m0, s53, 0
    s_add_u32 s54, s48, 0
    buffer_load_dwordx4 v5, s[8:11], s54 offen lds
    s_add_u32 m0, s53, 16384
    s_add_u32 s54, s49, 0
    buffer_load_dwordx4 v7, s[12:15], s54 offen lds
    s_add_u32 s53, s50, s52
    s_add_u32 m0, s53, 1024
    s_add_u32 s54, s48, 10240
    buffer_load_dwordx4 v6, s[8:11], s54 offen lds
    s_add_u32 m0, s53, 17408
    s_add_u32 s54, s49, 15360
    buffer_load_dwordx4 v7, s[12:15], s54 offen lds
    s_add_u32 s53, s50, s52
    s_add_u32 m0, s53, 2048
    s_add_u32 s54, s48, 20480
    buffer_load_dwordx4 v5, s[8:11], s54 offen lds
    s_add_u32 m0, s53, 18432
    s_add_u32 s54, s49, 30720
    buffer_load_dwordx4 v7, s[12:15], s54 offen lds
    s_add_u32 s53, s50, s52
    s_add_u32 m0, s53, 3072
    s_add_u32 s54, s48, 30720
    buffer_load_dwordx4 v6, s[8:11], s54 offen lds
    s_add_u32 m0, s53, 19456
    s_add_u32 s54, s49, 46080
    buffer_load_dwordx4 v7, s[12:15], s54 offen lds
    s_add_u32 s48, s48, 128
    s_add_u32 s49, s49, 245760
    s_add_u32 s50, s50, 32768
    s_cmp_eq_u32 s50, 133120
    s_cselect_b32 s50, 2048, s50
    s_sub_u32 s55, s55, 1
    s_cmp_lg_u32 s55, 0
    s_cbranch_scc1 ld_qkv1_kernel_3
    s_waitcnt vmcnt(8)
    s_barrier
    s_waitcnt vmcnt(0)
    s_barrier
    s_endpgm
comp_qkv1_kernel_2:
    s_mov_b32 s20, s82
    s_and_b32 s21, s83, 0xffff
    s_mov_b32 s22, 0x100000
    s_mov_b32 s23, 0x20000
    v_add_u32 v25, s56, v0
    v_lshlrev_b32 v25, 6, v25
    v_add_u32 v25, 0x8000, v25
    buffer_load_dwordx4 v[8:11], v25, s[20:23], 0 offen offset:0
    buffer_load_dwordx4 v[12:15], v25, s[20:23], 0 offen offset:16
    buffer_load_dwordx4 v[16:19], v25, s[20:23], 0 offen offset:32
    buffer_load_dwordx4 v[20:23], v25, s[20:23], 0 offen offset:48
    v_add_u32 v26, s57, v0
    v_lshlrev_b32 v26, 2, v26
    v_add_u32 v26, 0x40000, v26
    buffer_load_dword v24, v26, s[20:23], 0 offen
    s_mov_b32 s58, 21504
    buffer_load_dword v27, v26, s[20:23], s58 offen
    s_mov_b32 s58, 43008
    buffer_load_dword v28, v26, s[20:23], s58 offen
    s_mov_b32 s58, 64512
    buffer_load_dword v29, v26, s[20:23], s58 offen
    v_lshrrev_b32 v42, 5, v1
    v_and_b32 v43, 31, v1
    s_lshl_b32 s58, s6, 13
    v_bfe_u32 v3, v43, 1, 3
    v_add_u32 v4, 0, v42
    v_xor_b32 v3, v3, v4
    v_lshlrev_b32 v4, 7, v43
    v_lshl_add_u32 v30, v3, 4, v4
    v_add_u32 v30, s58, v30
    v_bfe_u32 v3, v43, 1, 3
    v_add_u32 v4, 2, v42
    v_xor_b32 v3, v3, v4
    v_lshlrev_b32 v4, 7, v43
    v_lshl_add_u32 v31, v3, 4, v4
    v_add_u32 v31, s58, v31
    v_bfe_u32 v3, v43, 1, 3
    v_add_u32 v4, 4, v42
    v_xor_b32 v3, v3, v4
    v_lshlrev_b32 v4, 7, v43
    v_lshl_add_u32 v32, v3, 4, v4
    v_add_u32 v32, s58, v32
    v_bfe_u32 v3, v43, 1, 3
    v_add_u32 v4, 6, v42
    v_xor_b32 v3, v3, v4
    v_lshlrev_b32 v4, 7, v43
    v_lshl_add_u32 v33, v3, 4, v4
    v_add_u32 v33, s58, v33
    v_bfe_u32 v44, v1, 2, 2
    s_lshl_b32 s58, s7, 1
    s_add_u32 s58, s58, 0
    v_xor_b32 v3, s58, v44
    v_lshlrev_b32 v3, 6, v3
    v_lshl_add_u32 v3, v44, 8, v3
    v_lshl_add_u32 v3, v42, 11, v3
    v_and_b32 v4, 1, v1
    v_lshl_add_u32 v3, v4, 5, v3
    v_bfe_u32 v4, v1, 4, 1
    v_lshl_add_u32 v3, v4, 4, v3
    v_bfe_u32 v4, v1, 1, 1
    v_lshl_add_u32 v3, v4, 3, v3
    v_add_u32 v34, 16384, v3
    s_lshl_b32 s58, s7, 1
    s_add_u32 s58, s58, 1
    v_xor_b32 v3, s58, v44
    v_lshlrev_b32 v3, 6, v3
    v_lshl_add_u32 v3, v44, 8, v3
    v_lshl_add_u32 v3, v42, 11, v3
    v_and_b32 v4, 1, v1
    v_lshl_add_u32 v3, v4, 5, v3
    v_bfe_u32 v4, v1, 4, 1
    v_lshl_add_u32 v3, v4, 4, v3
    v_bfe_u32 v4, v1, 1, 1
    v_lshl_add_u32 v3, v4, 3, v3
    v_add_u32 v35, 16384, v3
    s_add_u32 s24, s82, 0x100000
    s_addc_u32 s25, s83, 0
    s_and_b32 s25, s25, 0xffff
    s_mov_b32 s26, 0xc00000
    s_mov_b32 s27, 0x20000
    s_cmp_ge_u32 s4, 10
    s_cbranch_scc1 vpath_qkv1_kernel_4
    s_lshl_b32 s58, s4, 5
    s_lshl_b32 s60, s7, 4
    s_add_u32 s58, s58, s60
    s_cmp_lt_u32 s4, 5
    s_cselect_b32 s61, 0, 160
    s_cselect_b32 s60, 0, 0x400000
    s_sub_u32 s58, s58, s61
    s_mov_b32 s61, 52429
    v_lshl_add_u32 v217, v42, 2, s58
    v_add_u32 v217, 0, v217
    v_mul_lo_u32 v218, v217, s61
    v_lshrrev_b32 v218, 18, v218
    v_mul_u32_u24 v219, 5, v218
    v_sub_u32 v219, v217, v219
    v_lshlrev_b32 v168, 17, v218
    v_lshrrev_b32 v217, 2, v219
    v_lshl_add_u32 v168, v217, 10, v168
    v_bfe_u32 v217, v219, 1, 1
    v_lshl_add_u32 v168, v217, 9, v168
    v_and_b32 v217, 1, v219
    v_lshl_add_u32 v168, v217, 3, v168
    v_add_u32 v168, s60, v168
    v_lshl_add_u32 v217, v42, 2, s58
    v_add_u32 v217, 1, v217
    v_mul_lo_u32 v218, v217, s61
    v_lshrrev_b32 v218, 18, v218
    v_mul_u32_u24 v219, 5, v218
    v_sub_u32 v219, v217, v219
    v_lshlrev_b32 v169, 17, v218
    v_lshrrev_b32 v217, 2, v219
    v_lshl_add_u32 v169, v217, 10, v169
    v_bfe_u32 v217, v219, 1, 1
    v_lshl_add_u32 v169, v217, 9, v169
    v_and_b32 v217, 1, v219
    v_lshl_add_u32 v169, v217, 3, v169
    v_add_u32 v169, s60, v169
    v_lshl_add_u32 v217, v42, 2, s58
    v_add_u32 v217, 2, v217
    v_mul_lo_u32 v218, v217, s61
    v_lshrrev_b32 v218, 18, v218
    v_mul_u32_u24 v219, 5, v218
    v_sub_u32 v219, v217, v219
    v_lshlrev_b32 v170, 17, v218
    v_lshrrev_b32 v217, 2, v219
    v_lshl_add_u32 v170, v217, 10, v170
    v_bfe_u32 v217, v219, 1, 1
    v_lshl_add_u32 v170, v217, 9, v170
    v_and_b32 v217, 1, v219
    v_lshl_add_u32 v170, v217, 3, v170
    v_add_u32 v170, s60, v170
    v_lshl_add_u32 v217, v42, 2, s58
    v_add_u32 v217, 3, v217
    v_mul_lo_u32 v218, v217, s61
    v_lshrrev_b32 v218, 18, v218
    v_mul_u32_u24 v219, 5, v218
    v_sub_u32 v219, v217, v219
    v_lshlrev_b32 v171, 17, v218
    v_lshrrev_b32 v217, 2, v219
    v_lshl_add_u32 v171, v217, 10, v171
    v_bfe_u32 v217, v219, 1, 1
    v_lshl_add_u32 v171, v217, 9, v171
    v_and_b32 v217, 1, v219
    v_lshl_add_u32 v171, v217, 3, v171
    v_add_u32 v171, s60, v171
    v_lshl_add_u32 v217, v42, 2, s58
    v_add_u32 v217, 8, v217
    v_mul_lo_u32 v218, v217, s61
    v_lshrrev_b32 v218, 18, v218
    v_mul_u32_u24 v219, 5, v218
    v_sub_u32 v219, v217, v219
    v_lshlrev_b32 v172, 17, v218
    v_lshrrev_b32 v217, 2, v219
    v_lshl_add_u32 v172, v217, 10, v172
    v_bfe_u32 v217, v219, 1, 1
    v_lshl_add_u32 v172, v217, 9, v172
    v_and_b32 v217, 1, v219
    v_lshl_add_u32 v172, v217, 3, v172
    v_add_u32 v172, s60, v172
    v_lshl_add_u32 v217, v42, 2, s58
    v_add_u32 v217, 9, v217
    v_mul_lo_u32 v218, v217, s61
    v_lshrrev_b32 v218, 18, v218
    v_mul_u32_u24 v219, 5, v218
    v_sub_u32 v219, v217, v219
    v_lshlrev_b32 v173, 17, v218
    v_lshrrev_b32 v217, 2, v219
    v_lshl_add_u32 v173, v217, 10, v173
    v_bfe_u32 v217, v219, 1, 1
    v_lshl_add_u32 v173, v217, 9, v173
    v_and_b32 v217, 1, v219
    v_lshl_add_u32 v173, v217, 3, v173
    v_add_u32 v173, s60, v173
    v_lshl_add_u32 v217, v42, 2, s58
    v_add_u32 v217, 10, v217
    v_mul_lo_u32 v218, v217, s61
    v_lshrrev_b32 v218, 18, v218
    v_mul_u32_u24 v219, 5, v218
    v_sub_u32 v219, v217, v219
    v_lshlrev_b32 v174, 17, v218
    v_lshrrev_b32 v217, 2, v219
    v_lshl_add_u32 v174, v217, 10, v174
    v_bfe_u32 v217, v219, 1, 1
    v_lshl_add_u32 v174, v217, 9, v174
    v_and_b32 v217, 1, v219
    v_lshl_add_u32 v174, v217, 3, v174
    v_add_u32 v174, s60, v174
    v_lshl_add_u32 v217, v42, 2, s58
    v_add_u32 v217, 11, v217
    v_mul_lo_u32 v218, v217, s61
    v_lshrrev_b32 v218, 18, v218
    v_mul_u32_u24 v219, 5, v218
    v_sub_u32 v219, v217, v219
    v_lshlrev_b32 v175, 17, v218
    v_lshrrev_b32 v217, 2, v219
    v_lshl_add_u32 v175, v217, 10, v175
    v_bfe_u32 v217, v219, 1, 1
    v_lshl_add_u32 v175, v217, 9, v175
    v_and_b32 v217, 1, v219
    v_lshl_add_u32 v175, v217, 3, v175
    v_add_u32 v175, s60, v175
    s_lshl_b32 s58, s3, 2
    s_lshl_b32 s60, s6, 1
    s_add_u32 s58, s58, s60
    s_lshl_b32 s58, s58, 11
    v_lshlrev_b32 v164, 4, v43
    v_add_u32 v164, s58, v164
    v_add_u32 v168, v168, v164
    v_add_u32 v169, v169, v164
    v_add_u32 v170, v170, v164
    v_add_u32 v171, v171, v164
    v_add_u32 v172, v172, v164
    v_add_u32 v173, v173, v164
    v_add_u32 v174, v174, v164
    v_add_u32 v175, v175, v164
    s_waitcnt lgkmcnt(0)
    s_barrier
    v_add_u32 v36, s51, v30
    v_add_u32 v37, s51, v31
    v_add_u32 v38, s51, v32
    v_add_u32 v39, s51, v33
    v_add_u32 v40, s51, v34
    v_add_u32 v41, s51, v35
    s_add_u32 s51, s51, 32768
    s_cmp_eq_u32 s51, 133120
    s_cselect_b32 s51, 2048, s51
    ds_read_b128 v[48:51], v36 offset:0
    ds_read_b128 v[52:55], v36 offset:4096
    ds_read_b64_tr_b16 v[72:73], v40 offset:0
    ds_read_b64_tr_b16 v[74:75], v40 offset:1024
    ds_read_b64_tr_b16 v[76:77], v41 offset:0
    ds_read_b64_tr_b16 v[78:79], v41 offset:1024
    ds_read_b128 v[56:59], v37 offset:0
    ds_read_b128 v[60:63], v37 offset:4096
    ds_read_b64_tr_b16 v[80:81], v40 offset:4096
    ds_read_b64_tr_b16 v[82:83], v40 offset:5120
    ds_read_b64_tr_b16 v[84:85], v41 offset:4096
    ds_read_b64_tr_b16 v[86:87], v41 offset:5120
    s_waitcnt lgkmcnt(6)
    ds_read_b128 v[64:67], v38 offset:0
    ds_read_b128 v[68:71], v38 offset:4096
    v_mfma_f32_32x32x16_bf16 v[96:111], v[72:75], v[48:51], 0
    ds_read_b64_tr_b16 v[88:89], v40 offset:8192
    v_mfma_f32_32x32x16_bf16 v[112:127], v[72:75], v[52:55], 0
    ds_read_b64_tr_b16 v[90:91], v40 offset:9216
    v_mfma_f32_32x32x16_bf16 v[128:143], v[76:79], v[48:51], 0
    ds_read_b64_tr_b16 v[92:93], v41 offset:8192
    v_mfma_f32_32x32x16_bf16 v[144:159], v[76:79], v[52:55], 0
    ds_read_b64_tr_b16 v[94:95], v41 offset:9216
    s_waitcnt lgkmcnt(6)
    ds_read_b128 v[48:51], v39 offset:0
    ds_read_b128 v[52:55], v39 offset:4096
    v_mfma_f32_32x32x16_bf16 v[96:111], v[80:83], v[56:59], v[96:111]
    ds_read_b64_tr_b16 v[72:73], v40 offset:12288
    v_mfma_f32_32x32x16_bf16 v[112:127], v[80:83], v[60:63], v[112:127]
    ds_read_b64_tr_b16 v[74:75], v40 offset:13312
    v_mfma_f32_32x32x16_bf16 v[128:143], v[84:87], v[56:59], v[128:143]
    ds_read_b64_tr_b16 v[76:77], v41 offset:12288
    v_mfma_f32_32x32x16_bf16 v[144:159], v[84:87], v[60:63], v[144:159]
    ds_read_b64_tr_b16 v[78:79], v41 offset:13312
    s_waitcnt lgkmcnt(6)
    s_barrier
    v_add_u32 v36, s51, v30
    v_add_u32 v37, s51, v31
    v_add_u32 v38, s51, v32
    v_add_u32 v39, s51, v33
    v_add_u32 v40, s51, v34
    v_add_u32 v41, s51, v35
    s_add_u32 s51, s51, 32768
    s_cmp_eq_u32 s51, 133120
    s_cselect_b32 s51, 2048, s51
    ds_read_b128 v[56:59], v36 offset:0
    ds_read_b128 v[60:63], v36 offset:4096
    v_mfma_f32_32x32x16_bf16 v[96:111], v[88:91], v[64:67], v[96:111]
    ds_read_b64_tr_b16 v[80:81], v40 offset:0
    v_mfma_f32_32x32x16_bf16 v[112:127], v[88:91], v[68:71], v[112:127]
    ds_read_b64_tr_b16 v[82:83], v40 offset:1024
    v_mfma_f32_32x32x16_bf16 v[128:143], v[92:95], v[64:67], v[128:143]
    ds_read_b64_tr_b16 v[84:85], v41 offset:0
    v_mfma_f32_32x32x16_bf16 v[144:159], v[92:95], v[68:71], v[144:159]
    ds_read_b64_tr_b16 v[86:87], v41 offset:1024
    s_waitcnt lgkmcnt(6)
    ds_read_b128 v[64:67], v37 offset:0
    ds_read_b128 v[68:71], v37 offset:4096
    v_mfma_f32_32x32x16_bf16 v[96:111], v[72:75], v[48:51], v[96:111]
    ds_read_b64_tr_b16 v[88:89], v40 offset:4096
    v_mfma_f32_32x32x16_bf16 v[112:127], v[72:75], v[52:55], v[112:127]
    ds_read_b64_tr_b16 v[90:91], v40 offset:5120
    v_mfma_f32_32x32x16_bf16 v[128:143], v[76:79], v[48:51], v[128:143]
    ds_read_b64_tr_b16 v[92:93], v41 offset:4096
    v_mfma_f32_32x32x16_bf16 v[144:159], v[76:79], v[52:55], v[144:159]
    ds_read_b64_tr_b16 v[94:95], v41 offset:5120
    s_waitcnt lgkmcnt(6)
    s_waitcnt vmcnt(0)
    v_add_f32 v24, v24, v27
    v_add_f32 v24, v24, v28
    v_add_f32 v24, v24, v29
    v_add_f32 v8, v8, v10
    v_add_f32 v9, v9, v11
    v_add_f32 v8, v8, v12
    v_add_f32 v9, v9, v13
    v_add_f32 v8, v8, v14
    v_add_f32 v9, v9, v15
    v_add_f32 v8, v8, v16
    v_add_f32 v9, v9, v17
    v_add_f32 v8, v8, v18
    v_add_f32 v9, v9, v19
    v_add_f32 v8, v8, v20
    v_add_f32 v9, v9, v21
    v_add_f32 v8, v8, v22
    v_add_f32 v9, v9, v23
    v_mul_f32 v8, 0x3acccccd, v8
    v_mul_f32 v9, 0x3acccccd, v9
    v_fma_f32 v9, -v8, v8, v9
    v_max_f32 v9, 0, v9
    v_add_f32 v9, 0x3727c5ac, v9
    v_rsq_f32 v9, v9
    s_nop 0
    v_mul_f32 v8, v8, v9
    v_sub_f32 v8, 0, v8
    v_lshlrev_b32 v3, 3, v0
    v_cmp_gt_u32 vcc, 128, v0
    s_and_saveexec_b64 s[60:61], vcc
    s_cbranch_execz aux_qkv1_kernel_6
    ds_write_b64 v3, v[8:9] offset:0
aux_qkv1_kernel_6:
    s_mov_b64 exec, s[60:61]
    v_lshlrev_b32 v3, 2, v0
    v_cmp_gt_u32 vcc, 128, v0
    s_and_saveexec_b64 s[60:61], vcc
    s_cbranch_execz aux_qkv1_kernel_7
    ds_write_b32 v3, v24 offset:1024
aux_qkv1_kernel_7:
    s_mov_b64 exec, s[60:61]
    s_mov_b32 s55, 2
loop_qkv1_kernel_8:
    ds_read_b128 v[48:51], v38 offset:0
    ds_read_b128 v[52:55], v38 offset:4096
    v_mfma_f32_32x32x16_bf16 v[96:111], v[80:83], v[56:59], v[96:111]
    ds_read_b64_tr_b16 v[72:73], v40 offset:8192
    v_mfma_f32_32x32x16_bf16 v[112:127], v[80:83], v[60:63], v[112:127]
    ds_read_b64_tr_b16 v[74:75], v40 offset:9216
    v_mfma_f32_32x32x16_bf16 v[128:143], v[84:87], v[56:59], v[128:143]
    ds_read_b64_tr_b16 v[76:77], v41 offset:8192
    v_mfma_f32_32x32x16_bf16 v[144:159], v[84:87], v[60:63], v[144:159]
    ds_read_b64_tr_b16 v[78:79], v41 offset:9216
    s_waitcnt lgkmcnt(6)
    ds_read_b128 v[56:59], v39 offset:0
    ds_read_b128 v[60:63], v39 offset:4096
    v_mfma_f32_32x32x16_bf16 v[96:111], v[88:91], v[64:67], v[96:111]
    ds_read_b64_tr_b16 v[80:81], v40 offset:12288
    v_mfma_f32_32x32x16_bf16 v[112:127], v[88:91], v[68:71], v[112:127]
    ds_read_b64_tr_b16 v[82:83], v40 offset:13312
    v_mfma_f32_32x32x16_bf16 v[128:143], v[92:95], v[64:67], v[128:143]
    ds_read_b64_tr_b16 v[84:85], v41 offset:12288
    v_mfma_f32_32x32x16_bf16 v[144:159], v[92:95], v[68:71], v[144:159]
    ds_read_b64_tr_b16 v[86:87], v41 offset:13312
    s_waitcnt lgkmcnt(6)
    s_barrier
    v_add_u32 v36, s51, v30
    v_add_u32 v37, s51, v31
    v_add_u32 v38, s51, v32
    v_add_u32 v39, s51, v33
    v_add_u32 v40, s51, v34
    v_add_u32 v41, s51, v35
    s_add_u32 s51, s51, 32768
    s_cmp_eq_u32 s51, 133120
    s_cselect_b32 s51, 2048, s51
    ds_read_b128 v[64:67], v36 offset:0
    ds_read_b128 v[68:71], v36 offset:4096
    v_mfma_f32_32x32x16_bf16 v[96:111], v[72:75], v[48:51], v[96:111]
    ds_read_b64_tr_b16 v[88:89], v40 offset:0
    v_mfma_f32_32x32x16_bf16 v[112:127], v[72:75], v[52:55], v[112:127]
    ds_read_b64_tr_b16 v[90:91], v40 offset:1024
    v_mfma_f32_32x32x16_bf16 v[128:143], v[76:79], v[48:51], v[128:143]
    ds_read_b64_tr_b16 v[92:93], v41 offset:0
    v_mfma_f32_32x32x16_bf16 v[144:159], v[76:79], v[52:55], v[144:159]
    ds_read_b64_tr_b16 v[94:95], v41 offset:1024
    s_waitcnt lgkmcnt(6)
    ds_read_b128 v[48:51], v37 offset:0
    ds_read_b128 v[52:55], v37 offset:4096
    v_mfma_f32_32x32x16_bf16 v[96:111], v[80:83], v[56:59], v[96:111]
    ds_read_b64_tr_b16 v[72:73], v40 offset:4096
    v_mfma_f32_32x32x16_bf16 v[112:127], v[80:83], v[60:63], v[112:127]
    ds_read_b64_tr_b16 v[74:75], v40 offset:5120
    v_mfma_f32_32x32x16_bf16 v[128:143], v[84:87], v[56:59], v[128:143]
    ds_read_b64_tr_b16 v[76:77], v41 offset:4096
    v_mfma_f32_32x32x16_bf16 v[144:159], v[84:87], v[60:63], v[144:159]
    ds_read_b64_tr_b16 v[78:79], v41 offset:5120
    s_waitcnt lgkmcnt(6)
    ds_read_b128 v[56:59], v38 offset:0
    ds_read_b128 v[60:63], v38 offset:4096
    v_mfma_f32_32x32x16_bf16 v[96:111], v[88:91], v[64:67], v[96:111]
    ds_read_b64_tr_b16 v[80:81], v40 offset:8192
    v_mfma_f32_32x32x16_bf16 v[112:127], v[88:91], v[68:71], v[112:127]
    ds_read_b64_tr_b16 v[82:83], v40 offset:9216
    v_mfma_f32_32x32x16_bf16 v[128:143], v[92:95], v[64:67], v[128:143]
    ds_read_b64_tr_b16 v[84:85], v41 offset:8192
    v_mfma_f32_32x32x16_bf16 v[144:159], v[92:95], v[68:71], v[144:159]
    ds_read_b64_tr_b16 v[86:87], v41 offset:9216
    s_waitcnt lgkmcnt(6)
    ds_read_b128 v[64:67], v39 offset:0
    ds_read_b128 v[68:71], v39 offset:4096
    v_mfma_f32_32x32x16_bf16 v[96:111], v[72:75], v[48:51], v[96:111]
    ds_read_b64_tr_b16 v[88:89], v40 offset:12288
    v_mfma_f32_32x32x16_bf16 v[112:127], v[72:75], v[52:55], v[112:127]
    ds_read_b64_tr_b16 v[90:91], v40 offset:13312
    v_mfma_f32_32x32x16_bf16 v[128:143], v[76:79], v[48:51], v[128:143]
    ds_read_b64_tr_b16 v[92:93], v41 offset:12288
    v_mfma_f32_32x32x16_bf16 v[144:159], v[76:79], v[52:55], v[144:159]
    ds_read_b64_tr_b16 v[94:95], v41 offset:13312
    s_waitcnt lgkmcnt(6)
    s_barrier
    v_add_u32 v36, s51, v30
    v_add_u32 v37, s51, v31
    v_add_u32 v38, s51, v32
    v_add_u32 v39, s51, v33
    v_add_u32 v40, s51, v34
    v_add_u32 v41, s51, v35
    s_add_u32 s51, s51, 32768
    s_cmp_eq_u32 s51, 133120
    s_cselect_b32 s51, 2048, s51
    ds_read_b128 v[48:51], v36 offset:0
    ds_read_b128 v[52:55], v36 offset:4096
    v_mfma_f32_32x32x16_bf16 v[96:111], v[80:83], v[56:59], v[96:111]
    ds_read_b64_tr_b16 v[72:73], v40 offset:0
    v_mfma_f32_32x32x16_bf16 v[112:127], v[80:83], v[60:63], v[112:127]
    ds_read_b64_tr_b16 v[74:75], v40 offset:1024
    v_mfma_f32_32x32x16_bf16 v[128:143], v[84:87], v[56:59], v[128:143]
    ds_read_b64_tr_b16 v[76:77], v41 offset:0
    v_mfma_f32_32x32x16_bf16 v[144:159], v[84:87], v[60:63], v[144:159]
    ds_read_b64_tr_b16 v[78:79], v41 offset:1024
    s_waitcnt lgkmcnt(6)
    ds_read_b128 v[56:59], v37 offset:0
    ds_read_b128 v[60:63], v37 offset:4096
    v_mfma_f32_32x32x16_bf16 v[96:111], v[88:91], v[64:67], v[96:111]
    ds_read_b64_tr_b16 v[80:81], v40 offset:4096
    v_mfma_f32_32x32x16_bf16 v[112:127], v[88:91], v[68:71], v[112:127]
    ds_read_b64_tr_b16 v[82:83], v40 offset:5120
    v_mfma_f32_32x32x16_bf16 v[128:143], v[92:95], v[64:67], v[128:143]
    ds_read_b64_tr_b16 v[84:85], v41 offset:4096
    v_mfma_f32_32x32x16_bf16 v[144:159], v[92:95], v[68:71], v[144:159]
    ds_read_b64_tr_b16 v[86:87], v41 offset:5120
    s_waitcnt lgkmcnt(6)
    ds_read_b128 v[64:67], v38 offset:0
    ds_read_b128 v[68:71], v38 offset:4096
    v_mfma_f32_32x32x16_bf16 v[96:111], v[72:75], v[48:51], v[96:111]
    ds_read_b64_tr_b16 v[88:89], v40 offset:8192
    v_mfma_f32_32x32x16_bf16 v[112:127], v[72:75], v[52:55], v[112:127]
    ds_read_b64_tr_b16 v[90:91], v40 offset:9216
    v_mfma_f32_32x32x16_bf16 v[128:143], v[76:79], v[48:51], v[128:143]
    ds_read_b64_tr_b16 v[92:93], v41 offset:8192
    v_mfma_f32_32x32x16_bf16 v[144:159], v[76:79], v[52:55], v[144:159]
    ds_read_b64_tr_b16 v[94:95], v41 offset:9216
    s_waitcnt lgkmcnt(6)
    ds_read_b128 v[48:51], v39 offset:0
    ds_read_b128 v[52:55], v39 offset:4096
    v_mfma_f32_32x32x16_bf16 v[96:111], v[80:83], v[56:59], v[96:111]
    ds_read_b64_tr_b16 v[72:73], v40 offset:12288
    v_mfma_f32_32x32x16_bf16 v[112:127], v[80:83], v[60:63], v[112:127]
    ds_read_b64_tr_b16 v[74:75], v40 offset:13312
    v_mfma_f32_32x32x16_bf16 v[128:143], v[84:87], v[56:59], v[128:143]
    ds_read_b64_tr_b16 v[76:77], v41 offset:12288
    v_mfma_f32_32x32x16_bf16 v[144:159], v[84:87], v[60:63], v[144:159]
    ds_read_b64_tr_b16 v[78:79], v41 offset:13312
    s_waitcnt lgkmcnt(6)
    s_barrier
    v_add_u32 v36, s51, v30
    v_add_u32 v37, s51, v31
    v_add_u32 v38, s51, v32
    v_add_u32 v39, s51, v33
    v_add_u32 v40, s51, v34
    v_add_u32 v41, s51, v35
    s_add_u32 s51, s51, 32768
    s_cmp_eq_u32 s51, 133120
    s_cselect_b32 s51, 2048, s51
    ds_read_b128 v[56:59], v36 offset:0
    ds_read_b128 v[60:63], v36 offset:4096
    v_mfma_f32_32x32x16_bf16 v[96:111], v[88:91], v[64:67], v[96:111]
    ds_read_b64_tr_b16 v[80:81], v40 offset:0
    v_mfma_f32_32x32x16_bf16 v[112:127], v[88:91], v[68:71], v[112:127]
    ds_read_b64_tr_b16 v[82:83], v40 offset:1024
    v_mfma_f32_32x32x16_bf16 v[128:143], v[92:95], v[64:67], v[128:143]
    ds_read_b64_tr_b16 v[84:85], v41 offset:0
    v_mfma_f32_32x32x16_bf16 v[144:159], v[92:95], v[68:71], v[144:159]
    ds_read_b64_tr_b16 v[86:87], v41 offset:1024
    s_waitcnt lgkmcnt(6)
    ds_read_b128 v[64:67], v37 offset:0
    ds_read_b128 v[68:71], v37 offset:4096
    v_mfma_f32_32x32x16_bf16 v[96:111], v[72:75], v[48:51], v[96:111]
    ds_read_b64_tr_b16 v[88:89], v40 offset:4096
    v_mfma_f32_32x32x16_bf16 v[112:127], v[72:75], v[52:55], v[112:127]
    ds_read_b64_tr_b16 v[90:91], v40 offset:5120
    v_mfma_f32_32x32x16_bf16 v[128:143], v[76:79], v[48:51], v[128:143]
    ds_read_b64_tr_b16 v[92:93], v41 offset:4096
    v_mfma_f32_32x32x16_bf16 v[144:159], v[76:79], v[52:55], v[144:159]
    ds_read_b64_tr_b16 v[94:95], v41 offset:5120
    s_waitcnt lgkmcnt(6)
    s_sub_u32 s55, s55, 1
    s_cmp_lg_u32 s55, 0
    s_cbranch_scc1 loop_qkv1_kernel_8
    ds_read_b128 v[48:51], v38 offset:0
    ds_read_b128 v[52:55], v38 offset:4096
    v_mfma_f32_32x32x16_bf16 v[96:111], v[80:83], v[56:59], v[96:111]
    ds_read_b64_tr_b16 v[72:73], v40 offset:8192
    v_mfma_f32_32x32x16_bf16 v[112:127], v[80:83], v[60:63], v[112:127]
    ds_read_b64_tr_b16 v[74:75], v40 offset:9216
    v_mfma_f32_32x32x16_bf16 v[128:143], v[84:87], v[56:59], v[128:143]
    ds_read_b64_tr_b16 v[76:77], v41 offset:8192
    v_mfma_f32_32x32x16_bf16 v[144:159], v[84:87], v[60:63], v[144:159]
    ds_read_b64_tr_b16 v[78:79], v41 offset:9216
    s_waitcnt lgkmcnt(6)
    ds_read_b128 v[56:59], v39 offset:0
    ds_read_b128 v[60:63], v39 offset:4096
    v_mfma_f32_32x32x16_bf16 v[96:111], v[88:91], v[64:67], v[96:111]
    ds_read_b64_tr_b16 v[80:81], v40 offset:12288
    v_mfma_f32_32x32x16_bf16 v[112:127], v[88:91], v[68:71], v[112:127]
    ds_read_b64_tr_b16 v[82:83], v40 offset:13312
    v_mfma_f32_32x32x16_bf16 v[128:143], v[92:95], v[64:67], v[128:143]
    ds_read_b64_tr_b16 v[84:85], v41 offset:12288
    v_mfma_f32_32x32x16_bf16 v[144:159], v[92:95], v[68:71], v[144:159]
    ds_read_b64_tr_b16 v[86:87], v41 offset:13312
    s_waitcnt lgkmcnt(6)
    s_barrier
    v_add_u32 v36, s51, v30
    v_add_u32 v37, s51, v31
    v_add_u32 v38, s51, v32
    v_add_u32 v39, s51, v33
    v_add_u32 v40, s51, v34
    v_add_u32 v41, s51, v35
    s_add_u32 s51, s51, 32768
    s_cmp_eq_u32 s51, 133120
    s_cselect_b32 s51, 2048, s51
    ds_read_b128 v[64:67], v36 offset:0
    ds_read_b128 v[68:71], v36 offset:4096
    v_mfma_f32_32x32x16_bf16 v[96:111], v[72:75], v[48:51], v[96:111]
    ds_read_b64_tr_b16 v[88:89], v40 offset:0
    v_mfma_f32_32x32x16_bf16 v[112:127], v[72:75], v[52:55], v[112:127]
    ds_read_b64_tr_b16 v[90:91], v40 offset:1024
    v_mfma_f32_32x32x16_bf16 v[128:143], v[76:79], v[48:51], v[128:143]
    ds_read_b64_tr_b16 v[92:93], v41 offset:0
    v_mfma_f32_32x32x16_bf16 v[144:159], v[76:79], v[52:55], v[144:159]
    ds_read_b64_tr_b16 v[94:95], v41 offset:1024
    s_waitcnt lgkmcnt(6)
    ds_read_b128 v[48:51], v37 offset:0
    ds_read_b128 v[52:55], v37 offset:4096
    v_mfma_f32_32x32x16_bf16 v[96:111], v[80:83], v[56:59], v[96:111]
    ds_read_b64_tr_b16 v[72:73], v40 offset:4096
    v_mfma_f32_32x32x16_bf16 v[112:127], v[80:83], v[60:63], v[112:127]
    ds_read_b64_tr_b16 v[74:75], v40 offset:5120
    v_mfma_f32_32x32x16_bf16 v[128:143], v[84:87], v[56:59], v[128:143]
    ds_read_b64_tr_b16 v[76:77], v41 offset:4096
    v_mfma_f32_32x32x16_bf16 v[144:159], v[84:87], v[60:63], v[144:159]
    ds_read_b64_tr_b16 v[78:79], v41 offset:5120
    s_waitcnt lgkmcnt(6)
    ds_read_b128 v[56:59], v38 offset:0
    ds_read_b128 v[60:63], v38 offset:4096
    v_mfma_f32_32x32x16_bf16 v[96:111], v[88:91], v[64:67], v[96:111]
    ds_read_b64_tr_b16 v[80:81], v40 offset:8192
    v_mfma_f32_32x32x16_bf16 v[112:127], v[88:91], v[68:71], v[112:127]
    ds_read_b64_tr_b16 v[82:83], v40 offset:9216
    v_mfma_f32_32x32x16_bf16 v[128:143], v[92:95], v[64:67], v[128:143]
    ds_read_b64_tr_b16 v[84:85], v41 offset:8192
    v_mfma_f32_32x32x16_bf16 v[144:159], v[92:95], v[68:71], v[144:159]
    ds_read_b64_tr_b16 v[86:87], v41 offset:9216
    s_waitcnt lgkmcnt(6)
    ds_read_b128 v[64:67], v39 offset:0
    ds_read_b128 v[68:71], v39 offset:4096
    v_mfma_f32_32x32x16_bf16 v[96:111], v[72:75], v[48:51], v[96:111]
    ds_read_b64_tr_b16 v[88:89], v40 offset:12288
    v_mfma_f32_32x32x16_bf16 v[112:127], v[72:75], v[52:55], v[112:127]
    ds_read_b64_tr_b16 v[90:91], v40 offset:13312
    v_mfma_f32_32x32x16_bf16 v[128:143], v[76:79], v[48:51], v[128:143]
    ds_read_b64_tr_b16 v[92:93], v41 offset:12288
    v_mfma_f32_32x32x16_bf16 v[144:159], v[76:79], v[52:55], v[144:159]
    ds_read_b64_tr_b16 v[94:95], v41 offset:13312
    s_waitcnt lgkmcnt(6)
    s_barrier
    v_add_u32 v36, s51, v30
    v_add_u32 v37, s51, v31
    v_add_u32 v38, s51, v32
    v_add_u32 v39, s51, v33
    v_add_u32 v40, s51, v34
    v_add_u32 v41, s51, v35
    s_add_u32 s51, s51, 32768
    s_cmp_eq_u32 s51, 133120
    s_cselect_b32 s51, 2048, s51
    ds_read_b128 v[48:51], v36 offset:0
    ds_read_b128 v[52:55], v36 offset:4096
    v_mfma_f32_32x32x16_bf16 v[96:111], v[80:83], v[56:59], v[96:111]
    ds_read_b64_tr_b16 v[72:73], v40 offset:0
    v_mfma_f32_32x32x16_bf16 v[112:127], v[80:83], v[60:63], v[112:127]
    ds_read_b64_tr_b16 v[74:75], v40 offset:1024
    v_mfma_f32_32x32x16_bf16 v[128:143], v[84:87], v[56:59], v[128:143]
    ds_read_b64_tr_b16 v[76:77], v41 offset:0
    v_mfma_f32_32x32x16_bf16 v[144:159], v[84:87], v[60:63], v[144:159]
    ds_read_b64_tr_b16 v[78:79], v41 offset:1024
    s_waitcnt lgkmcnt(6)
    ds_read_b128 v[56:59], v37 offset:0
    ds_read_b128 v[60:63], v37 offset:4096
    v_mfma_f32_32x32x16_bf16 v[96:111], v[88:91], v[64:67], v[96:111]
    ds_read_b64_tr_b16 v[80:81], v40 offset:4096
    v_mfma_f32_32x32x16_bf16 v[112:127], v[88:91], v[68:71], v[112:127]
    ds_read_b64_tr_b16 v[82:83], v40 offset:5120
    v_mfma_f32_32x32x16_bf16 v[128:143], v[92:95], v[64:67], v[128:143]
    ds_read_b64_tr_b16 v[84:85], v41 offset:4096
    v_mfma_f32_32x32x16_bf16 v[144:159], v[92:95], v[68:71], v[144:159]
    ds_read_b64_tr_b16 v[86:87], v41 offset:5120
    s_waitcnt lgkmcnt(6)
    ds_read_b128 v[64:67], v38 offset:0
    ds_read_b128 v[68:71], v38 offset:4096
    v_mfma_f32_32x32x16_bf16 v[96:111], v[72:75], v[48:51], v[96:111]
    ds_read_b64_tr_b16 v[88:89], v40 offset:8192
    v_mfma_f32_32x32x16_bf16 v[112:127], v[72:75], v[52:55], v[112:127]
    ds_read_b64_tr_b16 v[90:91], v40 offset:9216
    v_mfma_f32_32x32x16_bf16 v[128:143], v[76:79], v[48:51], v[128:143]
    ds_read_b64_tr_b16 v[92:93], v41 offset:8192
    v_mfma_f32_32x32x16_bf16 v[144:159], v[76:79], v[52:55], v[144:159]
    ds_read_b64_tr_b16 v[94:95], v41 offset:9216
    s_waitcnt lgkmcnt(6)
    ds_read_b128 v[48:51], v39 offset:0
    ds_read_b128 v[52:55], v39 offset:4096
    v_mfma_f32_32x32x16_bf16 v[96:111], v[80:83], v[56:59], v[96:111]
    ds_read_b64_tr_b16 v[72:73], v40 offset:12288
    v_mfma_f32_32x32x16_bf16 v[112:127], v[80:83], v[60:63], v[112:127]
    ds_read_b64_tr_b16 v[74:75], v40 offset:13312
    v_mfma_f32_32x32x16_bf16 v[128:143], v[84:87], v[56:59], v[128:143]
    ds_read_b64_tr_b16 v[76:77], v41 offset:12288
    v_mfma_f32_32x32x16_bf16 v[144:159], v[84:87], v[60:63], v[144:159]
    ds_read_b64_tr_b16 v[78:79], v41 offset:13312
    s_waitcnt lgkmcnt(6)
    v_mfma_f32_32x32x16_bf16 v[96:111], v[88:91], v[64:67], v[96:111]
    v_mfma_f32_32x32x16_bf16 v[112:127], v[88:91], v[68:71], v[112:127]
    v_mfma_f32_32x32x16_bf16 v[128:143], v[92:95], v[64:67], v[128:143]
    v_mfma_f32_32x32x16_bf16 v[144:159], v[92:95], v[68:71], v[144:159]
    s_waitcnt lgkmcnt(0)
    v_mfma_f32_32x32x16_bf16 v[96:111], v[72:75], v[48:51], v[96:111]
    v_mfma_f32_32x32x16_bf16 v[112:127], v[72:75], v[52:55], v[112:127]
    v_mfma_f32_32x32x16_bf16 v[128:143], v[76:79], v[48:51], v[128:143]
    v_mfma_f32_32x32x16_bf16 v[144:159], v[76:79], v[52:55], v[144:159]
    s_nop 7
    s_nop 7
    s_cmp_lt_u32 s4, 5
    s_cselect_b32 s59, 0x3ea52b5c, 1.0
    s_lshl_b32 s58, s6, 9
    v_lshlrev_b32 v216, 3, v43
    v_add_u32 v216, s58, v216
    ds_read_b64 v[160:161], v216 offset:0
    ds_read_b64 v[162:163], v216 offset:256
    s_lshl_b32 s58, s7, 8
    v_lshlrev_b32 v217, 6, v42
    v_add_u32 v217, s58, v217
    ds_read_b128 v[176:179], v217 offset:1024
    ds_read_b128 v[180:183], v217 offset:1040
    ds_read_b128 v[184:187], v217 offset:1056
    ds_read_b128 v[188:191], v217 offset:1072
    ds_read_b128 v[192:195], v217 offset:1152
    ds_read_b128 v[196:199], v217 offset:1168
    ds_read_b128 v[200:203], v217 offset:1184
    ds_read_b128 v[204:207], v217 offset:1200
    s_waitcnt lgkmcnt(0)
    v_mul_f32 v160, s59, v160
    v_mul_f32 v161, s59, v161
    v_mul_f32 v162, s59, v162
    v_mul_f32 v163, s59, v163
    v_mov_b32 v219, 0
    v_pk_mul_f32 v[208:209], v[96:97], v[160:161] op_sel:[0,1] op_sel_hi:[1,1]
    v_pk_mul_f32 v[210:211], v[98:99], v[160:161] op_sel:[0,1] op_sel_hi:[1,1]
    v_pk_fma_f32 v[208:209], v[176:177], v[160:161], v[208:209] op_sel_hi:[1,0,1]
    v_pk_fma_f32 v[210:211], v[178:179], v[160:161], v[210:211] op_sel_hi:[1,0,1]
    v_max3_f32 v219, abs(v208), abs(v209), v219
    v_max3_f32 v219, abs(v210), abs(v211), v219
    v_cvt_pk_bf16_f32 v208, v208, v209
    v_cvt_pk_bf16_f32 v209, v210, v211
    buffer_store_dwordx2 v[208:209], v168, s[24:27], 0 offen offset:0
    v_pk_mul_f32 v[212:213], v[100:101], v[160:161] op_sel:[0,1] op_sel_hi:[1,1]
    v_pk_mul_f32 v[214:215], v[102:103], v[160:161] op_sel:[0,1] op_sel_hi:[1,1]
    v_pk_fma_f32 v[212:213], v[180:181], v[160:161], v[212:213] op_sel_hi:[1,0,1]
    v_pk_fma_f32 v[214:215], v[182:183], v[160:161], v[214:215] op_sel_hi:[1,0,1]
    v_max3_f32 v219, abs(v212), abs(v213), v219
    v_max3_f32 v219, abs(v214), abs(v215), v219
    v_cvt_pk_bf16_f32 v212, v212, v213
    v_cvt_pk_bf16_f32 v213, v214, v215
    buffer_store_dwordx2 v[212:213], v169, s[24:27], 0 offen offset:0
    v_pk_mul_f32 v[208:209], v[104:105], v[160:161] op_sel:[0,1] op_sel_hi:[1,1]
    v_pk_mul_f32 v[210:211], v[106:107], v[160:161] op_sel:[0,1] op_sel_hi:[1,1]
    v_pk_fma_f32 v[208:209], v[184:185], v[160:161], v[208:209] op_sel_hi:[1,0,1]
    v_pk_fma_f32 v[210:211], v[186:187], v[160:161], v[210:211] op_sel_hi:[1,0,1]
    v_max3_f32 v219, abs(v208), abs(v209), v219
    v_max3_f32 v219, abs(v210), abs(v211), v219
    v_cvt_pk_bf16_f32 v208, v208, v209
    v_cvt_pk_bf16_f32 v209, v210, v211
    buffer_store_dwordx2 v[208:209], v170, s[24:27], 0 offen offset:0
    v_pk_mul_f32 v[212:213], v[108:109], v[160:161] op_sel:[0,1] op_sel_hi:[1,1]
    v_pk_mul_f32 v[214:215], v[110:111], v[160:161] op_sel:[0,1] op_sel_hi:[1,1]
    v_pk_fma_f32 v[212:213], v[188:189], v[160:161], v[212:213] op_sel_hi:[1,0,1]
    v_pk_fma_f32 v[214:215], v[190:191], v[160:161], v[214:215] op_sel_hi:[1,0,1]
    v_max3_f32 v219, abs(v212), abs(v213), v219
    v_max3_f32 v219, abs(v214), abs(v215), v219
    v_cvt_pk_bf16_f32 v212, v212, v213
    v_cvt_pk_bf16_f32 v213, v214, v215
    buffer_store_dwordx2 v[212:213], v171, s[24:27], 0 offen offset:0
    v_pk_mul_f32 v[208:209], v[128:129], v[160:161] op_sel:[0,1] op_sel_hi:[1,1]
    v_pk_mul_f32 v[210:211], v[130:131], v[160:161] op_sel:[0,1] op_sel_hi:[1,1]
    v_pk_fma_f32 v[208:209], v[192:193], v[160:161], v[208:209] op_sel_hi:[1,0,1]
    v_pk_fma_f32 v[210:211], v[194:195], v[160:161], v[210:211] op_sel_hi:[1,0,1]
    v_max3_f32 v219, abs(v208), abs(v209), v219
    v_max3_f32 v219, abs(v210), abs(v211), v219
    v_cvt_pk_bf16_f32 v208, v208, v209
    v_cvt_pk_bf16_f32 v209, v210, v211
    buffer_store_dwordx2 v[208:209], v172, s[24:27], 0 offen offset:0
    v_pk_mul_f32 v[212:213], v[132:133], v[160:161] op_sel:[0,1] op_sel_hi:[1,1]
    v_pk_mul_f32 v[214:215], v[134:135], v[160:161] op_sel:[0,1] op_sel_hi:[1,1]
    v_pk_fma_f32 v[212:213], v[196:197], v[160:161], v[212:213] op_sel_hi:[1,0,1]
    v_pk_fma_f32 v[214:215], v[198:199], v[160:161], v[214:215] op_sel_hi:[1,0,1]
    v_max3_f32 v219, abs(v212), abs(v213), v219
    v_max3_f32 v219, abs(v214), abs(v215), v219
    v_cvt_pk_bf16_f32 v212, v212, v213
    v_cvt_pk_bf16_f32 v213, v214, v215
    buffer_store_dwordx2 v[212:213], v173, s[24:27], 0 offen offset:0
    v_pk_mul_f32 v[208:209], v[136:137], v[160:161] op_sel:[0,1] op_sel_hi:[1,1]
    v_pk_mul_f32 v[210:211], v[138:139], v[160:161] op_sel:[0,1] op_sel_hi:[1,1]
    v_pk_fma_f32 v[208:209], v[200:201], v[160:161], v[208:209] op_sel_hi:[1,0,1]
    v_pk_fma_f32 v[210:211], v[202:203], v[160:161], v[210:211] op_sel_hi:[1,0,1]
    v_max3_f32 v219, abs(v208), abs(v209), v219
    v_max3_f32 v219, abs(v210), abs(v211), v219
    v_cvt_pk_bf16_f32 v208, v208, v209
    v_cvt_pk_bf16_f32 v209, v210, v211
    buffer_store_dwordx2 v[208:209], v174, s[24:27], 0 offen offset:0
    v_pk_mul_f32 v[212:213], v[140:141], v[160:161] op_sel:[0,1] op_sel_hi:[1,1]
    v_pk_mul_f32 v[214:215], v[142:143], v[160:161] op_sel:[0,1] op_sel_hi:[1,1]
    v_pk_fma_f32 v[212:213], v[204:205], v[160:161], v[212:213] op_sel_hi:[1,0,1]
    v_pk_fma_f32 v[214:215], v[206:207], v[160:161], v[214:215] op_sel_hi:[1,0,1]
    v_max3_f32 v219, abs(v212), abs(v213), v219
    v_max3_f32 v219, abs(v214), abs(v215), v219
    v_cvt_pk_bf16_f32 v212, v212, v213
    v_cvt_pk_bf16_f32 v213, v214, v215
    buffer_store_dwordx2 v[212:213], v175, s[24:27], 0 offen offset:0
    v_pk_mul_f32 v[208:209], v[112:113], v[162:163] op_sel:[0,1] op_sel_hi:[1,1]
    v_pk_mul_f32 v[210:211], v[114:115], v[162:163] op_sel:[0,1] op_sel_hi:[1,1]
    v_pk_fma_f32 v[208:209], v[176:177], v[162:163], v[208:209] op_sel_hi:[1,0,1]
    v_pk_fma_f32 v[210:211], v[178:179], v[162:163], v[210:211] op_sel_hi:[1,0,1]
    v_max3_f32 v219, abs(v208), abs(v209), v219
    v_max3_f32 v219, abs(v210), abs(v211), v219
    v_cvt_pk_bf16_f32 v208, v208, v209
    v_cvt_pk_bf16_f32 v209, v210, v211
    buffer_store_dwordx2 v[208:209], v168, s[24:27], 0 offen offset:2048
    v_pk_mul_f32 v[212:213], v[116:117], v[162:163] op_sel:[0,1] op_sel_hi:[1,1]
    v_pk_mul_f32 v[214:215], v[118:119], v[162:163] op_sel:[0,1] op_sel_hi:[1,1]
    v_pk_fma_f32 v[212:213], v[180:181], v[162:163], v[212:213] op_sel_hi:[1,0,1]
    v_pk_fma_f32 v[214:215], v[182:183], v[162:163], v[214:215] op_sel_hi:[1,0,1]
    v_max3_f32 v219, abs(v212), abs(v213), v219
    v_max3_f32 v219, abs(v214), abs(v215), v219
    v_cvt_pk_bf16_f32 v212, v212, v213
    v_cvt_pk_bf16_f32 v213, v214, v215
    buffer_store_dwordx2 v[212:213], v169, s[24:27], 0 offen offset:2048
    v_pk_mul_f32 v[208:209], v[120:121], v[162:163] op_sel:[0,1] op_sel_hi:[1,1]
    v_pk_mul_f32 v[210:211], v[122:123], v[162:163] op_sel:[0,1] op_sel_hi:[1,1]
    v_pk_fma_f32 v[208:209], v[184:185], v[162:163], v[208:209] op_sel_hi:[1,0,1]
    v_pk_fma_f32 v[210:211], v[186:187], v[162:163], v[210:211] op_sel_hi:[1,0,1]
    v_max3_f32 v219, abs(v208), abs(v209), v219
    v_max3_f32 v219, abs(v210), abs(v211), v219
    v_cvt_pk_bf16_f32 v208, v208, v209
    v_cvt_pk_bf16_f32 v209, v210, v211
    buffer_store_dwordx2 v[208:209], v170, s[24:27], 0 offen offset:2048
    v_pk_mul_f32 v[212:213], v[124:125], v[162:163] op_sel:[0,1] op_sel_hi:[1,1]
    v_pk_mul_f32 v[214:215], v[126:127], v[162:163] op_sel:[0,1] op_sel_hi:[1,1]
    v_pk_fma_f32 v[212:213], v[188:189], v[162:163], v[212:213] op_sel_hi:[1,0,1]
    v_pk_fma_f32 v[214:215], v[190:191], v[162:163], v[214:215] op_sel_hi:[1,0,1]
    v_max3_f32 v219, abs(v212), abs(v213), v219
    v_max3_f32 v219, abs(v214), abs(v215), v219
    v_cvt_pk_bf16_f32 v212, v212, v213
    v_cvt_pk_bf16_f32 v213, v214, v215
    buffer_store_dwordx2 v[212:213], v171, s[24:27], 0 offen offset:2048
    v_pk_mul_f32 v[208:209], v[144:145], v[162:163] op_sel:[0,1] op_sel_hi:[1,1]
    v_pk_mul_f32 v[210:211], v[146:147], v[162:163] op_sel:[0,1] op_sel_hi:[1,1]
    v_pk_fma_f32 v[208:209], v[192:193], v[162:163], v[208:209] op_sel_hi:[1,0,1]
    v_pk_fma_f32 v[210:211], v[194:195], v[162:163], v[210:211] op_sel_hi:[1,0,1]
    v_max3_f32 v219, abs(v208), abs(v209), v219
    v_max3_f32 v219, abs(v210), abs(v211), v219
    v_cvt_pk_bf16_f32 v208, v208, v209
    v_cvt_pk_bf16_f32 v209, v210, v211
    buffer_store_dwordx2 v[208:209], v172, s[24:27], 0 offen offset:2048
    v_pk_mul_f32 v[212:213], v[148:149], v[162:163] op_sel:[0,1] op_sel_hi:[1,1]
    v_pk_mul_f32 v[214:215], v[150:151], v[162:163] op_sel:[0,1] op_sel_hi:[1,1]
    v_pk_fma_f32 v[212:213], v[196:197], v[162:163], v[212:213] op_sel_hi:[1,0,1]
    v_pk_fma_f32 v[214:215], v[198:199], v[162:163], v[214:215] op_sel_hi:[1,0,1]
    v_max3_f32 v219, abs(v212), abs(v213), v219
    v_max3_f32 v219, abs(v214), abs(v215), v219
    v_cvt_pk_bf16_f32 v212, v212, v213
    v_cvt_pk_bf16_f32 v213, v214, v215
    buffer_store_dwordx2 v[212:213], v173, s[24:27], 0 offen offset:2048
    v_pk_mul_f32 v[208:209], v[152:153], v[162:163] op_sel:[0,1] op_sel_hi:[1,1]
    v_pk_mul_f32 v[210:211], v[154:155], v[162:163] op_sel:[0,1] op_sel_hi:[1,1]
    v_pk_fma_f32 v[208:209], v[200:201], v[162:163], v[208:209] op_sel_hi:[1,0,1]
    v_pk_fma_f32 v[210:211], v[202:203], v[162:163], v[210:211] op_sel_hi:[1,0,1]
    v_max3_f32 v219, abs(v208), abs(v209), v219
    v_max3_f32 v219, abs(v210), abs(v211), v219
    v_cvt_pk_bf16_f32 v208, v208, v209
    v_cvt_pk_bf16_f32 v209, v210, v211
    buffer_store_dwordx2 v[208:209], v174, s[24:27], 0 offen offset:2048
    v_pk_mul_f32 v[212:213], v[156:157], v[162:163] op_sel:[0,1] op_sel_hi:[1,1]
    v_pk_mul_f32 v[214:215], v[158:159], v[162:163] op_sel:[0,1] op_sel_hi:[1,1]
    v_pk_fma_f32 v[212:213], v[204:205], v[162:163], v[212:213] op_sel_hi:[1,0,1]
    v_pk_fma_f32 v[214:215], v[206:207], v[162:163], v[214:215] op_sel_hi:[1,0,1]
    v_max3_f32 v219, abs(v212), abs(v213), v219
    v_max3_f32 v219, abs(v214), abs(v215), v219
    v_cvt_pk_bf16_f32 v212, v212, v213
    v_cvt_pk_bf16_f32 v213, v214, v215
    buffer_store_dwordx2 v[212:213], v175, s[24:27], 0 offen offset:2048
    s_cmp_lt_u32 s4, 5
    s_cbranch_scc1 qkvdone_qkv1_kernel_5
    v_xor_b32 v216, 1, v1
    v_lshlrev_b32 v216, 2, v216
    ds_bpermute_b32 v217, v216, v219
    s_waitcnt lgkmcnt(0)
    v_max_f32 v219, v219, v217
    v_xor_b32 v216, 2, v1
    v_lshlrev_b32 v216, 2, v216
    ds_bpermute_b32 v217, v216, v219
    s_waitcnt lgkmcnt(0)
    v_max_f32 v219, v219, v217
    v_xor_b32 v216, 4, v1
    v_lshlrev_b32 v216, 2, v216
    ds_bpermute_b32 v217, v216, v219
    s_waitcnt lgkmcnt(0)
    v_max_f32 v219, v219, v217
    v_xor_b32 v216, 8, v1
    v_lshlrev_b32 v216, 2, v216
    ds_bpermute_b32 v217, v216, v219
    s_waitcnt lgkmcnt(0)
    v_max_f32 v219, v219, v217
    v_xor_b32 v216, 16, v1
    v_lshlrev_b32 v216, 2, v216
    ds_bpermute_b32 v217, v216, v219
    s_waitcnt lgkmcnt(0)
    v_max_f32 v219, v219, v217
    v_xor_b32 v216, 32, v1
    v_lshlrev_b32 v216, 2, v216
    ds_bpermute_b32 v217, v216, v219
    s_waitcnt lgkmcnt(0)
    v_max_f32 v219, v219, v217
    s_sub_u32 s58, s2, 80
    s_lshl_b32 s58, s58, 2
    s_add_u32 s58, s58, s5
    s_lshl_b32 s58, s58, 2
    s_add_u32 s58, s58, 0x30000
    v_mov_b32 v216, s58
    buffer_store_dword v219, v216, s[20:23], 0 offen
    s_branch qkvdone_qkv1_kernel_5
vpath_qkv1_kernel_4:
    v_bfe_u32 v216, v1, 2, 1
    v_lshlrev_b32 v216, 4, v216
    v_bfe_u32 v217, v1, 3, 2
    v_lshl_add_u32 v216, v217, 2, v216
    v_and_b32 v217, 3, v1
    v_add_u32 v216, v216, v217
    s_lshl_b32 s58, s7, 6
    v_add_u32 v216, s58, v216
    s_sub_u32 s58, s57, 1280
    s_movk_i32 s61, 3277
    v_add_u32 v218, s58, v216
    v_mul_lo_u32 v219, v218, s61
    v_lshrrev_b32 v219, 16, v219
    v_mul_u32_u24 v194, 20, v219
    v_sub_u32 v194, v218, v194
    v_lshlrev_b32 v194, 4, v194
    v_lshl_add_u32 v194, v219, 17, v194
    v_lshl_add_u32 v194, v42, 9, v194
    v_add_u32 v218, s58, v216
    v_add_u32 v218, 32, v218
    v_mul_lo_u32 v219, v218, s61
    v_lshrrev_b32 v219, 16, v219
    v_mul_u32_u24 v195, 20, v219
    v_sub_u32 v195, v218, v195
    v_lshlrev_b32 v195, 4, v195
    v_lshl_add_u32 v195, v219, 17, v195
    v_lshl_add_u32 v195, v42, 9, v195
    s_lshl_b32 s58, s3, 2
    s_lshl_b32 s60, s6, 1
    s_add_u32 s58, s58, s60
    s_lshl_b32 s58, s58, 11
    s_add_u32 s58, s58, 0x800000
    v_add_u32 v194, s58, v194
    v_add_u32 v195, s58, v195
    s_waitcnt lgkmcnt(0)
    s_barrier
    v_add_u32 v36, s51, v30
    v_add_u32 v37, s51, v31
    v_add_u32 v38, s51, v32
    v_add_u32 v39, s51, v33
    v_add_u32 v40, s51, v34
    v_add_u32 v41, s51, v35
    s_add_u32 s51, s51, 32768
    s_cmp_eq_u32 s51, 133120
    s_cselect_b32 s51, 2048, s51
    ds_read_b128 v[48:51], v36 offset:0
    ds_read_b128 v[52:55], v36 offset:4096
    ds_read_b64_tr_b16 v[72:73], v40 offset:0
    ds_read_b64_tr_b16 v[74:75], v40 offset:1024
    ds_read_b64_tr_b16 v[76:77], v41 offset:0
    ds_read_b64_tr_b16 v[78:79], v41 offset:1024
    ds_read_b128 v[56:59], v37 offset:0
    ds_read_b128 v[60:63], v37 offset:4096
    ds_read_b64_tr_b16 v[80:81], v40 offset:4096
    ds_read_b64_tr_b16 v[82:83], v40 offset:5120
    ds_read_b64_tr_b16 v[84:85], v41 offset:4096
    ds_read_b64_tr_b16 v[86:87], v41 offset:5120
    s_waitcnt lgkmcnt(6)
    ds_read_b128 v[64:67], v38 offset:0
    ds_read_b128 v[68:71], v38 offset:4096
    v_mfma_f32_32x32x16_bf16 v[96:111], v[48:51], v[72:75], 0
    ds_read_b64_tr_b16 v[88:89], v40 offset:8192
    v_mfma_f32_32x32x16_bf16 v[112:127], v[52:55], v[72:75], 0
    ds_read_b64_tr_b16 v[90:91], v40 offset:9216
    v_mfma_f32_32x32x16_bf16 v[128:143], v[48:51], v[76:79], 0
    ds_read_b64_tr_b16 v[92:93], v41 offset:8192
    v_mfma_f32_32x32x16_bf16 v[144:159], v[52:55], v[76:79], 0
    ds_read_b64_tr_b16 v[94:95], v41 offset:9216
    s_waitcnt lgkmcnt(6)
    ds_read_b128 v[48:51], v39 offset:0
    ds_read_b128 v[52:55], v39 offset:4096
    v_mfma_f32_32x32x16_bf16 v[96:111], v[56:59], v[80:83], v[96:111]
    ds_read_b64_tr_b16 v[72:73], v40 offset:12288
    v_mfma_f32_32x32x16_bf16 v[112:127], v[60:63], v[80:83], v[112:127]
    ds_read_b64_tr_b16 v[74:75], v40 offset:13312
    v_mfma_f32_32x32x16_bf16 v[128:143], v[56:59], v[84:87], v[128:143]
    ds_read_b64_tr_b16 v[76:77], v41 offset:12288
    v_mfma_f32_32x32x16_bf16 v[144:159], v[60:63], v[84:87], v[144:159]
    ds_read_b64_tr_b16 v[78:79], v41 offset:13312
    s_waitcnt lgkmcnt(6)
    s_barrier
    v_add_u32 v36, s51, v30
    v_add_u32 v37, s51, v31
    v_add_u32 v38, s51, v32
    v_add_u32 v39, s51, v33
    v_add_u32 v40, s51, v34
    v_add_u32 v41, s51, v35
    s_add_u32 s51, s51, 32768
    s_cmp_eq_u32 s51, 133120
    s_cselect_b32 s51, 2048, s51
    ds_read_b128 v[56:59], v36 offset:0
    ds_read_b128 v[60:63], v36 offset:4096
    v_mfma_f32_32x32x16_bf16 v[96:111], v[64:67], v[88:91], v[96:111]
    ds_read_b64_tr_b16 v[80:81], v40 offset:0
    v_mfma_f32_32x32x16_bf16 v[112:127], v[68:71], v[88:91], v[112:127]
    ds_read_b64_tr_b16 v[82:83], v40 offset:1024
    v_mfma_f32_32x32x16_bf16 v[128:143], v[64:67], v[92:95], v[128:143]
    ds_read_b64_tr_b16 v[84:85], v41 offset:0
    v_mfma_f32_32x32x16_bf16 v[144:159], v[68:71], v[92:95], v[144:159]
    ds_read_b64_tr_b16 v[86:87], v41 offset:1024
    s_waitcnt lgkmcnt(6)
    ds_read_b128 v[64:67], v37 offset:0
    ds_read_b128 v[68:71], v37 offset:4096
    v_mfma_f32_32x32x16_bf16 v[96:111], v[48:51], v[72:75], v[96:111]
    ds_read_b64_tr_b16 v[88:89], v40 offset:4096
    v_mfma_f32_32x32x16_bf16 v[112:127], v[52:55], v[72:75], v[112:127]
    ds_read_b64_tr_b16 v[90:91], v40 offset:5120
    v_mfma_f32_32x32x16_bf16 v[128:143], v[48:51], v[76:79], v[128:143]
    ds_read_b64_tr_b16 v[92:93], v41 offset:4096
    v_mfma_f32_32x32x16_bf16 v[144:159], v[52:55], v[76:79], v[144:159]
    ds_read_b64_tr_b16 v[94:95], v41 offset:5120
    s_waitcnt lgkmcnt(6)
    s_waitcnt vmcnt(0)
    v_add_f32 v24, v24, v27
    v_add_f32 v24, v24, v28
    v_add_f32 v24, v24, v29
    v_add_f32 v8, v8, v10
    v_add_f32 v9, v9, v11
    v_add_f32 v8, v8, v12
    v_add_f32 v9, v9, v13
    v_add_f32 v8, v8, v14
    v_add_f32 v9, v9, v15
    v_add_f32 v8, v8, v16
    v_add_f32 v9, v9, v17
    v_add_f32 v8, v8, v18
    v_add_f32 v9, v9, v19
    v_add_f32 v8, v8, v20
    v_add_f32 v9, v9, v21
    v_add_f32 v8, v8, v22
    v_add_f32 v9, v9, v23
    v_mul_f32 v8, 0x3acccccd, v8
    v_mul_f32 v9, 0x3acccccd, v9
    v_fma_f32 v9, -v8, v8, v9
    v_max_f32 v9, 0, v9
    v_add_f32 v9, 0x3727c5ac, v9
    v_rsq_f32 v9, v9
    s_nop 0
    v_mul_f32 v8, v8, v9
    v_sub_f32 v8, 0, v8
    v_lshlrev_b32 v3, 3, v0
    v_cmp_gt_u32 vcc, 128, v0
    s_and_saveexec_b64 s[60:61], vcc
    s_cbranch_execz aux_qkv1_kernel_9
    ds_write_b64 v3, v[8:9] offset:0
aux_qkv1_kernel_9:
    s_mov_b64 exec, s[60:61]
    v_lshlrev_b32 v3, 2, v0
    v_cmp_gt_u32 vcc, 128, v0
    s_and_saveexec_b64 s[60:61], vcc
    s_cbranch_execz aux_qkv1_kernel_10
    ds_write_b32 v3, v24 offset:1024
aux_qkv1_kernel_10:
    s_mov_b64 exec, s[60:61]
    s_mov_b32 s55, 2
loop_qkv1_kernel_11:
    ds_read_b128 v[48:51], v38 offset:0
    ds_read_b128 v[52:55], v38 offset:4096
    v_mfma_f32_32x32x16_bf16 v[96:111], v[56:59], v[80:83], v[96:111]
    ds_read_b64_tr_b16 v[72:73], v40 offset:8192
    v_mfma_f32_32x32x16_bf16 v[112:127], v[60:63], v[80:83], v[112:127]
    ds_read_b64_tr_b16 v[74:75], v40 offset:9216
    v_mfma_f32_32x32x16_bf16 v[128:143], v[56:59], v[84:87], v[128:143]
    ds_read_b64_tr_b16 v[76:77], v41 offset:8192
    v_mfma_f32_32x32x16_bf16 v[144:159], v[60:63], v[84:87], v[144:159]
    ds_read_b64_tr_b16 v[78:79], v41 offset:9216
    s_waitcnt lgkmcnt(6)
    ds_read_b128 v[56:59], v39 offset:0
    ds_read_b128 v[60:63], v39 offset:4096
    v_mfma_f32_32x32x16_bf16 v[96:111], v[64:67], v[88:91], v[96:111]
    ds_read_b64_tr_b16 v[80:81], v40 offset:12288
    v_mfma_f32_32x32x16_bf16 v[112:127], v[68:71], v[88:91], v[112:127]
    ds_read_b64_tr_b16 v[82:83], v40 offset:13312
    v_mfma_f32_32x32x16_bf16 v[128:143], v[64:67], v[92:95], v[128:143]
    ds_read_b64_tr_b16 v[84:85], v41 offset:12288
    v_mfma_f32_32x32x16_bf16 v[144:159], v[68:71], v[92:95], v[144:159]
    ds_read_b64_tr_b16 v[86:87], v41 offset:13312
    s_waitcnt lgkmcnt(6)
    s_barrier
    v_add_u32 v36, s51, v30
    v_add_u32 v37, s51, v31
    v_add_u32 v38, s51, v32
    v_add_u32 v39, s51, v33
    v_add_u32 v40, s51, v34
    v_add_u32 v41, s51, v35
    s_add_u32 s51, s51, 32768
    s_cmp_eq_u32 s51, 133120
    s_cselect_b32 s51, 2048, s51
    ds_read_b128 v[64:67], v36 offset:0
    ds_read_b128 v[68:71], v36 offset:4096
    v_mfma_f32_32x32x16_bf16 v[96:111], v[48:51], v[72:75], v[96:111]
    ds_read_b64_tr_b16 v[88:89], v40 offset:0
    v_mfma_f32_32x32x16_bf16 v[112:127], v[52:55], v[72:75], v[112:127]
    ds_read_b64_tr_b16 v[90:91], v40 offset:1024
    v_mfma_f32_32x32x16_bf16 v[128:143], v[48:51], v[76:79], v[128:143]
    ds_read_b64_tr_b16 v[92:93], v41 offset:0
    v_mfma_f32_32x32x16_bf16 v[144:159], v[52:55], v[76:79], v[144:159]
    ds_read_b64_tr_b16 v[94:95], v41 offset:1024
    s_waitcnt lgkmcnt(6)
    ds_read_b128 v[48:51], v37 offset:0
    ds_read_b128 v[52:55], v37 offset:4096
    v_mfma_f32_32x32x16_bf16 v[96:111], v[56:59], v[80:83], v[96:111]
    ds_read_b64_tr_b16 v[72:73], v40 offset:4096
    v_mfma_f32_32x32x16_bf16 v[112:127], v[60:63], v[80:83], v[112:127]
    ds_read_b64_tr_b16 v[74:75], v40 offset:5120
    v_mfma_f32_32x32x16_bf16 v[128:143], v[56:59], v[84:87], v[128:143]
    ds_read_b64_tr_b16 v[76:77], v41 offset:4096
    v_mfma_f32_32x32x16_bf16 v[144:159], v[60:63], v[84:87], v[144:159]
    ds_read_b64_tr_b16 v[78:79], v41 offset:5120
    s_waitcnt lgkmcnt(6)
    ds_read_b128 v[56:59], v38 offset:0
    ds_read_b128 v[60:63], v38 offset:4096
    v_mfma_f32_32x32x16_bf16 v[96:111], v[64:67], v[88:91], v[96:111]
    ds_read_b64_tr_b16 v[80:81], v40 offset:8192
    v_mfma_f32_32x32x16_bf16 v[112:127], v[68:71], v[88:91], v[112:127]
    ds_read_b64_tr_b16 v[82:83], v40 offset:9216
    v_mfma_f32_32x32x16_bf16 v[128:143], v[64:67], v[92:95], v[128:143]
    ds_read_b64_tr_b16 v[84:85], v41 offset:8192
    v_mfma_f32_32x32x16_bf16 v[144:159], v[68:71], v[92:95], v[144:159]
    ds_read_b64_tr_b16 v[86:87], v41 offset:9216
    s_waitcnt lgkmcnt(6)
    ds_read_b128 v[64:67], v39 offset:0
    ds_read_b128 v[68:71], v39 offset:4096
    v_mfma_f32_32x32x16_bf16 v[96:111], v[48:51], v[72:75], v[96:111]
    ds_read_b64_tr_b16 v[88:89], v40 offset:12288
    v_mfma_f32_32x32x16_bf16 v[112:127], v[52:55], v[72:75], v[112:127]
    ds_read_b64_tr_b16 v[90:91], v40 offset:13312
    v_mfma_f32_32x32x16_bf16 v[128:143], v[48:51], v[76:79], v[128:143]
    ds_read_b64_tr_b16 v[92:93], v41 offset:12288
    v_mfma_f32_32x32x16_bf16 v[144:159], v[52:55], v[76:79], v[144:159]
    ds_read_b64_tr_b16 v[94:95], v41 offset:13312
    s_waitcnt lgkmcnt(6)
    s_barrier
    v_add_u32 v36, s51, v30
    v_add_u32 v37, s51, v31
    v_add_u32 v38, s51, v32
    v_add_u32 v39, s51, v33
    v_add_u32 v40, s51, v34
    v_add_u32 v41, s51, v35
    s_add_u32 s51, s51, 32768
    s_cmp_eq_u32 s51, 133120
    s_cselect_b32 s51, 2048, s51
    ds_read_b128 v[48:51], v36 offset:0
    ds_read_b128 v[52:55], v36 offset:4096
    v_mfma_f32_32x32x16_bf16 v[96:111], v[56:59], v[80:83], v[96:111]
    ds_read_b64_tr_b16 v[72:73], v40 offset:0
    v_mfma_f32_32x32x16_bf16 v[112:127], v[60:63], v[80:83], v[112:127]
    ds_read_b64_tr_b16 v[74:75], v40 offset:1024
    v_mfma_f32_32x32x16_bf16 v[128:143], v[56:59], v[84:87], v[128:143]
    ds_read_b64_tr_b16 v[76:77], v41 offset:0
    v_mfma_f32_32x32x16_bf16 v[144:159], v[60:63], v[84:87], v[144:159]
    ds_read_b64_tr_b16 v[78:79], v41 offset:1024
    s_waitcnt lgkmcnt(6)
    ds_read_b128 v[56:59], v37 offset:0
    ds_read_b128 v[60:63], v37 offset:4096
    v_mfma_f32_32x32x16_bf16 v[96:111], v[64:67], v[88:91], v[96:111]
    ds_read_b64_tr_b16 v[80:81], v40 offset:4096
    v_mfma_f32_32x32x16_bf16 v[112:127], v[68:71], v[88:91], v[112:127]
    ds_read_b64_tr_b16 v[82:83], v40 offset:5120
    v_mfma_f32_32x32x16_bf16 v[128:143], v[64:67], v[92:95], v[128:143]
    ds_read_b64_tr_b16 v[84:85], v41 offset:4096
    v_mfma_f32_32x32x16_bf16 v[144:159], v[68:71], v[92:95], v[144:159]
    ds_read_b64_tr_b16 v[86:87], v41 offset:5120
    s_waitcnt lgkmcnt(6)
    ds_read_b128 v[64:67], v38 offset:0
    ds_read_b128 v[68:71], v38 offset:4096
    v_mfma_f32_32x32x16_bf16 v[96:111], v[48:51], v[72:75], v[96:111]
    ds_read_b64_tr_b16 v[88:89], v40 offset:8192
    v_mfma_f32_32x32x16_bf16 v[112:127], v[52:55], v[72:75], v[112:127]
    ds_read_b64_tr_b16 v[90:91], v40 offset:9216
    v_mfma_f32_32x32x16_bf16 v[128:143], v[48:51], v[76:79], v[128:143]
    ds_read_b64_tr_b16 v[92:93], v41 offset:8192
    v_mfma_f32_32x32x16_bf16 v[144:159], v[52:55], v[76:79], v[144:159]
    ds_read_b64_tr_b16 v[94:95], v41 offset:9216
    s_waitcnt lgkmcnt(6)
    ds_read_b128 v[48:51], v39 offset:0
    ds_read_b128 v[52:55], v39 offset:4096
    v_mfma_f32_32x32x16_bf16 v[96:111], v[56:59], v[80:83], v[96:111]
    ds_read_b64_tr_b16 v[72:73], v40 offset:12288
    v_mfma_f32_32x32x16_bf16 v[112:127], v[60:63], v[80:83], v[112:127]
    ds_read_b64_tr_b16 v[74:75], v40 offset:13312
    v_mfma_f32_32x32x16_bf16 v[128:143], v[56:59], v[84:87], v[128:143]
    ds_read_b64_tr_b16 v[76:77], v41 offset:12288
    v_mfma_f32_32x32x16_bf16 v[144:159], v[60:63], v[84:87], v[144:159]
    ds_read_b64_tr_b16 v[78:79], v41 offset:13312
    s_waitcnt lgkmcnt(6)
    s_barrier
    v_add_u32 v36, s51, v30
    v_add_u32 v37, s51, v31
    v_add_u32 v38, s51, v32
    v_add_u32 v39, s51, v33
    v_add_u32 v40, s51, v34
    v_add_u32 v41, s51, v35
    s_add_u32 s51, s51, 32768
    s_cmp_eq_u32 s51, 133120
    s_cselect_b32 s51, 2048, s51
    ds_read_b128 v[56:59], v36 offset:0
    ds_read_b128 v[60:63], v36 offset:4096
    v_mfma_f32_32x32x16_bf16 v[96:111], v[64:67], v[88:91], v[96:111]
    ds_read_b64_tr_b16 v[80:81], v40 offset:0
    v_mfma_f32_32x32x16_bf16 v[112:127], v[68:71], v[88:91], v[112:127]
    ds_read_b64_tr_b16 v[82:83], v40 offset:1024
    v_mfma_f32_32x32x16_bf16 v[128:143], v[64:67], v[92:95], v[128:143]
    ds_read_b64_tr_b16 v[84:85], v41 offset:0
    v_mfma_f32_32x32x16_bf16 v[144:159], v[68:71], v[92:95], v[144:159]
    ds_read_b64_tr_b16 v[86:87], v41 offset:1024
    s_waitcnt lgkmcnt(6)
    ds_read_b128 v[64:67], v37 offset:0
    ds_read_b128 v[68:71], v37 offset:4096
    v_mfma_f32_32x32x16_bf16 v[96:111], v[48:51], v[72:75], v[96:111]
    ds_read_b64_tr_b16 v[88:89], v40 offset:4096
    v_mfma_f32_32x32x16_bf16 v[112:127], v[52:55], v[72:75], v[112:127]
    ds_read_b64_tr_b16 v[90:91], v40 offset:5120
    v_mfma_f32_32x32x16_bf16 v[128:143], v[48:51], v[76:79], v[128:143]
    ds_read_b64_tr_b16 v[92:93], v41 offset:4096
    v_mfma_f32_32x32x16_bf16 v[144:159], v[52:55], v[76:79], v[144:159]
    ds_read_b64_tr_b16 v[94:95], v41 offset:5120
    s_waitcnt lgkmcnt(6)
    s_sub_u32 s55, s55, 1
    s_cmp_lg_u32 s55, 0
    s_cbranch_scc1 loop_qkv1_kernel_11
    ds_read_b128 v[48:51], v38 offset:0
    ds_read_b128 v[52:55], v38 offset:4096
    v_mfma_f32_32x32x16_bf16 v[96:111], v[56:59], v[80:83], v[96:111]
    ds_read_b64_tr_b16 v[72:73], v40 offset:8192
    v_mfma_f32_32x32x16_bf16 v[112:127], v[60:63], v[80:83], v[112:127]
    ds_read_b64_tr_b16 v[74:75], v40 offset:9216
    v_mfma_f32_32x32x16_bf16 v[128:143], v[56:59], v[84:87], v[128:143]
    ds_read_b64_tr_b16 v[76:77], v41 offset:8192
    v_mfma_f32_32x32x16_bf16 v[144:159], v[60:63], v[84:87], v[144:159]
    ds_read_b64_tr_b16 v[78:79], v41 offset:9216
    s_waitcnt lgkmcnt(6)
    ds_read_b128 v[56:59], v39 offset:0
    ds_read_b128 v[60:63], v39 offset:4096
    v_mfma_f32_32x32x16_bf16 v[96:111], v[64:67], v[88:91], v[96:111]
    ds_read_b64_tr_b16 v[80:81], v40 offset:12288
    v_mfma_f32_32x32x16_bf16 v[112:127], v[68:71], v[88:91], v[112:127]
    ds_read_b64_tr_b16 v[82:83], v40 offset:13312
    v_mfma_f32_32x32x16_bf16 v[128:143], v[64:67], v[92:95], v[128:143]
    ds_read_b64_tr_b16 v[84:85], v41 offset:12288
    v_mfma_f32_32x32x16_bf16 v[144:159], v[68:71], v[92:95], v[144:159]
    ds_read_b64_tr_b16 v[86:87], v41 offset:13312
    s_waitcnt lgkmcnt(6)
    s_barrier
    v_add_u32 v36, s51, v30
    v_add_u32 v37, s51, v31
    v_add_u32 v38, s51, v32
    v_add_u32 v39, s51, v33
    v_add_u32 v40, s51, v34
    v_add_u32 v41, s51, v35
    s_add_u32 s51, s51, 32768
    s_cmp_eq_u32 s51, 133120
    s_cselect_b32 s51, 2048, s51
    ds_read_b128 v[64:67], v36 offset:0
    ds_read_b128 v[68:71], v36 offset:4096
    v_mfma_f32_32x32x16_bf16 v[96:111], v[48:51], v[72:75], v[96:111]
    ds_read_b64_tr_b16 v[88:89], v40 offset:0
    v_mfma_f32_32x32x16_bf16 v[112:127], v[52:55], v[72:75], v[112:127]
    ds_read_b64_tr_b16 v[90:91], v40 offset:1024
    v_mfma_f32_32x32x16_bf16 v[128:143], v[48:51], v[76:79], v[128:143]
    ds_read_b64_tr_b16 v[92:93], v41 offset:0
    v_mfma_f32_32x32x16_bf16 v[144:159], v[52:55], v[76:79], v[144:159]
    ds_read_b64_tr_b16 v[94:95], v41 offset:1024
    s_waitcnt lgkmcnt(6)
    ds_read_b128 v[48:51], v37 offset:0
    ds_read_b128 v[52:55], v37 offset:4096
    v_mfma_f32_32x32x16_bf16 v[96:111], v[56:59], v[80:83], v[96:111]
    ds_read_b64_tr_b16 v[72:73], v40 offset:4096
    v_mfma_f32_32x32x16_bf16 v[112:127], v[60:63], v[80:83], v[112:127]
    ds_read_b64_tr_b16 v[74:75], v40 offset:5120
    v_mfma_f32_32x32x16_bf16 v[128:143], v[56:59], v[84:87], v[128:143]
    ds_read_b64_tr_b16 v[76:77], v41 offset:4096
    v_mfma_f32_32x32x16_bf16 v[144:159], v[60:63], v[84:87], v[144:159]
    ds_read_b64_tr_b16 v[78:79], v41 offset:5120
    s_waitcnt lgkmcnt(6)
    ds_read_b128 v[56:59], v38 offset:0
    ds_read_b128 v[60:63], v38 offset:4096
    v_mfma_f32_32x32x16_bf16 v[96:111], v[64:67], v[88:91], v[96:111]
    ds_read_b64_tr_b16 v[80:81], v40 offset:8192
    v_mfma_f32_32x32x16_bf16 v[112:127], v[68:71], v[88:91], v[112:127]
    ds_read_b64_tr_b16 v[82:83], v40 offset:9216
    v_mfma_f32_32x32x16_bf16 v[128:143], v[64:67], v[92:95], v[128:143]
    ds_read_b64_tr_b16 v[84:85], v41 offset:8192
    v_mfma_f32_32x32x16_bf16 v[144:159], v[68:71], v[92:95], v[144:159]
    ds_read_b64_tr_b16 v[86:87], v41 offset:9216
    s_waitcnt lgkmcnt(6)
    ds_read_b128 v[64:67], v39 offset:0
    ds_read_b128 v[68:71], v39 offset:4096
    v_mfma_f32_32x32x16_bf16 v[96:111], v[48:51], v[72:75], v[96:111]
    ds_read_b64_tr_b16 v[88:89], v40 offset:12288
    v_mfma_f32_32x32x16_bf16 v[112:127], v[52:55], v[72:75], v[112:127]
    ds_read_b64_tr_b16 v[90:91], v40 offset:13312
    v_mfma_f32_32x32x16_bf16 v[128:143], v[48:51], v[76:79], v[128:143]
    ds_read_b64_tr_b16 v[92:93], v41 offset:12288
    v_mfma_f32_32x32x16_bf16 v[144:159], v[52:55], v[76:79], v[144:159]
    ds_read_b64_tr_b16 v[94:95], v41 offset:13312
    s_waitcnt lgkmcnt(6)
    s_barrier
    v_add_u32 v36, s51, v30
    v_add_u32 v37, s51, v31
    v_add_u32 v38, s51, v32
    v_add_u32 v39, s51, v33
    v_add_u32 v40, s51, v34
    v_add_u32 v41, s51, v35
    s_add_u32 s51, s51, 32768
    s_cmp_eq_u32 s51, 133120
    s_cselect_b32 s51, 2048, s51
    ds_read_b128 v[48:51], v36 offset:0
    ds_read_b128 v[52:55], v36 offset:4096
    v_mfma_f32_32x32x16_bf16 v[96:111], v[56:59], v[80:83], v[96:111]
    ds_read_b64_tr_b16 v[72:73], v40 offset:0
    v_mfma_f32_32x32x16_bf16 v[112:127], v[60:63], v[80:83], v[112:127]
    ds_read_b64_tr_b16 v[74:75], v40 offset:1024
    v_mfma_f32_32x32x16_bf16 v[128:143], v[56:59], v[84:87], v[128:143]
    ds_read_b64_tr_b16 v[76:77], v41 offset:0
    v_mfma_f32_32x32x16_bf16 v[144:159], v[60:63], v[84:87], v[144:159]
    ds_read_b64_tr_b16 v[78:79], v41 offset:1024
    s_waitcnt lgkmcnt(6)
    ds_read_b128 v[56:59], v37 offset:0
    ds_read_b128 v[60:63], v37 offset:4096
    v_mfma_f32_32x32x16_bf16 v[96:111], v[64:67], v[88:91], v[96:111]
    ds_read_b64_tr_b16 v[80:81], v40 offset:4096
    v_mfma_f32_32x32x16_bf16 v[112:127], v[68:71], v[88:91], v[112:127]
    ds_read_b64_tr_b16 v[82:83], v40 offset:5120
    v_mfma_f32_32x32x16_bf16 v[128:143], v[64:67], v[92:95], v[128:143]
    ds_read_b64_tr_b16 v[84:85], v41 offset:4096
    v_mfma_f32_32x32x16_bf16 v[144:159], v[68:71], v[92:95], v[144:159]
    ds_read_b64_tr_b16 v[86:87], v41 offset:5120
    s_waitcnt lgkmcnt(6)
    ds_read_b128 v[64:67], v38 offset:0
    ds_read_b128 v[68:71], v38 offset:4096
    v_mfma_f32_32x32x16_bf16 v[96:111], v[48:51], v[72:75], v[96:111]
    ds_read_b64_tr_b16 v[88:89], v40 offset:8192
    v_mfma_f32_32x32x16_bf16 v[112:127], v[52:55], v[72:75], v[112:127]
    ds_read_b64_tr_b16 v[90:91], v40 offset:9216
    v_mfma_f32_32x32x16_bf16 v[128:143], v[48:51], v[76:79], v[128:143]
    ds_read_b64_tr_b16 v[92:93], v41 offset:8192
    v_mfma_f32_32x32x16_bf16 v[144:159], v[52:55], v[76:79], v[144:159]
    ds_read_b64_tr_b16 v[94:95], v41 offset:9216
    s_waitcnt lgkmcnt(6)
    ds_read_b128 v[48:51], v39 offset:0
    ds_read_b128 v[52:55], v39 offset:4096
    v_mfma_f32_32x32x16_bf16 v[96:111], v[56:59], v[80:83], v[96:111]
    ds_read_b64_tr_b16 v[72:73], v40 offset:12288
    v_mfma_f32_32x32x16_bf16 v[112:127], v[60:63], v[80:83], v[112:127]
    ds_read_b64_tr_b16 v[74:75], v40 offset:13312
    v_mfma_f32_32x32x16_bf16 v[128:143], v[56:59], v[84:87], v[128:143]
    ds_read_b64_tr_b16 v[76:77], v41 offset:12288
    v_mfma_f32_32x32x16_bf16 v[144:159], v[60:63], v[84:87], v[144:159]
    ds_read_b64_tr_b16 v[78:79], v41 offset:13312
    s_waitcnt lgkmcnt(6)
    v_mfma_f32_32x32x16_bf16 v[96:111], v[64:67], v[88:91], v[96:111]
    v_mfma_f32_32x32x16_bf16 v[112:127], v[68:71], v[88:91], v[112:127]
    v_mfma_f32_32x32x16_bf16 v[128:143], v[64:67], v[92:95], v[128:143]
    v_mfma_f32_32x32x16_bf16 v[144:159], v[68:71], v[92:95], v[144:159]
    s_waitcnt lgkmcnt(0)
    v_mfma_f32_32x32x16_bf16 v[96:111], v[48:51], v[72:75], v[96:111]
    v_mfma_f32_32x32x16_bf16 v[112:127], v[52:55], v[72:75], v[112:127]
    v_mfma_f32_32x32x16_bf16 v[128:143], v[48:51], v[76:79], v[128:143]
    v_mfma_f32_32x32x16_bf16 v[144:159], v[52:55], v[76:79], v[144:159]
    s_nop 7
    s_nop 7
    v_lshlrev_b32 v217, 2, v216
    ds_read_b32 v192, v217 offset:1024
    ds_read_b32 v193, v217 offset:1152
    s_lshl_b32 s58, s6, 9
    v_lshlrev_b32 v217, 5, v42
    v_add_u32 v217, s58, v217
    ds_read_b128 v[160:163], v217 offset:0
    ds_read_b128 v[164:167], v217 offset:16
    ds_read_b128 v[168:171], v217 offset:64
    ds_read_b128 v[172:175], v217 offset:80
    ds_read_b128 v[176:179], v217 offset:128
    ds_read_b128 v[180:183], v217 offset:144
    ds_read_b128 v[184:187], v217 offset:192
    ds_read_b128 v[188:191], v217 offset:208
    s_waitcnt lgkmcnt(0)
    v_mul_f32 v196, v96, v161
    v_fmac_f32 v196, v192, v160
    v_mul_f32 v197, v97, v163
    v_fmac_f32 v197, v192, v162
    v_mul_f32 v198, v98, v165
    v_fmac_f32 v198, v192, v164
    v_mul_f32 v199, v99, v167
    v_fmac_f32 v199, v192, v166
    v_mul_f32 v200, v100, v169
    v_fmac_f32 v200, v192, v168
    v_mul_f32 v201, v101, v171
    v_fmac_f32 v201, v192, v170
    v_mul_f32 v202, v102, v173
    v_fmac_f32 v202, v192, v172
    v_mul_f32 v203, v103, v175
    v_fmac_f32 v203, v192, v174
    v_cvt_pk_bf16_f32 v196, v196, v197
    v_cvt_pk_bf16_f32 v197, v198, v199
    v_cvt_pk_bf16_f32 v198, v200, v201
    v_cvt_pk_bf16_f32 v199, v202, v203
    buffer_store_dwordx4 v[196:199], v194, s[24:27], 0 offen offset:0
    s_nop 1
    v_mul_f32 v196, v104, v177
    v_fmac_f32 v196, v192, v176
    v_mul_f32 v197, v105, v179
    v_fmac_f32 v197, v192, v178
    v_mul_f32 v198, v106, v181
    v_fmac_f32 v198, v192, v180
    v_mul_f32 v199, v107, v183
    v_fmac_f32 v199, v192, v182
    v_mul_f32 v200, v108, v185
    v_fmac_f32 v200, v192, v184
    v_mul_f32 v201, v109, v187
    v_fmac_f32 v201, v192, v186
    v_mul_f32 v202, v110, v189
    v_fmac_f32 v202, v192, v188
    v_mul_f32 v203, v111, v191
    v_fmac_f32 v203, v192, v190
    v_cvt_pk_bf16_f32 v196, v196, v197
    v_cvt_pk_bf16_f32 v197, v198, v199
    v_cvt_pk_bf16_f32 v198, v200, v201
    v_cvt_pk_bf16_f32 v199, v202, v203
    buffer_store_dwordx4 v[196:199], v194, s[24:27], 0 offen offset:1024
    s_nop 1
    v_mul_f32 v196, v128, v161
    v_fmac_f32 v196, v193, v160
    v_mul_f32 v197, v129, v163
    v_fmac_f32 v197, v193, v162
    v_mul_f32 v198, v130, v165
    v_fmac_f32 v198, v193, v164
    v_mul_f32 v199, v131, v167
    v_fmac_f32 v199, v193, v166
    v_mul_f32 v200, v132, v169
    v_fmac_f32 v200, v193, v168
    v_mul_f32 v201, v133, v171
    v_fmac_f32 v201, v193, v170
    v_mul_f32 v202, v134, v173
    v_fmac_f32 v202, v193, v172
    v_mul_f32 v203, v135, v175
    v_fmac_f32 v203, v193, v174
    v_cvt_pk_bf16_f32 v196, v196, v197
    v_cvt_pk_bf16_f32 v197, v198, v199
    v_cvt_pk_bf16_f32 v198, v200, v201
    v_cvt_pk_bf16_f32 v199, v202, v203
    buffer_store_dwordx4 v[196:199], v195, s[24:27], 0 offen offset:0
    s_nop 1
    v_mul_f32 v196, v136, v177
    v_fmac_f32 v196, v193, v176
    v_mul_f32 v197, v137, v179
    v_fmac_f32 v197, v193, v178
    v_mul_f32 v198, v138, v181
    v_fmac_f32 v198, v193, v180
    v_mul_f32 v199, v139, v183
    v_fmac_f32 v199, v193, v182
    v_mul_f32 v200, v140, v185
    v_fmac_f32 v200, v193, v184
    v_mul_f32 v201, v141, v187
    v_fmac_f32 v201, v193, v186
    v_mul_f32 v202, v142, v189
    v_fmac_f32 v202, v193, v188
    v_mul_f32 v203, v143, v191
    v_fmac_f32 v203, v193, v190
    v_cvt_pk_bf16_f32 v196, v196, v197
    v_cvt_pk_bf16_f32 v197, v198, v199
    v_cvt_pk_bf16_f32 v198, v200, v201
    v_cvt_pk_bf16_f32 v199, v202, v203
    buffer_store_dwordx4 v[196:199], v195, s[24:27], 0 offen offset:1024
    s_nop 1
    ds_read_b128 v[160:163], v217 offset:256
    ds_read_b128 v[164:167], v217 offset:272
    ds_read_b128 v[168:171], v217 offset:320
    ds_read_b128 v[172:175], v217 offset:336
    ds_read_b128 v[176:179], v217 offset:384
    ds_read_b128 v[180:183], v217 offset:400
    ds_read_b128 v[184:187], v217 offset:448
    ds_read_b128 v[188:191], v217 offset:464
    s_waitcnt lgkmcnt(0)
    v_mul_f32 v196, v112, v161
    v_fmac_f32 v196, v192, v160
    v_mul_f32 v197, v113, v163
    v_fmac_f32 v197, v192, v162
    v_mul_f32 v198, v114, v165
    v_fmac_f32 v198, v192, v164
    v_mul_f32 v199, v115, v167
    v_fmac_f32 v199, v192, v166
    v_mul_f32 v200, v116, v169
    v_fmac_f32 v200, v192, v168
    v_mul_f32 v201, v117, v171
    v_fmac_f32 v201, v192, v170
    v_mul_f32 v202, v118, v173
    v_fmac_f32 v202, v192, v172
    v_mul_f32 v203, v119, v175
    v_fmac_f32 v203, v192, v174
    v_cvt_pk_bf16_f32 v196, v196, v197
    v_cvt_pk_bf16_f32 v197, v198, v199
    v_cvt_pk_bf16_f32 v198, v200, v201
    v_cvt_pk_bf16_f32 v199, v202, v203
    buffer_store_dwordx4 v[196:199], v194, s[24:27], 0 offen offset:2048
    s_nop 1
    v_mul_f32 v196, v120, v177
    v_fmac_f32 v196, v192, v176
    v_mul_f32 v197, v121, v179
    v_fmac_f32 v197, v192, v178
    v_mul_f32 v198, v122, v181
    v_fmac_f32 v198, v192, v180
    v_mul_f32 v199, v123, v183
    v_fmac_f32 v199, v192, v182
    v_mul_f32 v200, v124, v185
    v_fmac_f32 v200, v192, v184
    v_mul_f32 v201, v125, v187
    v_fmac_f32 v201, v192, v186
    v_mul_f32 v202, v126, v189
    v_fmac_f32 v202, v192, v188
    v_mul_f32 v203, v127, v191
    v_fmac_f32 v203, v192, v190
    v_cvt_pk_bf16_f32 v196, v196, v197
    v_cvt_pk_bf16_f32 v197, v198, v199
    v_cvt_pk_bf16_f32 v198, v200, v201
    v_cvt_pk_bf16_f32 v199, v202, v203
    buffer_store_dwordx4 v[196:199], v194, s[24:27], 0 offen offset:3072
    s_nop 1
    v_mul_f32 v196, v144, v161
    v_fmac_f32 v196, v193, v160
    v_mul_f32 v197, v145, v163
    v_fmac_f32 v197, v193, v162
    v_mul_f32 v198, v146, v165
    v_fmac_f32 v198, v193, v164
    v_mul_f32 v199, v147, v167
    v_fmac_f32 v199, v193, v166
    v_mul_f32 v200, v148, v169
    v_fmac_f32 v200, v193, v168
    v_mul_f32 v201, v149, v171
    v_fmac_f32 v201, v193, v170
    v_mul_f32 v202, v150, v173
    v_fmac_f32 v202, v193, v172
    v_mul_f32 v203, v151, v175
    v_fmac_f32 v203, v193, v174
    v_cvt_pk_bf16_f32 v196, v196, v197
    v_cvt_pk_bf16_f32 v197, v198, v199
    v_cvt_pk_bf16_f32 v198, v200, v201
    v_cvt_pk_bf16_f32 v199, v202, v203
    buffer_store_dwordx4 v[196:199], v195, s[24:27], 0 offen offset:2048
    s_nop 1
    v_mul_f32 v196, v152, v177
    v_fmac_f32 v196, v193, v176
    v_mul_f32 v197, v153, v179
    v_fmac_f32 v197, v193, v178
    v_mul_f32 v198, v154, v181
    v_fmac_f32 v198, v193, v180
    v_mul_f32 v199, v155, v183
    v_fmac_f32 v199, v193, v182
    v_mul_f32 v200, v156, v185
    v_fmac_f32 v200, v193, v184
    v_mul_f32 v201, v157, v187
    v_fmac_f32 v201, v193, v186
    v_mul_f32 v202, v158, v189
    v_fmac_f32 v202, v193, v188
    v_mul_f32 v203, v159, v191
    v_fmac_f32 v203, v193, v190
    v_cvt_pk_bf16_f32 v196, v196, v197
    v_cvt_pk_bf16_f32 v197, v198, v199
    v_cvt_pk_bf16_f32 v198, v200, v201
    v_cvt_pk_bf16_f32 v199, v202, v203
    buffer_store_dwordx4 v[196:199], v195, s[24:27], 0 offen offset:3072
    s_nop 1
qkvdone_qkv1_kernel_5:
end_qkv1_kernel_1:
    s_endpgm
.globl oproj1_kernel
.p2align 8
.type oproj1_kernel,@function
oproj1_kernel:
    s_cmp_ge_u32 s2, 256
    s_cbranch_scc1 end_oproj1_kernel_1
    s_load_dwordx16 s[64:79], s[0:1], 0
    s_load_dwordx4 s[80:83], s[0:1], 64
    s_and_b32 s3, s2, 31
    s_lshr_b32 s4, s2, 5
    v_and_b32 v1, 63, v0
    v_lshrrev_b32 v2, 6, v0
    s_nop 0
    v_readfirstlane_b32 s5, v2
    s_lshl_b32 s56, s3, 6
    s_mul_i32 s57, s4, 80
    s_min_u32 s58, s5, 0
    s_mul_i32 s59, s5, 5
    s_add_u32 s59, s59, s58
    s_cmp_lt_u32 s5, 0
    s_cselect_b32 s55, 6, 5
    v_lshlrev_b32 v5, 4, v1
    s_mul_i32 s48, s3, 20
    s_add_u32 s48, s48, s59
    s_lshl_b32 s48, s48, 12
    s_mul_i32 s49, s4, 640
    s_lshl_b32 s58, s59, 5
    s_add_u32 s49, s49, s58
    s_mul_i32 s49, s49, 160
    s_mul_i32 s52, s5, 36864
    s_add_u32 s53, s52, 36864
    s_mov_b32 s50, s52
    s_mov_b32 s51, s52
    s_waitcnt lgkmcnt(0)
    s_add_u32 s8, s82, 0xd00000
    s_addc_u32 s9, s83, 0
    s_and_b32 s9, s9, 0xffff
    s_mov_b32 s10, 0x280000
    s_mov_b32 s11, 0x20000
    s_add_u32 s12, s82, 0x2000000
    s_addc_u32 s13, s83, 0
    s_and_b32 s13, s13, 0xffff
    s_mov_b32 s14, 0xc8000
    s_mov_b32 s15, 0x20000
    s_mov_b32 m0, s50
    s_nop 0
    buffer_load_dwordx4 v5, s[8:11], s48 offen lds
    buffer_load_dwordx4 v5, s[8:11], s48 offen offset:1024 lds
    buffer_load_dwordx4 v5, s[8:11], s48 offen offset:2048 lds
    buffer_load_dwordx4 v5, s[8:11], s48 offen offset:3072 lds
    s_add_u32 m0, s50, 4096
    s_nop 0
    buffer_load_dwordx4 v5, s[12:15], s49 offen lds
    buffer_load_dwordx4 v5, s[12:15], s49 offen offset:1024 lds
    buffer_load_dwordx4 v5, s[12:15], s49 offen offset:2048 lds
    buffer_load_dwordx4 v5, s[12:15], s49 offen offset:3072 lds
    s_add_u32 m0, s50, 8192
    s_add_u32 s54, s49, 4096
    buffer_load_dwordx4 v5, s[12:15], s54 offen lds
    s_add_u32 s48, s48, 4096
    s_add_u32 s49, s49, 5120
    s_add_u32 s50, s50, 9216
    s_cmp_eq_u32 s50, s53
    s_cselect_b32 s50, s52, s50
    s_mov_b32 m0, s50
    s_nop 0
    buffer_load_dwordx4 v5, s[8:11], s48 offen lds
    buffer_load_dwordx4 v5, s[8:11], s48 offen offset:1024 lds
    buffer_load_dwordx4 v5, s[8:11], s48 offen offset:2048 lds
    buffer_load_dwordx4 v5, s[8:11], s48 offen offset:3072 lds
    s_add_u32 m0, s50, 4096
    s_nop 0
    buffer_load_dwordx4 v5, s[12:15], s49 offen lds
    buffer_load_dwordx4 v5, s[12:15], s49 offen offset:1024 lds
    buffer_load_dwordx4 v5, s[12:15], s49 offen offset:2048 lds
    buffer_load_dwordx4 v5, s[12:15], s49 offen offset:3072 lds
    s_add_u32 m0, s50, 8192
    s_add_u32 s54, s49, 4096
    buffer_load_dwordx4 v5, s[12:15], s54 offen lds
    s_add_u32 s48, s48, 4096
    s_add_u32 s49, s49, 5120
    s_add_u32 s50, s50, 9216
    s_cmp_eq_u32 s50, s53
    s_cselect_b32 s50, s52, s50
    s_mov_b32 m0, s50
    s_nop 0
    buffer_load_dwordx4 v5, s[8:11], s48 offen lds
    buffer_load_dwordx4 v5, s[8:11], s48 offen offset:1024 lds
    buffer_load_dwordx4 v5, s[8:11], s48 offen offset:2048 lds
    buffer_load_dwordx4 v5, s[8:11], s48 offen offset:3072 lds
    s_add_u32 m0, s50, 4096
    s_nop 0
    buffer_load_dwordx4 v5, s[12:15], s49 offen lds
    buffer_load_dwordx4 v5, s[12:15], s49 offen offset:1024 lds
    buffer_load_dwordx4 v5, s[12:15], s49 offen offset:2048 lds
    buffer_load_dwordx4 v5, s[12:15], s49 offen offset:3072 lds
    s_add_u32 m0, s50, 8192
    s_add_u32 s54, s49, 4096
    buffer_load_dwordx4 v5, s[12:15], s54 offen lds
    s_add_u32 s48, s48, 4096
    s_add_u32 s49, s49, 5120
    s_add_u32 s50, s50, 9216
    s_cmp_eq_u32 s50, s53
    s_cselect_b32 s50, s52, s50
    s_mov_b32 m0, s50
    s_nop 0
    buffer_load_dwordx4 v5, s[8:11], s48 offen lds
    buffer_load_dwordx4 v5, s[8:11], s48 offen offset:1024 lds
    buffer_load_dwordx4 v5, s[8:11], s48 offen offset:2048 lds
    buffer_load_dwordx4 v5, s[8:11], s48 offen offset:3072 lds
    s_add_u32 m0, s50, 4096
    s_nop 0
    buffer_load_dwordx4 v5, s[12:15], s49 offen lds
    buffer_load_dwordx4 v5, s[12:15], s49 offen offset:1024 lds
    buffer_load_dwordx4 v5, s[12:15], s49 offen offset:2048 lds
    buffer_load_dwordx4 v5, s[12:15], s49 offen offset:3072 lds
    s_add_u32 m0, s50, 8192
    s_add_u32 s54, s49, 4096
    buffer_load_dwordx4 v5, s[12:15], s54 offen lds
    s_add_u32 s48, s48, 4096
    s_add_u32 s49, s49, 5120
    s_add_u32 s50, s50, 9216
    s_cmp_eq_u32 s50, s53
    s_cselect_b32 s50, s52, s50
    s_add_u32 s24, s82, 0x1000000
    s_addc_u32 s25, s83, 0
    s_and_b32 s25, s25, 0xffff
    s_mov_b32 s26, 0x280000
    s_mov_b32 s27, 0x20000
    s_add_u32 s28, s82, 0x1300000
    s_addc_u32 s29, s83, 0
    s_and_b32 s29, s29, 0xffff
    s_mov_b32 s30, 0x280000
    s_mov_b32 s31, 0x20000
    s_mov_b32 s20, s82
    s_and_b32 s21, s83, 0xffff
    s_mov_b32 s22, 0x100000
    s_mov_b32 s23, 0x20000
    v_lshrrev_b32 v7, 4, v1
    s_lshl_b32 s58, s5, 4
    s_add_u32 s58, s58, s56
    v_and_b32 v20, 15, v1
    v_add_u32 v20, s58, v20
    v_mul_u32_u24 v20, 1280, v20
    v_lshl_add_u32 v20, v7, 4, v20
    s_lshl_b32 s58, s57, 1
    v_add_u32 v20, s58, v20
    v_lshlrev_b32 v21, 3, v7
    v_sub_u32 v21, v20, v21
    buffer_load_dwordx4 v[8:11], v20, s[28:31], 0 offen
    buffer_load_dwordx4 v[12:15], v20, s[28:31], 0 offen offset:64
    buffer_load_dwordx2 v[16:17], v21, s[28:31], 0 offen offset:128
    v_and_b32 v3, 15, v1
    v_lshrrev_b32 v4, 2, v3
    v_sub_u32 v4, 0, v4
    v_xor_b32 v4, v4, v7
    v_and_b32 v4, 3, v4
    v_lshlrev_b32 v22, 6, v3
    v_lshl_add_u32 v22, v4, 4, v22
    v_bfe_u32 v30, v1, 2, 2
    v_lshl_add_u32 v3, v7, 3, v30
    v_mul_u32_u24 v3, 160, v3
    v_and_b32 v4, 3, v1
    v_lshl_add_u32 v3, v4, 4, v3
    v_add_u32 v23, 4096, v3
    v_lshl_add_u32 v3, v7, 3, v30
    v_mul_u32_u24 v3, 160, v3
    v_and_b32 v4, 3, v1
    v_lshl_add_u32 v3, v4, 4, v3
    v_add_u32 v24, 4160, v3
    v_lshl_add_u32 v3, v7, 3, v30
    v_mul_u32_u24 v3, 160, v3
    v_and_b32 v4, 3, v1
    v_lshl_add_u32 v3, v4, 3, v3
    v_add_u32 v25, 4224, v3
    v_mov_b32 v104, 0
    v_mov_b32 v105, 0
    v_mov_b32 v106, 0
    v_mov_b32 v107, 0
    v_mov_b32 v108, 0
    v_mov_b32 v109, 0
    v_mov_b32 v110, 0
    v_mov_b32 v111, 0
    v_mov_b32 v112, 0
    v_mov_b32 v113, 0
    v_mov_b32 v114, 0
    v_mov_b32 v115, 0
    v_mov_b32 v116, 0
    v_mov_b32 v117, 0
    v_mov_b32 v118, 0
    v_mov_b32 v119, 0
    v_mov_b32 v120, 0
    v_mov_b32 v121, 0
    v_mov_b32 v122, 0
    v_mov_b32 v123, 0
    v_mov_b32 v124, 0
    v_mov_b32 v125, 0
    v_mov_b32 v126, 0
    v_mov_b32 v127, 0
    v_mov_b32 v128, 0
    v_mov_b32 v129, 0
    v_mov_b32 v130, 0
    v_mov_b32 v131, 0
    v_mov_b32 v132, 0
    v_mov_b32 v133, 0
    v_mov_b32 v134, 0
    v_mov_b32 v135, 0
    v_mov_b32 v136, 0
    v_mov_b32 v137, 0
    v_mov_b32 v138, 0
    v_mov_b32 v139, 0
    v_mov_b32 v140, 0
    v_mov_b32 v141, 0
    v_mov_b32 v142, 0
    v_mov_b32 v143, 0
    v_mov_b32 v144, 0
    v_mov_b32 v145, 0
    v_mov_b32 v146, 0
    v_mov_b32 v147, 0
    v_mov_b32 v148, 0
    v_mov_b32 v149, 0
    v_mov_b32 v150, 0
    v_mov_b32 v151, 0
    v_mov_b32 v152, 0
    v_mov_b32 v153, 0
    v_mov_b32 v154, 0
    v_mov_b32 v155, 0
    v_mov_b32 v156, 0
    v_mov_b32 v157, 0
    v_mov_b32 v158, 0
    v_mov_b32 v159, 0
    v_mov_b32 v160, 0
    v_mov_b32 v161, 0
    v_mov_b32 v162, 0
    v_mov_b32 v163, 0
    v_mov_b32 v164, 0
    v_mov_b32 v165, 0
    v_mov_b32 v166, 0
    v_mov_b32 v167, 0
    v_mov_b32 v168, 0
    v_mov_b32 v169, 0
    v_mov_b32 v170, 0
    v_mov_b32 v171, 0
    v_mov_b32 v172, 0
    v_mov_b32 v173, 0
    v_mov_b32 v174, 0
    v_mov_b32 v175, 0
    v_mov_b32 v176, 0
    v_mov_b32 v177, 0
    v_mov_b32 v178, 0
    v_mov_b32 v179, 0
    v_mov_b32 v180, 0
    v_mov_b32 v181, 0
    v_mov_b32 v182, 0
    v_mov_b32 v183, 0
    s_waitcnt vmcnt(30)
    v_add_u32 v26, s51, v22
    v_add_u32 v27, s51, v23
    v_add_u32 v28, s51, v24
    v_add_u32 v29, s51, v25
    s_add_u32 s51, s51, 9216
    s_cmp_eq_u32 s51, s53
    s_cselect_b32 s51, s52, s51
    ds_read_b128 v[32:35], v26 offset:0
    ds_read_b128 v[36:39], v26 offset:1024
    ds_read_b128 v[40:43], v26 offset:2048
    ds_read_b128 v[44:47], v26 offset:3072
    ds_read_b64_tr_b16 v[64:65], v27 offset:0
    ds_read_b64_tr_b16 v[66:67], v27 offset:640
    ds_read_b64_tr_b16 v[68:69], v27 offset:8
    ds_read_b64_tr_b16 v[70:71], v27 offset:648
    ds_read_b64_tr_b16 v[72:73], v28 offset:0
    ds_read_b64_tr_b16 v[74:75], v28 offset:640
    ds_read_b64_tr_b16 v[76:77], v28 offset:8
    ds_read_b64_tr_b16 v[78:79], v28 offset:648
    ds_read_b64_tr_b16 v[80:81], v29 offset:0
    ds_read_b64_tr_b16 v[82:83], v29 offset:640
    s_waitcnt lgkmcnt(0)
loop_oproj1_kernel_2:
    s_cmp_le_u32 s55, 4
    s_cbranch_scc1 tail_oproj1_kernel_5
    s_waitcnt vmcnt(18)
    v_add_u32 v26, s51, v22
    v_add_u32 v27, s51, v23
    v_add_u32 v28, s51, v24
    v_add_u32 v29, s51, v25
    s_add_u32 s51, s51, 9216
    s_cmp_eq_u32 s51, s53
    s_cselect_b32 s51, s52, s51
    ds_read_b128 v[48:51], v26 offset:0
    ds_read_b128 v[52:55], v26 offset:1024
    v_mfma_f32_16x16x32_bf16 v[104:107], v[64:67], v[32:35], v[104:107]
    ds_read_b128 v[56:59], v26 offset:2048
    v_mfma_f32_16x16x32_bf16 v[124:127], v[64:67], v[36:39], v[124:127]
    ds_read_b128 v[60:63], v26 offset:3072
    v_mfma_f32_16x16x32_bf16 v[144:147], v[64:67], v[40:43], v[144:147]
    ds_read_b64_tr_b16 v[84:85], v27 offset:0
    v_mfma_f32_16x16x32_bf16 v[164:167], v[64:67], v[44:47], v[164:167]
    ds_read_b64_tr_b16 v[86:87], v27 offset:640
    v_mfma_f32_16x16x32_bf16 v[108:111], v[68:71], v[32:35], v[108:111]
    ds_read_b64_tr_b16 v[88:89], v27 offset:8
    ds_read_b64_tr_b16 v[90:91], v27 offset:648
    v_mfma_f32_16x16x32_bf16 v[128:131], v[68:71], v[36:39], v[128:131]
    ds_read_b64_tr_b16 v[92:93], v28 offset:0
    v_mfma_f32_16x16x32_bf16 v[148:151], v[68:71], v[40:43], v[148:151]
    ds_read_b64_tr_b16 v[94:95], v28 offset:640
    v_mfma_f32_16x16x32_bf16 v[168:171], v[68:71], v[44:47], v[168:171]
    ds_read_b64_tr_b16 v[96:97], v28 offset:8
    v_mfma_f32_16x16x32_bf16 v[112:115], v[72:75], v[32:35], v[112:115]
    ds_read_b64_tr_b16 v[98:99], v28 offset:648
    v_mfma_f32_16x16x32_bf16 v[132:135], v[72:75], v[36:39], v[132:135]
    ds_read_b64_tr_b16 v[100:101], v29 offset:0
    ds_read_b64_tr_b16 v[102:103], v29 offset:640
    v_mfma_f32_16x16x32_bf16 v[152:155], v[72:75], v[40:43], v[152:155]
    s_mov_b32 m0, s50
    s_nop 0
    buffer_load_dwordx4 v5, s[8:11], s48 offen lds
    v_mfma_f32_16x16x32_bf16 v[172:175], v[72:75], v[44:47], v[172:175]
    buffer_load_dwordx4 v5, s[8:11], s48 offen offset:1024 lds
    v_mfma_f32_16x16x32_bf16 v[116:119], v[76:79], v[32:35], v[116:119]
    buffer_load_dwordx4 v5, s[8:11], s48 offen offset:2048 lds
    v_mfma_f32_16x16x32_bf16 v[136:139], v[76:79], v[36:39], v[136:139]
    buffer_load_dwordx4 v5, s[8:11], s48 offen offset:3072 lds
    v_mfma_f32_16x16x32_bf16 v[156:159], v[76:79], v[40:43], v[156:159]
    s_add_u32 m0, s50, 4096
    s_nop 0
    buffer_load_dwordx4 v5, s[12:15], s49 offen lds
    buffer_load_dwordx4 v5, s[12:15], s49 offen offset:1024 lds
    v_mfma_f32_16x16x32_bf16 v[176:179], v[76:79], v[44:47], v[176:179]
    buffer_load_dwordx4 v5, s[12:15], s49 offen offset:2048 lds
    v_mfma_f32_16x16x32_bf16 v[120:123], v[80:83], v[32:35], v[120:123]
    buffer_load_dwordx4 v5, s[12:15], s49 offen offset:3072 lds
    v_mfma_f32_16x16x32_bf16 v[140:143], v[80:83], v[36:39], v[140:143]
    s_add_u32 m0, s50, 8192
    s_add_u32 s54, s49, 4096
    buffer_load_dwordx4 v5, s[12:15], s54 offen lds
    v_mfma_f32_16x16x32_bf16 v[160:163], v[80:83], v[40:43], v[160:163]
    s_add_u32 s48, s48, 4096
    s_add_u32 s49, s49, 5120
    s_add_u32 s50, s50, 9216
    s_cmp_eq_u32 s50, s53
    s_cselect_b32 s50, s52, s50
    v_mfma_f32_16x16x32_bf16 v[180:183], v[80:83], v[44:47], v[180:183]
    s_nop 0
    s_nop 0
    s_branch join_oproj1_kernel_6
tail_oproj1_kernel_5:
    s_waitcnt vmcnt(0)
    v_add_u32 v26, s51, v22
    v_add_u32 v27, s51, v23
    v_add_u32 v28, s51, v24
    v_add_u32 v29, s51, v25
    s_add_u32 s51, s51, 9216
    s_cmp_eq_u32 s51, s53
    s_cselect_b32 s51, s52, s51
    ds_read_b128 v[48:51], v26 offset:0
    ds_read_b128 v[52:55], v26 offset:1024
    v_mfma_f32_16x16x32_bf16 v[104:107], v[64:67], v[32:35], v[104:107]
    v_mfma_f32_16x16x32_bf16 v[124:127], v[64:67], v[36:39], v[124:127]
    ds_read_b128 v[56:59], v26 offset:2048
    v_mfma_f32_16x16x32_bf16 v[144:147], v[64:67], v[40:43], v[144:147]
    v_mfma_f32_16x16x32_bf16 v[164:167], v[64:67], v[44:47], v[164:167]
    ds_read_b128 v[60:63], v26 offset:3072
    v_mfma_f32_16x16x32_bf16 v[108:111], v[68:71], v[32:35], v[108:111]
    ds_read_b64_tr_b16 v[84:85], v27 offset:0
    v_mfma_f32_16x16x32_bf16 v[128:131], v[68:71], v[36:39], v[128:131]
    v_mfma_f32_16x16x32_bf16 v[148:151], v[68:71], v[40:43], v[148:151]
    ds_read_b64_tr_b16 v[86:87], v27 offset:640
    v_mfma_f32_16x16x32_bf16 v[168:171], v[68:71], v[44:47], v[168:171]
    v_mfma_f32_16x16x32_bf16 v[112:115], v[72:75], v[32:35], v[112:115]
    ds_read_b64_tr_b16 v[88:89], v27 offset:8
    v_mfma_f32_16x16x32_bf16 v[132:135], v[72:75], v[36:39], v[132:135]
    ds_read_b64_tr_b16 v[90:91], v27 offset:648
    v_mfma_f32_16x16x32_bf16 v[152:155], v[72:75], v[40:43], v[152:155]
    v_mfma_f32_16x16x32_bf16 v[172:175], v[72:75], v[44:47], v[172:175]
    ds_read_b64_tr_b16 v[92:93], v28 offset:0
    v_mfma_f32_16x16x32_bf16 v[116:119], v[76:79], v[32:35], v[116:119]
    v_mfma_f32_16x16x32_bf16 v[136:139], v[76:79], v[36:39], v[136:139]
    ds_read_b64_tr_b16 v[94:95], v28 offset:640
    v_mfma_f32_16x16x32_bf16 v[156:159], v[76:79], v[40:43], v[156:159]
    ds_read_b64_tr_b16 v[96:97], v28 offset:8
    v_mfma_f32_16x16x32_bf16 v[176:179], v[76:79], v[44:47], v[176:179]
    v_mfma_f32_16x16x32_bf16 v[120:123], v[80:83], v[32:35], v[120:123]
    ds_read_b64_tr_b16 v[98:99], v28 offset:648
    v_mfma_f32_16x16x32_bf16 v[140:143], v[80:83], v[36:39], v[140:143]
    v_mfma_f32_16x16x32_bf16 v[160:163], v[80:83], v[40:43], v[160:163]
    ds_read_b64_tr_b16 v[100:101], v29 offset:0
    v_mfma_f32_16x16x32_bf16 v[180:183], v[80:83], v[44:47], v[180:183]
    ds_read_b64_tr_b16 v[102:103], v29 offset:640
join_oproj1_kernel_6:
    s_waitcnt lgkmcnt(0)
    s_sub_u32 s55, s55, 1
    s_cmp_eq_u32 s55, 1
    s_cbranch_scc1 lastB_oproj1_kernel_3
    s_cmp_le_u32 s55, 4
    s_cbranch_scc1 tail_oproj1_kernel_7
    s_waitcnt vmcnt(18)
    v_add_u32 v26, s51, v22
    v_add_u32 v27, s51, v23
    v_add_u32 v28, s51, v24
    v_add_u32 v29, s51, v25
    s_add_u32 s51, s51, 9216
    s_cmp_eq_u32 s51, s53
    s_cselect_b32 s51, s52, s51
    ds_read_b128 v[32:35], v26 offset:0
    ds_read_b128 v[36:39], v26 offset:1024
    v_mfma_f32_16x16x32_bf16 v[104:107], v[84:87], v[48:51], v[104:107]
    ds_read_b128 v[40:43], v26 offset:2048
    v_mfma_f32_16x16x32_bf16 v[124:127], v[84:87], v[52:55], v[124:127]
    ds_read_b128 v[44:47], v26 offset:3072
    v_mfma_f32_16x16x32_bf16 v[144:147], v[84:87], v[56:59], v[144:147]
    ds_read_b64_tr_b16 v[64:65], v27 offset:0
    v_mfma_f32_16x16x32_bf16 v[164:167], v[84:87], v[60:63], v[164:167]
    ds_read_b64_tr_b16 v[66:67], v27 offset:640
    v_mfma_f32_16x16x32_bf16 v[108:111], v[88:91], v[48:51], v[108:111]
    ds_read_b64_tr_b16 v[68:69], v27 offset:8
    ds_read_b64_tr_b16 v[70:71], v27 offset:648
    v_mfma_f32_16x16x32_bf16 v[128:131], v[88:91], v[52:55], v[128:131]
    ds_read_b64_tr_b16 v[72:73], v28 offset:0
    v_mfma_f32_16x16x32_bf16 v[148:151], v[88:91], v[56:59], v[148:151]
    ds_read_b64_tr_b16 v[74:75], v28 offset:640
    v_mfma_f32_16x16x32_bf16 v[168:171], v[88:91], v[60:63], v[168:171]
    ds_read_b64_tr_b16 v[76:77], v28 offset:8
    v_mfma_f32_16x16x32_bf16 v[112:115], v[92:95], v[48:51], v[112:115]
    ds_read_b64_tr_b16 v[78:79], v28 offset:648
    v_mfma_f32_16x16x32_bf16 v[132:135], v[92:95], v[52:55], v[132:135]
    ds_read_b64_tr_b16 v[80:81], v29 offset:0
    ds_read_b64_tr_b16 v[82:83], v29 offset:640
    v_mfma_f32_16x16x32_bf16 v[152:155], v[92:95], v[56:59], v[152:155]
    s_mov_b32 m0, s50
    s_nop 0
    buffer_load_dwordx4 v5, s[8:11], s48 offen lds
    v_mfma_f32_16x16x32_bf16 v[172:175], v[92:95], v[60:63], v[172:175]
    buffer_load_dwordx4 v5, s[8:11], s48 offen offset:1024 lds
    v_mfma_f32_16x16x32_bf16 v[116:119], v[96:99], v[48:51], v[116:119]
    buffer_load_dwordx4 v5, s[8:11], s48 offen offset:2048 lds
    v_mfma_f32_16x16x32_bf16 v[136:139], v[96:99], v[52:55], v[136:139]
    buffer_load_dwordx4 v5, s[8:11], s48 offen offset:3072 lds
    v_mfma_f32_16x16x32_bf16 v[156:159], v[96:99], v[56:59], v[156:159]
    s_add_u32 m0, s50, 4096
    s_nop 0
    buffer_load_dwordx4 v5, s[12:15], s49 offen lds
    buffer_load_dwordx4 v5, s[12:15], s49 offen offset:1024 lds
    v_mfma_f32_16x16x32_bf16 v[176:179], v[96:99], v[60:63], v[176:179]
    buffer_load_dwordx4 v5, s[12:15], s49 offen offset:2048 lds
    v_mfma_f32_16x16x32_bf16 v[120:123], v[100:103], v[48:51], v[120:123]
    buffer_load_dwordx4 v5, s[12:15], s49 offen offset:3072 lds
    v_mfma_f32_16x16x32_bf16 v[140:143], v[100:103], v[52:55], v[140:143]
    s_add_u32 m0, s50, 8192
    s_add_u32 s54, s49, 4096
    buffer_load_dwordx4 v5, s[12:15], s54 offen lds
    v_mfma_f32_16x16x32_bf16 v[160:163], v[100:103], v[56:59], v[160:163]
    s_add_u32 s48, s48, 4096
    s_add_u32 s49, s49, 5120
    s_add_u32 s50, s50, 9216
    s_cmp_eq_u32 s50, s53
    s_cselect_b32 s50, s52, s50
    v_mfma_f32_16x16x32_bf16 v[180:183], v[100:103], v[60:63], v[180:183]
    s_nop 0
    s_nop 0
    s_branch join_oproj1_kernel_8
tail_oproj1_kernel_7:
    s_waitcnt vmcnt(0)
    v_add_u32 v26, s51, v22
    v_add_u32 v27, s51, v23
    v_add_u32 v28, s51, v24
    v_add_u32 v29, s51, v25
    s_add_u32 s51, s51, 9216
    s_cmp_eq_u32 s51, s53
    s_cselect_b32 s51, s52, s51
    ds_read_b128 v[32:35], v26 offset:0
    ds_read_b128 v[36:39], v26 offset:1024
    v_mfma_f32_16x16x32_bf16 v[104:107], v[84:87], v[48:51], v[104:107]
    v_mfma_f32_16x16x32_bf16 v[124:127], v[84:87], v[52:55], v[124:127]
    ds_read_b128 v[40:43], v26 offset:2048
    v_mfma_f32_16x16x32_bf16 v[144:147], v[84:87], v[56:59], v[144:147]
    v_mfma_f32_16x16x32_bf16 v[164:167], v[84:87], v[60:63], v[164:167]
    ds_read_b128 v[44:47], v26 offset:3072
    v_mfma_f32_16x16x32_bf16 v[108:111], v[88:91], v[48:51], v[108:111]
    ds_read_b64_tr_b16 v[64:65], v27 offset:0
    v_mfma_f32_16x16x32_bf16 v[128:131], v[88:91], v[52:55], v[128:131]
    v_mfma_f32_16x16x32_bf16 v[148:151], v[88:91], v[56:59], v[148:151]
    ds_read_b64_tr_b16 v[66:67], v27 offset:640
    v_mfma_f32_16x16x32_bf16 v[168:171], v[88:91], v[60:63], v[168:171]
    v_mfma_f32_16x16x32_bf16 v[112:115], v[92:95], v[48:51], v[112:115]
    ds_read_b64_tr_b16 v[68:69], v27 offset:8
    v_mfma_f32_16x16x32_bf16 v[132:135], v[92:95], v[52:55], v[132:135]
    ds_read_b64_tr_b16 v[70:71], v27 offset:648
    v_mfma_f32_16x16x32_bf16 v[152:155], v[92:95], v[56:59], v[152:155]
    v_mfma_f32_16x16x32_bf16 v[172:175], v[92:95], v[60:63], v[172:175]
    ds_read_b64_tr_b16 v[72:73], v28 offset:0
    v_mfma_f32_16x16x32_bf16 v[116:119], v[96:99], v[48:51], v[116:119]
    v_mfma_f32_16x16x32_bf16 v[136:139], v[96:99], v[52:55], v[136:139]
    ds_read_b64_tr_b16 v[74:75], v28 offset:640
    v_mfma_f32_16x16x32_bf16 v[156:159], v[96:99], v[56:59], v[156:159]
    ds_read_b64_tr_b16 v[76:77], v28 offset:8
    v_mfma_f32_16x16x32_bf16 v[176:179], v[96:99], v[60:63], v[176:179]
    v_mfma_f32_16x16x32_bf16 v[120:123], v[100:103], v[48:51], v[120:123]
    ds_read_b64_tr_b16 v[78:79], v28 offset:648
    v_mfma_f32_16x16x32_bf16 v[140:143], v[100:103], v[52:55], v[140:143]
    v_mfma_f32_16x16x32_bf16 v[160:163], v[100:103], v[56:59], v[160:163]
    ds_read_b64_tr_b16 v[80:81], v29 offset:0
    v_mfma_f32_16x16x32_bf16 v[180:183], v[100:103], v[60:63], v[180:183]
    ds_read_b64_tr_b16 v[82:83], v29 offset:640
join_oproj1_kernel_8:
    s_waitcnt lgkmcnt(0)
    s_sub_u32 s55, s55, 1
    s_cmp_eq_u32 s55, 1
    s_cbranch_scc0 loop_oproj1_kernel_2
    v_mfma_f32_16x16x32_bf16 v[104:107], v[64:67], v[32:35], v[104:107]
    v_mfma_f32_16x16x32_bf16 v[124:127], v[64:67], v[36:39], v[124:127]
    v_mfma_f32_16x16x32_bf16 v[144:147], v[64:67], v[40:43], v[144:147]
    v_mfma_f32_16x16x32_bf16 v[164:167], v[64:67], v[44:47], v[164:167]
    v_mfma_f32_16x16x32_bf16 v[108:111], v[68:71], v[32:35], v[108:111]
    v_mfma_f32_16x16x32_bf16 v[128:131], v[68:71], v[36:39], v[128:131]
    v_mfma_f32_16x16x32_bf16 v[148:151], v[68:71], v[40:43], v[148:151]
    v_mfma_f32_16x16x32_bf16 v[168:171], v[68:71], v[44:47], v[168:171]
    v_mfma_f32_16x16x32_bf16 v[112:115], v[72:75], v[32:35], v[112:115]
    v_mfma_f32_16x16x32_bf16 v[132:135], v[72:75], v[36:39], v[132:135]
    v_mfma_f32_16x16x32_bf16 v[152:155], v[72:75], v[40:43], v[152:155]
    v_mfma_f32_16x16x32_bf16 v[172:175], v[72:75], v[44:47], v[172:175]
    v_mfma_f32_16x16x32_bf16 v[116:119], v[76:79], v[32:35], v[116:119]
    v_mfma_f32_16x16x32_bf16 v[136:139], v[76:79], v[36:39], v[136:139]
    v_mfma_f32_16x16x32_bf16 v[156:159], v[76:79], v[40:43], v[156:159]
    v_mfma_f32_16x16x32_bf16 v[176:179], v[76:79], v[44:47], v[176:179]
    v_mfma_f32_16x16x32_bf16 v[120:123], v[80:83], v[32:35], v[120:123]
    v_mfma_f32_16x16x32_bf16 v[140:143], v[80:83], v[36:39], v[140:143]
    v_mfma_f32_16x16x32_bf16 v[160:163], v[80:83], v[40:43], v[160:163]
    v_mfma_f32_16x16x32_bf16 v[180:183], v[80:83], v[44:47], v[180:183]
    s_branch done_oproj1_kernel_4
lastB_oproj1_kernel_3:
    v_mfma_f32_16x16x32_bf16 v[104:107], v[84:87], v[48:51], v[104:107]
    v_mfma_f32_16x16x32_bf16 v[124:127], v[84:87], v[52:55], v[124:127]
    v_mfma_f32_16x16x32_bf16 v[144:147], v[84:87], v[56:59], v[144:147]
    v_mfma_f32_16x16x32_bf16 v[164:167], v[84:87], v[60:63], v[164:167]
    v_mfma_f32_16x16x32_bf16 v[108:111], v[88:91], v[48:51], v[108:111]
    v_mfma_f32_16x16x32_bf16 v[128:131], v[88:91], v[52:55], v[128:131]
    v_mfma_f32_16x16x32_bf16 v[148:151], v[88:91], v[56:59], v[148:151]
    v_mfma_f32_16x16x32_bf16 v[168:171], v[88:91], v[60:63], v[168:171]
    v_mfma_f32_16x16x32_bf16 v[112:115], v[92:95], v[48:51], v[112:115]
    v_mfma_f32_16x16x32_bf16 v[132:135], v[92:95], v[52:55], v[132:135]
    v_mfma_f32_16x16x32_bf16 v[152:155], v[92:95], v[56:59], v[152:155]
    v_mfma_f32_16x16x32_bf16 v[172:175], v[92:95], v[60:63], v[172:175]
    v_mfma_f32_16x16x32_bf16 v[116:119], v[96:99], v[48:51], v[116:119]
    v_mfma_f32_16x16x32_bf16 v[136:139], v[96:99], v[52:55], v[136:139]
    v_mfma_f32_16x16x32_bf16 v[156:159], v[96:99], v[56:59], v[156:159]
    v_mfma_f32_16x16x32_bf16 v[176:179], v[96:99], v[60:63], v[176:179]
    v_mfma_f32_16x16x32_bf16 v[120:123], v[100:103], v[48:51], v[120:123]
    v_mfma_f32_16x16x32_bf16 v[140:143], v[100:103], v[52:55], v[140:143]
    v_mfma_f32_16x16x32_bf16 v[160:163], v[100:103], v[56:59], v[160:163]
    v_mfma_f32_16x16x32_bf16 v[180:183], v[100:103], v[60:63], v[180:183]
done_oproj1_kernel_4:
    s_nop 7
    s_barrier
    v_lshlrev_b32 v184, 4, v1
    s_mul_i32 s58, s5, 20480
    v_add_u32 v3, s58, v184
    ds_write_b128 v3, v[104:107] offset:0
    ds_write_b128 v3, v[108:111] offset:1024
    ds_write_b128 v3, v[112:115] offset:2048
    ds_write_b128 v3, v[116:119] offset:3072
    ds_write_b128 v3, v[120:123] offset:4096
    ds_write_b128 v3, v[124:127] offset:5120
    ds_write_b128 v3, v[128:131] offset:6144
    ds_write_b128 v3, v[132:135] offset:7168
    ds_write_b128 v3, v[136:139] offset:8192
    ds_write_b128 v3, v[140:143] offset:9216
    ds_write_b128 v3, v[144:147] offset:10240
    ds_write_b128 v3, v[148:151] offset:11264
    ds_write_b128 v3, v[152:155] offset:12288
    ds_write_b128 v3, v[156:159] offset:13312
    ds_write_b128 v3, v[160:163] offset:14336
    ds_write_b128 v3, v[164:167] offset:15360
    ds_write_b128 v3, v[168:171] offset:16384
    ds_write_b128 v3, v[172:175] offset:17408
    ds_write_b128 v3, v[176:179] offset:18432
    ds_write_b128 v3, v[180:183] offset:19456
    s_waitcnt lgkmcnt(0)
    s_barrier
    s_mul_i32 s58, s5, 5120
    v_add_u32 v3, s58, v184
    v_add_u32 v4, 40960, v3
    ds_read_b128 v[104:107], v3 offset:0
    ds_read_b128 v[108:111], v3 offset:1024
    ds_read_b128 v[112:115], v3 offset:2048
    ds_read_b128 v[116:119], v3 offset:3072
    ds_read_b128 v[120:123], v3 offset:4096
    ds_read_b128 v[32:35], v3 offset:20480
    ds_read_b128 v[36:39], v3 offset:21504
    ds_read_b128 v[40:43], v3 offset:22528
    ds_read_b128 v[44:47], v3 offset:23552
    ds_read_b128 v[48:51], v3 offset:24576
    ds_read_b128 v[52:55], v4 offset:0
    ds_read_b128 v[56:59], v4 offset:1024
    ds_read_b128 v[60:63], v4 offset:2048
    ds_read_b128 v[64:67], v4 offset:3072
    ds_read_b128 v[68:71], v4 offset:4096
    ds_read_b128 v[72:75], v4 offset:20480
    ds_read_b128 v[76:79], v4 offset:21504
    ds_read_b128 v[80:83], v4 offset:22528
    ds_read_b128 v[84:87], v4 offset:23552
    ds_read_b128 v[88:91], v4 offset:24576
    s_waitcnt lgkmcnt(0)
    v_add_f32 v104, v104, v32
    v_add_f32 v104, v104, v52
    v_add_f32 v104, v104, v72
    v_add_f32 v105, v105, v33
    v_add_f32 v105, v105, v53
    v_add_f32 v105, v105, v73
    v_add_f32 v106, v106, v34
    v_add_f32 v106, v106, v54
    v_add_f32 v106, v106, v74
    v_add_f32 v107, v107, v35
    v_add_f32 v107, v107, v55
    v_add_f32 v107, v107, v75
    v_add_f32 v108, v108, v36
    v_add_f32 v108, v108, v56
    v_add_f32 v108, v108, v76
    v_add_f32 v109, v109, v37
    v_add_f32 v109, v109, v57
    v_add_f32 v109, v109, v77
    v_add_f32 v110, v110, v38
    v_add_f32 v110, v110, v58
    v_add_f32 v110, v110, v78
    v_add_f32 v111, v111, v39
    v_add_f32 v111, v111, v59
    v_add_f32 v111, v111, v79
    v_add_f32 v112, v112, v40
    v_add_f32 v112, v112, v60
    v_add_f32 v112, v112, v80
    v_add_f32 v113, v113, v41
    v_add_f32 v113, v113, v61
    v_add_f32 v113, v113, v81
    v_add_f32 v114, v114, v42
    v_add_f32 v114, v114, v62
    v_add_f32 v114, v114, v82
    v_add_f32 v115, v115, v43
    v_add_f32 v115, v115, v63
    v_add_f32 v115, v115, v83
    v_add_f32 v116, v116, v44
    v_add_f32 v116, v116, v64
    v_add_f32 v116, v116, v84
    v_add_f32 v117, v117, v45
    v_add_f32 v117, v117, v65
    v_add_f32 v117, v117, v85
    v_add_f32 v118, v118, v46
    v_add_f32 v118, v118, v66
    v_add_f32 v118, v118, v86
    v_add_f32 v119, v119, v47
    v_add_f32 v119, v119, v67
    v_add_f32 v119, v119, v87
    v_add_f32 v120, v120, v48
    v_add_f32 v120, v120, v68
    v_add_f32 v120, v120, v88
    v_add_f32 v121, v121, v49
    v_add_f32 v121, v121, v69
    v_add_f32 v121, v121, v89
    v_add_f32 v122, v122, v50
    v_add_f32 v122, v122, v70
    v_add_f32 v122, v122, v90
    v_add_f32 v123, v123, v51
    v_add_f32 v123, v123, v71
    v_add_f32 v123, v123, v91
    v_mov_b32 v136, 0
    v_mov_b32 v137, 0
    v_lshlrev_b32 v140, 16, v8
    v_add_f32 v128, v104, v140
    v_and_b32 v140, 0xffff0000, v8
    v_add_f32 v129, v105, v140
    v_lshlrev_b32 v140, 16, v9
    v_add_f32 v130, v106, v140
    v_and_b32 v140, 0xffff0000, v9
    v_add_f32 v131, v107, v140
    v_lshlrev_b32 v140, 16, v10
    v_add_f32 v132, v108, v140
    v_and_b32 v140, 0xffff0000, v10
    v_add_f32 v133, v109, v140
    v_lshlrev_b32 v140, 16, v11
    v_add_f32 v134, v110, v140
    v_and_b32 v140, 0xffff0000, v11
    v_add_f32 v135, v111, v140
    v_cvt_pk_bf16_f32 v8, v128, v129
    v_cvt_pk_bf16_f32 v9, v130, v131
    v_cvt_pk_bf16_f32 v10, v132, v133
    v_cvt_pk_bf16_f32 v11, v134, v135
    buffer_store_dwordx4 v[8:11], v20, s[24:27], 0 offen offset:0
    v_lshlrev_b32 v140, 16, v8
    v_and_b32 v142, 0xffff0000, v8
    v_add_f32 v136, v136, v140
    v_fmac_f32 v137, v140, v140
    v_add_f32 v136, v136, v142
    v_fmac_f32 v137, v142, v142
    v_lshlrev_b32 v140, 16, v9
    v_and_b32 v142, 0xffff0000, v9
    v_add_f32 v136, v136, v140
    v_fmac_f32 v137, v140, v140
    v_add_f32 v136, v136, v142
    v_fmac_f32 v137, v142, v142
    v_lshlrev_b32 v140, 16, v10
    v_and_b32 v142, 0xffff0000, v10
    v_add_f32 v136, v136, v140
    v_fmac_f32 v137, v140, v140
    v_add_f32 v136, v136, v142
    v_fmac_f32 v137, v142, v142
    v_lshlrev_b32 v140, 16, v11
    v_and_b32 v142, 0xffff0000, v11
    v_add_f32 v136, v136, v140
    v_fmac_f32 v137, v140, v140
    v_add_f32 v136, v136, v142
    v_fmac_f32 v137, v142, v142
    v_lshlrev_b32 v140, 16, v12
    v_add_f32 v128, v112, v140
    v_and_b32 v140, 0xffff0000, v12
    v_add_f32 v129, v113, v140
    v_lshlrev_b32 v140, 16, v13
    v_add_f32 v130, v114, v140
    v_and_b32 v140, 0xffff0000, v13
    v_add_f32 v131, v115, v140
    v_lshlrev_b32 v140, 16, v14
    v_add_f32 v132, v116, v140
    v_and_b32 v140, 0xffff0000, v14
    v_add_f32 v133, v117, v140
    v_lshlrev_b32 v140, 16, v15
    v_add_f32 v134, v118, v140
    v_and_b32 v140, 0xffff0000, v15
    v_add_f32 v135, v119, v140
    v_cvt_pk_bf16_f32 v12, v128, v129
    v_cvt_pk_bf16_f32 v13, v130, v131
    v_cvt_pk_bf16_f32 v14, v132, v133
    v_cvt_pk_bf16_f32 v15, v134, v135
    buffer_store_dwordx4 v[12:15], v20, s[24:27], 0 offen offset:64
    v_lshlrev_b32 v140, 16, v12
    v_and_b32 v142, 0xffff0000, v12
    v_add_f32 v136, v136, v140
    v_fmac_f32 v137, v140, v140
    v_add_f32 v136, v136, v142
    v_fmac_f32 v137, v142, v142
    v_lshlrev_b32 v140, 16, v13
    v_and_b32 v142, 0xffff0000, v13
    v_add_f32 v136, v136, v140
    v_fmac_f32 v137, v140, v140
    v_add_f32 v136, v136, v142
    v_fmac_f32 v137, v142, v142
    v_lshlrev_b32 v140, 16, v14
    v_and_b32 v142, 0xffff0000, v14
    v_add_f32 v136, v136, v140
    v_fmac_f32 v137, v140, v140
    v_add_f32 v136, v136, v142
    v_fmac_f32 v137, v142, v142
    v_lshlrev_b32 v140, 16, v15
    v_and_b32 v142, 0xffff0000, v15
    v_add_f32 v136, v136, v140
    v_fmac_f32 v137, v140, v140
    v_add_f32 v136, v136, v142
    v_fmac_f32 v137, v142, v142
    v_lshlrev_b32 v140, 16, v16
    v_add_f32 v128, v120, v140
    v_and_b32 v140, 0xffff0000, v16
    v_add_f32 v129, v121, v140
    v_lshlrev_b32 v140, 16, v17
    v_add_f32 v130, v122, v140
    v_and_b32 v140, 0xffff0000, v17
    v_add_f32 v131, v123, v140
    v_cvt_pk_bf16_f32 v16, v128, v129
    v_cvt_pk_bf16_f32 v17, v130, v131
    buffer_store_dwordx2 v[16:17], v21, s[24:27], 0 offen offset:128
    v_lshlrev_b32 v140, 16, v16
    v_and_b32 v142, 0xffff0000, v16
    v_add_f32 v136, v136, v140
    v_fmac_f32 v137, v140, v140
    v_add_f32 v136, v136, v142
    v_fmac_f32 v137, v142, v142
    v_lshlrev_b32 v140, 16, v17
    v_and_b32 v142, 0xffff0000, v17
    v_add_f32 v136, v136, v140
    v_fmac_f32 v137, v140, v140
    v_add_f32 v136, v136, v142
    v_fmac_f32 v137, v142, v142
    v_mov_b32 v140, v136
    v_mov_b32 v141, v137
    s_nop 1
    v_permlane16_swap_b32 v136, v140
    v_permlane16_swap_b32 v137, v141
    v_add_f32 v136, v136, v140
    v_add_f32 v137, v137, v141
    v_mov_b32 v140, v136
    v_mov_b32 v141, v137
    s_nop 1
    v_permlane32_swap_b32 v136, v140
    v_permlane32_swap_b32 v137, v141
    v_add_f32 v136, v136, v140
    v_add_f32 v137, v137, v141
    s_lshl_b32 s58, s5, 4
    s_add_u32 s58, s58, s56
    v_add_u32 v140, s58, v1
    v_lshlrev_b32 v140, 6, v140
    s_lshl_b32 s58, s4, 3
    s_add_u32 s58, s58, 0x8000
    v_add_u32 v140, s58, v140
    v_cmp_gt_u32 vcc, 16, v1
    s_and_saveexec_b64 s[60:61], vcc
    s_cbranch_execz st_oproj1_kernel_9
    buffer_store_dwordx2 v[136:137], v140, s[20:23], 0 offen
st_oproj1_kernel_9:
    s_mov_b64 exec, s[60:61]
end_oproj1_kernel_1:
    s_endpgm
.globl down1_kernel
.p2align 8
.type down1_kernel,@function
down1_kernel:
    s_cmp_ge_u32 s2, 256
    s_cbranch_scc1 end_down1_kernel_1
    s_load_dwordx16 s[64:79], s[0:1], 0
    s_load_dwordx4 s[80:83], s[0:1], 64
    s_and_b32 s3, s2, 31
    s_lshr_b32 s4, s2, 5
    v_and_b32 v1, 63, v0
    v_lshrrev_b32 v2, 6, v0
    s_nop 0
    v_readfirstlane_b32 s5, v2
    s_lshl_b32 s56, s3, 6
    s_mul_i32 s57, s4, 80
    s_min_u32 s58, s5, 2
    s_mul_i32 s59, s5, 13
    s_add_u32 s59, s59, s58
    s_cmp_lt_u32 s5, 2
    s_cselect_b32 s55, 14, 13
    v_lshlrev_b32 v5, 4, v1
    s_mul_i32 s48, s3, 54
    s_add_u32 s48, s48, s59
    s_lshl_b32 s48, s48, 12
    s_mul_i32 s49, s4, 1728
    s_lshl_b32 s58, s59, 5
    s_add_u32 s49, s49, s58
    s_mul_i32 s49, s49, 160
    s_mul_i32 s52, s5, 36864
    s_add_u32 s53, s52, 36864
    s_mov_b32 s50, s52
    s_mov_b32 s51, s52
    s_waitcnt lgkmcnt(0)
    s_add_u32 s8, s82, 0x1600000
    s_addc_u32 s9, s83, 0
    s_and_b32 s9, s9, 0xffff
    s_mov_b32 s10, 0x6c0000
    s_mov_b32 s11, 0x20000
    s_add_u32 s12, s82, 0x2100000
    s_addc_u32 s13, s83, 0
    s_and_b32 s13, s13, 0xffff
    s_mov_b32 s14, 0x21c000
    s_mov_b32 s15, 0x20000
    s_mov_b32 m0, s50
    s_nop 0
    buffer_load_dwordx4 v5, s[8:11], s48 offen lds
    buffer_load_dwordx4 v5, s[8:11], s48 offen offset:1024 lds
    buffer_load_dwordx4 v5, s[8:11], s48 offen offset:2048 lds
    buffer_load_dwordx4 v5, s[8:11], s48 offen offset:3072 lds
    s_add_u32 m0, s50, 4096
    s_nop 0
    buffer_load_dwordx4 v5, s[12:15], s49 offen lds
    buffer_load_dwordx4 v5, s[12:15], s49 offen offset:1024 lds
    buffer_load_dwordx4 v5, s[12:15], s49 offen offset:2048 lds
    buffer_load_dwordx4 v5, s[12:15], s49 offen offset:3072 lds
    s_add_u32 m0, s50, 8192
    s_add_u32 s54, s49, 4096
    buffer_load_dwordx4 v5, s[12:15], s54 offen lds
    s_add_u32 s48, s48, 4096
    s_add_u32 s49, s49, 5120
    s_add_u32 s50, s50, 9216
    s_cmp_eq_u32 s50, s53
    s_cselect_b32 s50, s52, s50
    s_mov_b32 m0, s50
    s_nop 0
    buffer_load_dwordx4 v5, s[8:11], s48 offen lds
    buffer_load_dwordx4 v5, s[8:11], s48 offen offset:1024 lds
    buffer_load_dwordx4 v5, s[8:11], s48 offen offset:2048 lds
    buffer_load_dwordx4 v5, s[8:11], s48 offen offset:3072 lds
    s_add_u32 m0, s50, 4096
    s_nop 0
    buffer_load_dwordx4 v5, s[12:15], s49 offen lds
    buffer_load_dwordx4 v5, s[12:15], s49 offen offset:1024 lds
    buffer_load_dwordx4 v5, s[12:15], s49 offen offset:2048 lds
    buffer_load_dwordx4 v5, s[12:15], s49 offen offset:3072 lds
    s_add_u32 m0, s50, 8192
    s_add_u32 s54, s49, 4096
    buffer_load_dwordx4 v5, s[12:15], s54 offen lds
    s_add_u32 s48, s48, 4096
    s_add_u32 s49, s49, 5120
    s_add_u32 s50, s50, 9216
    s_cmp_eq_u32 s50, s53
    s_cselect_b32 s50, s52, s50
    s_mov_b32 m0, s50
    s_nop 0
    buffer_load_dwordx4 v5, s[8:11], s48 offen lds
    buffer_load_dwordx4 v5, s[8:11], s48 offen offset:1024 lds
    buffer_load_dwordx4 v5, s[8:11], s48 offen offset:2048 lds
    buffer_load_dwordx4 v5, s[8:11], s48 offen offset:3072 lds
    s_add_u32 m0, s50, 4096
    s_nop 0
    buffer_load_dwordx4 v5, s[12:15], s49 offen lds
    buffer_load_dwordx4 v5, s[12:15], s49 offen offset:1024 lds
    buffer_load_dwordx4 v5, s[12:15], s49 offen offset:2048 lds
    buffer_load_dwordx4 v5, s[12:15], s49 offen offset:3072 lds
    s_add_u32 m0, s50, 8192
    s_add_u32 s54, s49, 4096
    buffer_load_dwordx4 v5, s[12:15], s54 offen lds
    s_add_u32 s48, s48, 4096
    s_add_u32 s49, s49, 5120
    s_add_u32 s50, s50, 9216
    s_cmp_eq_u32 s50, s53
    s_cselect_b32 s50, s52, s50
    s_mov_b32 m0, s50
    s_nop 0
    buffer_load_dwordx4 v5, s[8:11], s48 offen lds
    buffer_load_dwordx4 v5, s[8:11], s48 offen offset:1024 lds
    buffer_load_dwordx4 v5, s[8:11], s48 offen offset:2048 lds
    buffer_load_dwordx4 v5, s[8:11], s48 offen offset:3072 lds
    s_add_u32 m0, s50, 4096
    s_nop 0
    buffer_load_dwordx4 v5, s[12:15], s49 offen lds
    buffer_load_dwordx4 v5, s[12:15], s49 offen offset:1024 lds
    buffer_load_dwordx4 v5, s[12:15], s49 offen offset:2048 lds
    buffer_load_dwordx4 v5, s[12:15], s49 offen offset:3072 lds
    s_add_u32 m0, s50, 8192
    s_add_u32 s54, s49, 4096
    buffer_load_dwordx4 v5, s[12:15], s54 offen lds
    s_add_u32 s48, s48, 4096
    s_add_u32 s49, s49, 5120
    s_add_u32 s50, s50, 9216
    s_cmp_eq_u32 s50, s53
    s_cselect_b32 s50, s52, s50
    s_mov_b32 s24, s78
    s_and_b32 s25, s79, 0xffff
    s_mov_b32 s26, 0x280000
    s_mov_b32 s27, 0x20000
    s_add_u32 s28, s82, 0x1000000
    s_addc_u32 s29, s83, 0
    s_and_b32 s29, s29, 0xffff
    s_mov_b32 s30, 0x280000
    s_mov_b32 s31, 0x20000
    s_mov_b32 s20, s82
    s_and_b32 s21, s83, 0xffff
    s_mov_b32 s22, 0x100000
    s_mov_b32 s23, 0x20000
    v_lshrrev_b32 v7, 4, v1
    s_lshl_b32 s58, s5, 4
    s_add_u32 s58, s58, s56
    v_and_b32 v20, 15, v1
    v_add_u32 v20, s58, v20
    v_mul_u32_u24 v20, 1280, v20
    v_lshl_add_u32 v20, v7, 4, v20
    s_lshl_b32 s58, s57, 1
    v_add_u32 v20, s58, v20
    v_lshlrev_b32 v21, 3, v7
    v_sub_u32 v21, v20, v21
    buffer_load_dwordx4 v[8:11], v20, s[28:31], 0 offen
    buffer_load_dwordx4 v[12:15], v20, s[28:31], 0 offen offset:64
    buffer_load_dwordx2 v[16:17], v21, s[28:31], 0 offen offset:128
    v_and_b32 v3, 15, v1
    v_lshrrev_b32 v4, 2, v3
    v_sub_u32 v4, 0, v4
    v_xor_b32 v4, v4, v7
    v_and_b32 v4, 3, v4
    v_lshlrev_b32 v22, 6, v3
    v_lshl_add_u32 v22, v4, 4, v22
    v_bfe_u32 v30, v1, 2, 2
    v_lshl_add_u32 v3, v7, 3, v30
    v_mul_u32_u24 v3, 160, v3
    v_and_b32 v4, 3, v1
    v_lshl_add_u32 v3, v4, 4, v3
    v_add_u32 v23, 4096, v3
    v_lshl_add_u32 v3, v7, 3, v30
    v_mul_u32_u24 v3, 160, v3
    v_and_b32 v4, 3, v1
    v_lshl_add_u32 v3, v4, 4, v3
    v_add_u32 v24, 4160, v3
    v_lshl_add_u32 v3, v7, 3, v30
    v_mul_u32_u24 v3, 160, v3
    v_and_b32 v4, 3, v1
    v_lshl_add_u32 v3, v4, 3, v3
    v_add_u32 v25, 4224, v3
    v_mov_b32 v104, 0
    v_mov_b32 v105, 0
    v_mov_b32 v106, 0
    v_mov_b32 v107, 0
    v_mov_b32 v108, 0
    v_mov_b32 v109, 0
    v_mov_b32 v110, 0
    v_mov_b32 v111, 0
    v_mov_b32 v112, 0
    v_mov_b32 v113, 0
    v_mov_b32 v114, 0
    v_mov_b32 v115, 0
    v_mov_b32 v116, 0
    v_mov_b32 v117, 0
    v_mov_b32 v118, 0
    v_mov_b32 v119, 0
    v_mov_b32 v120, 0
    v_mov_b32 v121, 0
    v_mov_b32 v122, 0
    v_mov_b32 v123, 0
    v_mov_b32 v124, 0
    v_mov_b32 v125, 0
    v_mov_b32 v126, 0
    v_mov_b32 v127, 0
    v_mov_b32 v128, 0
    v_mov_b32 v129, 0
    v_mov_b32 v130, 0
    v_mov_b32 v131, 0
    v_mov_b32 v132, 0
    v_mov_b32 v133, 0
    v_mov_b32 v134, 0
    v_mov_b32 v135, 0
    v_mov_b32 v136, 0
    v_mov_b32 v137, 0
    v_mov_b32 v138, 0
    v_mov_b32 v139, 0
    v_mov_b32 v140, 0
    v_mov_b32 v141, 0
    v_mov_b32 v142, 0
    v_mov_b32 v143, 0
    v_mov_b32 v144, 0
    v_mov_b32 v145, 0
    v_mov_b32 v146, 0
    v_mov_b32 v147, 0
    v_mov_b32 v148, 0
    v_mov_b32 v149, 0
    v_mov_b32 v150, 0
    v_mov_b32 v151, 0
    v_mov_b32 v152, 0
    v_mov_b32 v153, 0
    v_mov_b32 v154, 0
    v_mov_b32 v155, 0
    v_mov_b32 v156, 0
    v_mov_b32 v157, 0
    v_mov_b32 v158, 0
    v_mov_b32 v159, 0
    v_mov_b32 v160, 0
    v_mov_b32 v161, 0
    v_mov_b32 v162, 0
    v_mov_b32 v163, 0
    v_mov_b32 v164, 0
    v_mov_b32 v165, 0
    v_mov_b32 v166, 0
    v_mov_b32 v167, 0
    v_mov_b32 v168, 0
    v_mov_b32 v169, 0
    v_mov_b32 v170, 0
    v_mov_b32 v171, 0
    v_mov_b32 v172, 0
    v_mov_b32 v173, 0
    v_mov_b32 v174, 0
    v_mov_b32 v175, 0
    v_mov_b32 v176, 0
    v_mov_b32 v177, 0
    v_mov_b32 v178, 0
    v_mov_b32 v179, 0
    v_mov_b32 v180, 0
    v_mov_b32 v181, 0
    v_mov_b32 v182, 0
    v_mov_b32 v183, 0
    s_waitcnt vmcnt(30)
    v_add_u32 v26, s51, v22
    v_add_u32 v27, s51, v23
    v_add_u32 v28, s51, v24
    v_add_u32 v29, s51, v25
    s_add_u32 s51, s51, 9216
    s_cmp_eq_u32 s51, s53
    s_cselect_b32 s51, s52, s51
    ds_read_b128 v[32:35], v26 offset:0
    ds_read_b128 v[36:39], v26 offset:1024
    ds_read_b128 v[40:43], v26 offset:2048
    ds_read_b128 v[44:47], v26 offset:3072
    ds_read_b64_tr_b16 v[64:65], v27 offset:0
    ds_read_b64_tr_b16 v[66:67], v27 offset:640
    ds_read_b64_tr_b16 v[68:69], v27 offset:8
    ds_read_b64_tr_b16 v[70:71], v27 offset:648
    ds_read_b64_tr_b16 v[72:73], v28 offset:0
    ds_read_b64_tr_b16 v[74:75], v28 offset:640
    ds_read_b64_tr_b16 v[76:77], v28 offset:8
    ds_read_b64_tr_b16 v[78:79], v28 offset:648
    ds_read_b64_tr_b16 v[80:81], v29 offset:0
    ds_read_b64_tr_b16 v[82:83], v29 offset:640
    s_waitcnt lgkmcnt(0)
loop_down1_kernel_2:
    s_cmp_le_u32 s55, 4
    s_cbranch_scc1 tail_down1_kernel_5
    s_waitcnt vmcnt(18)
    v_add_u32 v26, s51, v22
    v_add_u32 v27, s51, v23
    v_add_u32 v28, s51, v24
    v_add_u32 v29, s51, v25
    s_add_u32 s51, s51, 9216
    s_cmp_eq_u32 s51, s53
    s_cselect_b32 s51, s52, s51
    ds_read_b128 v[48:51], v26 offset:0
    ds_read_b128 v[52:55], v26 offset:1024
    v_mfma_f32_16x16x32_bf16 v[104:107], v[64:67], v[32:35], v[104:107]
    ds_read_b128 v[56:59], v26 offset:2048
    v_mfma_f32_16x16x32_bf16 v[124:127], v[64:67], v[36:39], v[124:127]
    ds_read_b128 v[60:63], v26 offset:3072
    v_mfma_f32_16x16x32_bf16 v[144:147], v[64:67], v[40:43], v[144:147]
    ds_read_b64_tr_b16 v[84:85], v27 offset:0
    v_mfma_f32_16x16x32_bf16 v[164:167], v[64:67], v[44:47], v[164:167]
    ds_read_b64_tr_b16 v[86:87], v27 offset:640
    v_mfma_f32_16x16x32_bf16 v[108:111], v[68:71], v[32:35], v[108:111]
    ds_read_b64_tr_b16 v[88:89], v27 offset:8
    ds_read_b64_tr_b16 v[90:91], v27 offset:648
    v_mfma_f32_16x16x32_bf16 v[128:131], v[68:71], v[36:39], v[128:131]
    ds_read_b64_tr_b16 v[92:93], v28 offset:0
    v_mfma_f32_16x16x32_bf16 v[148:151], v[68:71], v[40:43], v[148:151]
    ds_read_b64_tr_b16 v[94:95], v28 offset:640
    v_mfma_f32_16x16x32_bf16 v[168:171], v[68:71], v[44:47], v[168:171]
    ds_read_b64_tr_b16 v[96:97], v28 offset:8
    v_mfma_f32_16x16x32_bf16 v[112:115], v[72:75], v[32:35], v[112:115]
    ds_read_b64_tr_b16 v[98:99], v28 offset:648
    v_mfma_f32_16x16x32_bf16 v[132:135], v[72:75], v[36:39], v[132:135]
    ds_read_b64_tr_b16 v[100:101], v29 offset:0
    ds_read_b64_tr_b16 v[102:103], v29 offset:640
    v_mfma_f32_16x16x32_bf16 v[152:155], v[72:75], v[40:43], v[152:155]
    s_mov_b32 m0, s50
    s_nop 0
    buffer_load_dwordx4 v5, s[8:11], s48 offen lds
    v_mfma_f32_16x16x32_bf16 v[172:175], v[72:75], v[44:47], v[172:175]
    buffer_load_dwordx4 v5, s[8:11], s48 offen offset:1024 lds
    v_mfma_f32_16x16x32_bf16 v[116:119], v[76:79], v[32:35], v[116:119]
    buffer_load_dwordx4 v5, s[8:11], s48 offen offset:2048 lds
    v_mfma_f32_16x16x32_bf16 v[136:139], v[76:79], v[36:39], v[136:139]
    buffer_load_dwordx4 v5, s[8:11], s48 offen offset:3072 lds
    v_mfma_f32_16x16x32_bf16 v[156:159], v[76:79], v[40:43], v[156:159]
    s_add_u32 m0, s50, 4096
    s_nop 0
    buffer_load_dwordx4 v5, s[12:15], s49 offen lds
    buffer_load_dwordx4 v5, s[12:15], s49 offen offset:1024 lds
    v_mfma_f32_16x16x32_bf16 v[176:179], v[76:79], v[44:47], v[176:179]
    buffer_load_dwordx4 v5, s[12:15], s49 offen offset:2048 lds
    v_mfma_f32_16x16x32_bf16 v[120:123], v[80:83], v[32:35], v[120:123]
    buffer_load_dwordx4 v5, s[12:15], s49 offen offset:3072 lds
    v_mfma_f32_16x16x32_bf16 v[140:143], v[80:83], v[36:39], v[140:143]
    s_add_u32 m0, s50, 8192
    s_add_u32 s54, s49, 4096
    buffer_load_dwordx4 v5, s[12:15], s54 offen lds
    v_mfma_f32_16x16x32_bf16 v[160:163], v[80:83], v[40:43], v[160:163]
    s_add_u32 s48, s48, 4096
    s_add_u32 s49, s49, 5120
    s_add_u32 s50, s50, 9216
    s_cmp_eq_u32 s50, s53
    s_cselect_b32 s50, s52, s50
    v_mfma_f32_16x16x32_bf16 v[180:183], v[80:83], v[44:47], v[180:183]
    s_nop 0
    s_nop 0
    s_branch join_down1_kernel_6
tail_down1_kernel_5:
    s_waitcnt vmcnt(0)
    v_add_u32 v26, s51, v22
    v_add_u32 v27, s51, v23
    v_add_u32 v28, s51, v24
    v_add_u32 v29, s51, v25
    s_add_u32 s51, s51, 9216
    s_cmp_eq_u32 s51, s53
    s_cselect_b32 s51, s52, s51
    ds_read_b128 v[48:51], v26 offset:0
    ds_read_b128 v[52:55], v26 offset:1024
    v_mfma_f32_16x16x32_bf16 v[104:107], v[64:67], v[32:35], v[104:107]
    v_mfma_f32_16x16x32_bf16 v[124:127], v[64:67], v[36:39], v[124:127]
    ds_read_b128 v[56:59], v26 offset:2048
    v_mfma_f32_16x16x32_bf16 v[144:147], v[64:67], v[40:43], v[144:147]
    v_mfma_f32_16x16x32_bf16 v[164:167], v[64:67], v[44:47], v[164:167]
    ds_read_b128 v[60:63], v26 offset:3072
    v_mfma_f32_16x16x32_bf16 v[108:111], v[68:71], v[32:35], v[108:111]
    ds_read_b64_tr_b16 v[84:85], v27 offset:0
    v_mfma_f32_16x16x32_bf16 v[128:131], v[68:71], v[36:39], v[128:131]
    v_mfma_f32_16x16x32_bf16 v[148:151], v[68:71], v[40:43], v[148:151]
    ds_read_b64_tr_b16 v[86:87], v27 offset:640
    v_mfma_f32_16x16x32_bf16 v[168:171], v[68:71], v[44:47], v[168:171]
    v_mfma_f32_16x16x32_bf16 v[112:115], v[72:75], v[32:35], v[112:115]
    ds_read_b64_tr_b16 v[88:89], v27 offset:8
    v_mfma_f32_16x16x32_bf16 v[132:135], v[72:75], v[36:39], v[132:135]
    ds_read_b64_tr_b16 v[90:91], v27 offset:648
    v_mfma_f32_16x16x32_bf16 v[152:155], v[72:75], v[40:43], v[152:155]
    v_mfma_f32_16x16x32_bf16 v[172:175], v[72:75], v[44:47], v[172:175]
    ds_read_b64_tr_b16 v[92:93], v28 offset:0
    v_mfma_f32_16x16x32_bf16 v[116:119], v[76:79], v[32:35], v[116:119]
    v_mfma_f32_16x16x32_bf16 v[136:139], v[76:79], v[36:39], v[136:139]
    ds_read_b64_tr_b16 v[94:95], v28 offset:640
    v_mfma_f32_16x16x32_bf16 v[156:159], v[76:79], v[40:43], v[156:159]
    ds_read_b64_tr_b16 v[96:97], v28 offset:8
    v_mfma_f32_16x16x32_bf16 v[176:179], v[76:79], v[44:47], v[176:179]
    v_mfma_f32_16x16x32_bf16 v[120:123], v[80:83], v[32:35], v[120:123]
    ds_read_b64_tr_b16 v[98:99], v28 offset:648
    v_mfma_f32_16x16x32_bf16 v[140:143], v[80:83], v[36:39], v[140:143]
    v_mfma_f32_16x16x32_bf16 v[160:163], v[80:83], v[40:43], v[160:163]
    ds_read_b64_tr_b16 v[100:101], v29 offset:0
    v_mfma_f32_16x16x32_bf16 v[180:183], v[80:83], v[44:47], v[180:183]
    ds_read_b64_tr_b16 v[102:103], v29 offset:640
join_down1_kernel_6:
    s_waitcnt lgkmcnt(0)
    s_sub_u32 s55, s55, 1
    s_cmp_eq_u32 s55, 1
    s_cbranch_scc1 lastB_down1_kernel_3
    s_cmp_le_u32 s55, 4
    s_cbranch_scc1 tail_down1_kernel_7
    s_waitcnt vmcnt(18)
    v_add_u32 v26, s51, v22
    v_add_u32 v27, s51, v23
    v_add_u32 v28, s51, v24
    v_add_u32 v29, s51, v25
    s_add_u32 s51, s51, 9216
    s_cmp_eq_u32 s51, s53
    s_cselect_b32 s51, s52, s51
    ds_read_b128 v[32:35], v26 offset:0
    ds_read_b128 v[36:39], v26 offset:1024
    v_mfma_f32_16x16x32_bf16 v[104:107], v[84:87], v[48:51], v[104:107]
    ds_read_b128 v[40:43], v26 offset:2048
    v_mfma_f32_16x16x32_bf16 v[124:127], v[84:87], v[52:55], v[124:127]
    ds_read_b128 v[44:47], v26 offset:3072
    v_mfma_f32_16x16x32_bf16 v[144:147], v[84:87], v[56:59], v[144:147]
    ds_read_b64_tr_b16 v[64:65], v27 offset:0
    v_mfma_f32_16x16x32_bf16 v[164:167], v[84:87], v[60:63], v[164:167]
    ds_read_b64_tr_b16 v[66:67], v27 offset:640
    v_mfma_f32_16x16x32_bf16 v[108:111], v[88:91], v[48:51], v[108:111]
    ds_read_b64_tr_b16 v[68:69], v27 offset:8
    ds_read_b64_tr_b16 v[70:71], v27 offset:648
    v_mfma_f32_16x16x32_bf16 v[128:131], v[88:91], v[52:55], v[128:131]
    ds_read_b64_tr_b16 v[72:73], v28 offset:0
    v_mfma_f32_16x16x32_bf16 v[148:151], v[88:91], v[56:59], v[148:151]
    ds_read_b64_tr_b16 v[74:75], v28 offset:640
    v_mfma_f32_16x16x32_bf16 v[168:171], v[88:91], v[60:63], v[168:171]
    ds_read_b64_tr_b16 v[76:77], v28 offset:8
    v_mfma_f32_16x16x32_bf16 v[112:115], v[92:95], v[48:51], v[112:115]
    ds_read_b64_tr_b16 v[78:79], v28 offset:648
    v_mfma_f32_16x16x32_bf16 v[132:135], v[92:95], v[52:55], v[132:135]
    ds_read_b64_tr_b16 v[80:81], v29 offset:0
    ds_read_b64_tr_b16 v[82:83], v29 offset:640
    v_mfma_f32_16x16x32_bf16 v[152:155], v[92:95], v[56:59], v[152:155]
    s_mov_b32 m0, s50
    s_nop 0
    buffer_load_dwordx4 v5, s[8:11], s48 offen lds
    v_mfma_f32_16x16x32_bf16 v[172:175], v[92:95], v[60:63], v[172:175]
    buffer_load_dwordx4 v5, s[8:11], s48 offen offset:1024 lds
    v_mfma_f32_16x16x32_bf16 v[116:119], v[96:99], v[48:51], v[116:119]
    buffer_load_dwordx4 v5, s[8:11], s48 offen offset:2048 lds
    v_mfma_f32_16x16x32_bf16 v[136:139], v[96:99], v[52:55], v[136:139]
    buffer_load_dwordx4 v5, s[8:11], s48 offen offset:3072 lds
    v_mfma_f32_16x16x32_bf16 v[156:159], v[96:99], v[56:59], v[156:159]
    s_add_u32 m0, s50, 4096
    s_nop 0
    buffer_load_dwordx4 v5, s[12:15], s49 offen lds
    buffer_load_dwordx4 v5, s[12:15], s49 offen offset:1024 lds
    v_mfma_f32_16x16x32_bf16 v[176:179], v[96:99], v[60:63], v[176:179]
    buffer_load_dwordx4 v5, s[12:15], s49 offen offset:2048 lds
    v_mfma_f32_16x16x32_bf16 v[120:123], v[100:103], v[48:51], v[120:123]
    buffer_load_dwordx4 v5, s[12:15], s49 offen offset:3072 lds
    v_mfma_f32_16x16x32_bf16 v[140:143], v[100:103], v[52:55], v[140:143]
    s_add_u32 m0, s50, 8192
    s_add_u32 s54, s49, 4096
    buffer_load_dwordx4 v5, s[12:15], s54 offen lds
    v_mfma_f32_16x16x32_bf16 v[160:163], v[100:103], v[56:59], v[160:163]
    s_add_u32 s48, s48, 4096
    s_add_u32 s49, s49, 5120
    s_add_u32 s50, s50, 9216
    s_cmp_eq_u32 s50, s53
    s_cselect_b32 s50, s52, s50
    v_mfma_f32_16x16x32_bf16 v[180:183], v[100:103], v[60:63], v[180:183]
    s_nop 0
    s_nop 0
    s_branch join_down1_kernel_8
tail_down1_kernel_7:
    s_waitcnt vmcnt(0)
    v_add_u32 v26, s51, v22
    v_add_u32 v27, s51, v23
    v_add_u32 v28, s51, v24
    v_add_u32 v29, s51, v25
    s_add_u32 s51, s51, 9216
    s_cmp_eq_u32 s51, s53
    s_cselect_b32 s51, s52, s51
    ds_read_b128 v[32:35], v26 offset:0
    ds_read_b128 v[36:39], v26 offset:1024
    v_mfma_f32_16x16x32_bf16 v[104:107], v[84:87], v[48:51], v[104:107]
    v_mfma_f32_16x16x32_bf16 v[124:127], v[84:87], v[52:55], v[124:127]
    ds_read_b128 v[40:43], v26 offset:2048
    v_mfma_f32_16x16x32_bf16 v[144:147], v[84:87], v[56:59], v[144:147]
    v_mfma_f32_16x16x32_bf16 v[164:167], v[84:87], v[60:63], v[164:167]
    ds_read_b128 v[44:47], v26 offset:3072
    v_mfma_f32_16x16x32_bf16 v[108:111], v[88:91], v[48:51], v[108:111]
    ds_read_b64_tr_b16 v[64:65], v27 offset:0
    v_mfma_f32_16x16x32_bf16 v[128:131], v[88:91], v[52:55], v[128:131]
    v_mfma_f32_16x16x32_bf16 v[148:151], v[88:91], v[56:59], v[148:151]
    ds_read_b64_tr_b16 v[66:67], v27 offset:640
    v_mfma_f32_16x16x32_bf16 v[168:171], v[88:91], v[60:63], v[168:171]
    v_mfma_f32_16x16x32_bf16 v[112:115], v[92:95], v[48:51], v[112:115]
    ds_read_b64_tr_b16 v[68:69], v27 offset:8
    v_mfma_f32_16x16x32_bf16 v[132:135], v[92:95], v[52:55], v[132:135]
    ds_read_b64_tr_b16 v[70:71], v27 offset:648
    v_mfma_f32_16x16x32_bf16 v[152:155], v[92:95], v[56:59], v[152:155]
    v_mfma_f32_16x16x32_bf16 v[172:175], v[92:95], v[60:63], v[172:175]
    ds_read_b64_tr_b16 v[72:73], v28 offset:0
    v_mfma_f32_16x16x32_bf16 v[116:119], v[96:99], v[48:51], v[116:119]
    v_mfma_f32_16x16x32_bf16 v[136:139], v[96:99], v[52:55], v[136:139]
    ds_read_b64_tr_b16 v[74:75], v28 offset:640
    v_mfma_f32_16x16x32_bf16 v[156:159], v[96:99], v[56:59], v[156:159]
    ds_read_b64_tr_b16 v[76:77], v28 offset:8
    v_mfma_f32_16x16x32_bf16 v[176:179], v[96:99], v[60:63], v[176:179]
    v_mfma_f32_16x16x32_bf16 v[120:123], v[100:103], v[48:51], v[120:123]
    ds_read_b64_tr_b16 v[78:79], v28 offset:648
    v_mfma_f32_16x16x32_bf16 v[140:143], v[100:103], v[52:55], v[140:143]
    v_mfma_f32_16x16x32_bf16 v[160:163], v[100:103], v[56:59], v[160:163]
    ds_read_b64_tr_b16 v[80:81], v29 offset:0
    v_mfma_f32_16x16x32_bf16 v[180:183], v[100:103], v[60:63], v[180:183]
    ds_read_b64_tr_b16 v[82:83], v29 offset:640
join_down1_kernel_8:
    s_waitcnt lgkmcnt(0)
    s_sub_u32 s55, s55, 1
    s_cmp_eq_u32 s55, 1
    s_cbranch_scc0 loop_down1_kernel_2
    v_mfma_f32_16x16x32_bf16 v[104:107], v[64:67], v[32:35], v[104:107]
    v_mfma_f32_16x16x32_bf16 v[124:127], v[64:67], v[36:39], v[124:127]
    v_mfma_f32_16x16x32_bf16 v[144:147], v[64:67], v[40:43], v[144:147]
    v_mfma_f32_16x16x32_bf16 v[164:167], v[64:67], v[44:47], v[164:167]
    v_mfma_f32_16x16x32_bf16 v[108:111], v[68:71], v[32:35], v[108:111]
    v_mfma_f32_16x16x32_bf16 v[128:131], v[68:71], v[36:39], v[128:131]
    v_mfma_f32_16x16x32_bf16 v[148:151], v[68:71], v[40:43], v[148:151]
    v_mfma_f32_16x16x32_bf16 v[168:171], v[68:71], v[44:47], v[168:171]
    v_mfma_f32_16x16x32_bf16 v[112:115], v[72:75], v[32:35], v[112:115]
    v_mfma_f32_16x16x32_bf16 v[132:135], v[72:75], v[36:39], v[132:135]
    v_mfma_f32_16x16x32_bf16 v[152:155], v[72:75], v[40:43], v[152:155]
    v_mfma_f32_16x16x32_bf16 v[172:175], v[72:75], v[44:47], v[172:175]
    v_mfma_f32_16x16x32_bf16 v[116:119], v[76:79], v[32:35], v[116:119]
    v_mfma_f32_16x16x32_bf16 v[136:139], v[76:79], v[36:39], v[136:139]
    v_mfma_f32_16x16x32_bf16 v[156:159], v[76:79], v[40:43], v[156:159]
    v_mfma_f32_16x16x32_bf16 v[176:179], v[76:79], v[44:47], v[176:179]
    v_mfma_f32_16x16x32_bf16 v[120:123], v[80:83], v[32:35], v[120:123]
    v_mfma_f32_16x16x32_bf16 v[140:143], v[80:83], v[36:39], v[140:143]
    v_mfma_f32_16x16x32_bf16 v[160:163], v[80:83], v[40:43], v[160:163]
    v_mfma_f32_16x16x32_bf16 v[180:183], v[80:83], v[44:47], v[180:183]
    s_branch done_down1_kernel_4
lastB_down1_kernel_3:
    v_mfma_f32_16x16x32_bf16 v[104:107], v[84:87], v[48:51], v[104:107]
    v_mfma_f32_16x16x32_bf16 v[124:127], v[84:87], v[52:55], v[124:127]
    v_mfma_f32_16x16x32_bf16 v[144:147], v[84:87], v[56:59], v[144:147]
    v_mfma_f32_16x16x32_bf16 v[164:167], v[84:87], v[60:63], v[164:167]
    v_mfma_f32_16x16x32_bf16 v[108:111], v[88:91], v[48:51], v[108:111]
    v_mfma_f32_16x16x32_bf16 v[128:131], v[88:91], v[52:55], v[128:131]
    v_mfma_f32_16x16x32_bf16 v[148:151], v[88:91], v[56:59], v[148:151]
    v_mfma_f32_16x16x32_bf16 v[168:171], v[88:91], v[60:63], v[168:171]
    v_mfma_f32_16x16x32_bf16 v[112:115], v[92:95], v[48:51], v[112:115]
    v_mfma_f32_16x16x32_bf16 v[132:135], v[92:95], v[52:55], v[132:135]
    v_mfma_f32_16x16x32_bf16 v[152:155], v[92:95], v[56:59], v[152:155]
    v_mfma_f32_16x16x32_bf16 v[172:175], v[92:95], v[60:63], v[172:175]
    v_mfma_f32_16x16x32_bf16 v[116:119], v[96:99], v[48:51], v[116:119]
    v_mfma_f32_16x16x32_bf16 v[136:139], v[96:99], v[52:55], v[136:139]
    v_mfma_f32_16x16x32_bf16 v[156:159], v[96:99], v[56:59], v[156:159]
    v_mfma_f32_16x16x32_bf16 v[176:179], v[96:99], v[60:63], v[176:179]
    v_mfma_f32_16x16x32_bf16 v[120:123], v[100:103], v[48:51], v[120:123]
    v_mfma_f32_16x16x32_bf16 v[140:143], v[100:103], v[52:55], v[140:143]
    v_mfma_f32_16x16x32_bf16 v[160:163], v[100:103], v[56:59], v[160:163]
    v_mfma_f32_16x16x32_bf16 v[180:183], v[100:103], v[60:63], v[180:183]
done_down1_kernel_4:
    s_nop 7
    s_barrier
    v_lshlrev_b32 v184, 4, v1
    s_mul_i32 s58, s5, 20480
    v_add_u32 v3, s58, v184
    ds_write_b128 v3, v[104:107] offset:0
    ds_write_b128 v3, v[108:111] offset:1024
    ds_write_b128 v3, v[112:115] offset:2048
    ds_write_b128 v3, v[116:119] offset:3072
    ds_write_b128 v3, v[120:123] offset:4096
    ds_write_b128 v3, v[124:127] offset:5120
    ds_write_b128 v3, v[128:131] offset:6144
    ds_write_b128 v3, v[132:135] offset:7168
    ds_write_b128 v3, v[136:139] offset:8192
    ds_write_b128 v3, v[140:143] offset:9216
    ds_write_b128 v3, v[144:147] offset:10240
    ds_write_b128 v3, v[148:151] offset:11264
    ds_write_b128 v3, v[152:155] offset:12288
    ds_write_b128 v3, v[156:159] offset:13312
    ds_write_b128 v3, v[160:163] offset:14336
    ds_write_b128 v3, v[164:167] offset:15360
    ds_write_b128 v3, v[168:171] offset:16384
    ds_write_b128 v3, v[172:175] offset:17408
    ds_write_b128 v3, v[176:179] offset:18432
    ds_write_b128 v3, v[180:183] offset:19456
    s_waitcnt lgkmcnt(0)
    s_barrier
    s_mul_i32 s58, s5, 5120
    v_add_u32 v3, s58, v184
    v_add_u32 v4, 40960, v3
    ds_read_b128 v[104:107], v3 offset:0
    ds_read_b128 v[108:111], v3 offset:1024
    ds_read_b128 v[112:115], v3 offset:2048
    ds_read_b128 v[116:119], v3 offset:3072
    ds_read_b128 v[120:123], v3 offset:4096
    ds_read_b128 v[32:35], v3 offset:20480
    ds_read_b128 v[36:39], v3 offset:21504
    ds_read_b128 v[40:43], v3 offset:22528
    ds_read_b128 v[44:47], v3 offset:23552
    ds_read_b128 v[48:51], v3 offset:24576
    ds_read_b128 v[52:55], v4 offset:0
    ds_read_b128 v[56:59], v4 offset:1024
    ds_read_b128 v[60:63], v4 offset:2048
    ds_read_b128 v[64:67], v4 offset:3072
    ds_read_b128 v[68:71], v4 offset:4096
    ds_read_b128 v[72:75], v4 offset:20480
    ds_read_b128 v[76:79], v4 offset:21504
    ds_read_b128 v[80:83], v4 offset:22528
    ds_read_b128 v[84:87], v4 offset:23552
    ds_read_b128 v[88:91], v4 offset:24576
    s_waitcnt lgkmcnt(0)
    v_add_f32 v104, v104, v32
    v_add_f32 v104, v104, v52
    v_add_f32 v104, v104, v72
    v_add_f32 v105, v105, v33
    v_add_f32 v105, v105, v53
    v_add_f32 v105, v105, v73
    v_add_f32 v106, v106, v34
    v_add_f32 v106, v106, v54
    v_add_f32 v106, v106, v74
    v_add_f32 v107, v107, v35
    v_add_f32 v107, v107, v55
    v_add_f32 v107, v107, v75
    v_add_f32 v108, v108, v36
    v_add_f32 v108, v108, v56
    v_add_f32 v108, v108, v76
    v_add_f32 v109, v109, v37
    v_add_f32 v109, v109, v57
    v_add_f32 v109, v109, v77
    v_add_f32 v110, v110, v38
    v_add_f32 v110, v110, v58
    v_add_f32 v110, v110, v78
    v_add_f32 v111, v111, v39
    v_add_f32 v111, v111, v59
    v_add_f32 v111, v111, v79
    v_add_f32 v112, v112, v40
    v_add_f32 v112, v112, v60
    v_add_f32 v112, v112, v80
    v_add_f32 v113, v113, v41
    v_add_f32 v113, v113, v61
    v_add_f32 v113, v113, v81
    v_add_f32 v114, v114, v42
    v_add_f32 v114, v114, v62
    v_add_f32 v114, v114, v82
    v_add_f32 v115, v115, v43
    v_add_f32 v115, v115, v63
    v_add_f32 v115, v115, v83
    v_add_f32 v116, v116, v44
    v_add_f32 v116, v116, v64
    v_add_f32 v116, v116, v84
    v_add_f32 v117, v117, v45
    v_add_f32 v117, v117, v65
    v_add_f32 v117, v117, v85
    v_add_f32 v118, v118, v46
    v_add_f32 v118, v118, v66
    v_add_f32 v118, v118, v86
    v_add_f32 v119, v119, v47
    v_add_f32 v119, v119, v67
    v_add_f32 v119, v119, v87
    v_add_f32 v120, v120, v48
    v_add_f32 v120, v120, v68
    v_add_f32 v120, v120, v88
    v_add_f32 v121, v121, v49
    v_add_f32 v121, v121, v69
    v_add_f32 v121, v121, v89
    v_add_f32 v122, v122, v50
    v_add_f32 v122, v122, v70
    v_add_f32 v122, v122, v90
    v_add_f32 v123, v123, v51
    v_add_f32 v123, v123, v71
    v_add_f32 v123, v123, v91
    v_mov_b32 v136, 0
    v_mov_b32 v137, 0
    v_lshlrev_b32 v140, 16, v8
    v_add_f32 v128, v104, v140
    v_and_b32 v140, 0xffff0000, v8
    v_add_f32 v129, v105, v140
    v_lshlrev_b32 v140, 16, v9
    v_add_f32 v130, v106, v140
    v_and_b32 v140, 0xffff0000, v9
    v_add_f32 v131, v107, v140
    v_lshlrev_b32 v140, 16, v10
    v_add_f32 v132, v108, v140
    v_and_b32 v140, 0xffff0000, v10
    v_add_f32 v133, v109, v140
    v_lshlrev_b32 v140, 16, v11
    v_add_f32 v134, v110, v140
    v_and_b32 v140, 0xffff0000, v11
    v_add_f32 v135, v111, v140
    v_cvt_pk_bf16_f32 v8, v128, v129
    v_cvt_pk_bf16_f32 v9, v130, v131
    v_cvt_pk_bf16_f32 v10, v132, v133
    v_cvt_pk_bf16_f32 v11, v134, v135
    buffer_store_dwordx4 v[8:11], v20, s[24:27], 0 offen offset:0
    v_lshlrev_b32 v140, 16, v12
    v_add_f32 v128, v112, v140
    v_and_b32 v140, 0xffff0000, v12
    v_add_f32 v129, v113, v140
    v_lshlrev_b32 v140, 16, v13
    v_add_f32 v130, v114, v140
    v_and_b32 v140, 0xffff0000, v13
    v_add_f32 v131, v115, v140
    v_lshlrev_b32 v140, 16, v14
    v_add_f32 v132, v116, v140
    v_and_b32 v140, 0xffff0000, v14
    v_add_f32 v133, v117, v140
    v_lshlrev_b32 v140, 16, v15
    v_add_f32 v134, v118, v140
    v_and_b32 v140, 0xffff0000, v15
    v_add_f32 v135, v119, v140
    v_cvt_pk_bf16_f32 v12, v128, v129
    v_cvt_pk_bf16_f32 v13, v130, v131
    v_cvt_pk_bf16_f32 v14, v132, v133
    v_cvt_pk_bf16_f32 v15, v134, v135
    buffer_store_dwordx4 v[12:15], v20, s[24:27], 0 offen offset:64
    v_lshlrev_b32 v140, 16, v16
    v_add_f32 v128, v120, v140
    v_and_b32 v140, 0xffff0000, v16
    v_add_f32 v129, v121, v140
    v_lshlrev_b32 v140, 16, v17
    v_add_f32 v130, v122, v140
    v_and_b32 v140, 0xffff0000, v17
    v_add_f32 v131, v123, v140
    v_cvt_pk_bf16_f32 v16, v128, v129
    v_cvt_pk_bf16_f32 v17, v130, v131
    buffer_store_dwordx2 v[16:17], v21, s[24:27], 0 offen offset:128
end_down1_kernel_1:
    s_endpgm
.section .rodata,"a"
.p2align 6
.amdhsa_kernel prep_kernel
  .amdhsa_next_free_vgpr 64
  .amdhsa_next_free_sgpr 102
  .amdhsa_accum_offset 64
  .amdhsa_group_segment_fixed_size 0
  .amdhsa_kernarg_size 80
  .amdhsa_user_sgpr_count 2
  .amdhsa_user_sgpr_kernarg_segment_ptr 1
  .amdhsa_system_sgpr_workgroup_id_x 1
.end_amdhsa_kernel
.p2align 6
.amdhsa_kernel attn_kernel
  .amdhsa_next_free_vgpr 133
  .amdhsa_next_free_sgpr 102
  .amdhsa_accum_offset 136
  .amdhsa_group_segment_fixed_size 0
  .amdhsa_kernarg_size 80
  .amdhsa_user_sgpr_count 2
  .amdhsa_user_sgpr_kernarg_segment_ptr 1
  .amdhsa_system_sgpr_workgroup_id_x 1
.end_amdhsa_kernel
.p2align 6
.amdhsa_kernel geglu_kernel
  .amdhsa_next_free_vgpr 248
  .amdhsa_next_free_sgpr 102
  .amdhsa_accum_offset 248
  .amdhsa_group_segment_fixed_size 0
  .amdhsa_kernarg_size 80
  .amdhsa_user_sgpr_count 2
  .amdhsa_user_sgpr_kernarg_segment_ptr 1
  .amdhsa_system_sgpr_workgroup_id_x 1
.end_amdhsa_kernel
.p2align 6
.amdhsa_kernel qkv0_kernel
  .amdhsa_next_free_vgpr 224
  .amdhsa_next_free_sgpr 102
  .amdhsa_accum_offset 224
  .amdhsa_group_segment_fixed_size 0
  .amdhsa_kernarg_size 80
  .amdhsa_user_sgpr_count 2
  .amdhsa_user_sgpr_kernarg_segment_ptr 1
  .amdhsa_system_sgpr_workgroup_id_x 1
.end_amdhsa_kernel
.p2align 6
.amdhsa_kernel oproj0_kernel
  .amdhsa_next_free_vgpr 185
  .amdhsa_next_free_sgpr 102
  .amdhsa_accum_offset 188
  .amdhsa_group_segment_fixed_size 0
  .amdhsa_kernarg_size 80
  .amdhsa_user_sgpr_count 2
  .amdhsa_user_sgpr_kernarg_segment_ptr 1
  .amdhsa_system_sgpr_workgroup_id_x 1
.end_amdhsa_kernel
.p2align 6
.amdhsa_kernel down0_kernel
  .amdhsa_next_free_vgpr 185
  .amdhsa_next_free_sgpr 102
  .amdhsa_accum_offset 188
  .amdhsa_group_segment_fixed_size 0
  .amdhsa_kernarg_size 80
  .amdhsa_user_sgpr_count 2
  .amdhsa_user_sgpr_kernarg_segment_ptr 1
  .amdhsa_system_sgpr_workgroup_id_x 1
.end_amdhsa_kernel
.p2align 6
.amdhsa_kernel qkv1_kernel
  .amdhsa_next_free_vgpr 224
  .amdhsa_next_free_sgpr 102
  .amdhsa_accum_offset 224
  .amdhsa_group_segment_fixed_size 0
  .amdhsa_kernarg_size 80
  .amdhsa_user_sgpr_count 2
  .amdhsa_user_sgpr_kernarg_segment_ptr 1
  .amdhsa_system_sgpr_workgroup_id_x 1
.end_amdhsa_kernel
.p2align 6
.amdhsa_kernel oproj1_kernel
  .amdhsa_next_free_vgpr 185
  .amdhsa_next_free_sgpr 102
  .amdhsa_accum_offset 188
  .amdhsa_group_segment_fixed_size 0
  .amdhsa_kernarg_size 80
  .amdhsa_user_sgpr_count 2
  .amdhsa_user_sgpr_kernarg_segment_ptr 1
  .amdhsa_system_sgpr_workgroup_id_x 1
.end_amdhsa_kernel
.p2align 6
.amdhsa_kernel down1_kernel
  .amdhsa_next_free_vgpr 185
  .amdhsa_next_free_sgpr 102
  .amdhsa_accum_offset 188
  .amdhsa_group_segment_fixed_size 0
  .amdhsa_kernarg_size 80
  .amdhsa_user_sgpr_count 2
  .amdhsa_user_sgpr_kernarg_segment_ptr 1
  .amdhsa_system_sgpr_workgroup_id_x 1
.end_amdhsa_kernel
```
